```python
import torch

def _softmax(x, axis=-1):
    return torch.softmax(x, dim=axis)
def _gelu(x):
    return torch.nn.functional.gelu(x, approximate="tanh")
def _silu(x):
    return torch.nn.functional.silu(x)
def _sigmoid(x):
    return torch.sigmoid(x)
def _layernorm(x, axis=-1, eps=1e-5):
    m = x.mean(dim=axis, keepdim=True)
    v = x.var(dim=axis, keepdim=True, unbiased=False)
    return (x - m) / torch.sqrt(v + eps)
def _scatter_add(tgt, idx, src, axis=0):
    return tgt.clone().index_add_(axis, idx, src)
def _segment_sum(src, seg, n):
    out = torch.zeros((n,) + src.shape[1:], dtype=src.dtype)
    return out.index_add_(0, seg, src)
def _pad(x, pw):
    flat = tuple(v for pair in reversed(pw) for v in pair)
    return torch.nn.functional.pad(x, flat)

kernel_name = 'parallel_sum__ssm_conv_s4__glu_gated_reglu__prompt'

def setup_inputs():

    _w = (lambda a: (lambda t: t.to(torch.bfloat16) if t.is_floating_point() else t)(torch.as_tensor(a)))
    def _A_setup():
        B, L, D, N = 1, 2048, 640, 128
        A_re = -(lambda _x: torch.exp(torch.as_tensor(_x)))((lambda *s: torch.randn(*s, dtype=torch.bfloat16) * 6.4)(D, N))
        A_im = torch.pi * (lambda *s: torch.randn(*s, dtype=torch.bfloat16) * 0.05)(D, N)
        B_re = (lambda *s: torch.randn(*s, dtype=torch.bfloat16) * 0.1)(D, N)
        B_im = (lambda *s: torch.randn(*s, dtype=torch.bfloat16) * 0.1)(D, N)
        C_re = (lambda *s: torch.randn(*s, dtype=torch.bfloat16) * 0.1)(D, N)
        C_im = (lambda *s: torch.randn(*s, dtype=torch.bfloat16) * 0.1)(D, N)
        log_dt = (lambda *s: torch.randn(*s, dtype=torch.bfloat16) * 0.05)(D) * 0.5 - 4.0
        Dskip = (lambda *s: torch.randn(*s, dtype=torch.bfloat16) * 0.05)(D)
        return {
            "u": _w((lambda *s: torch.randn(*s, dtype=torch.bfloat16) * 0.05)(B, L, D)),
            "A_re": _w(A_re),
            "A_im": _w(A_im),
            "B_re": _w(B_re),
            "B_im": _w(B_im),
            "C_re": _w(C_re),
            "C_im": _w(C_im),
            "log_dt": _w(log_dt),
            "Dskip": _w(Dskip),
        }
    _A_in = _A_setup()

    def _B_setup():
        B, S, D, F = 1, 2048, 640, 1728
        return {
            "x": _w((lambda *s: torch.randn(*s, dtype=torch.bfloat16) * 0.05)(B, S, D)),
            "W_gate": _w((lambda *s: torch.randn(*s, dtype=torch.bfloat16) * 0.4)(D, F) * (2.0 / D) ** 0.5),
            "W_up": _w((lambda *s: torch.randn(*s, dtype=torch.bfloat16) * 0.4)(D, F) * (2.0 / D) ** 0.5),
            "W_down": _w((lambda *s: torch.randn(*s, dtype=torch.bfloat16) * 0.4)(F, D) * (1.0 / F) ** 0.5),
        }
    _B_in = _B_setup()

    return {
        "A_u": _A_in["u"],
        "A_A_re": _A_in["A_re"],
        "A_A_im": _A_in["A_im"],
        "A_B_re": _A_in["B_re"],
        "A_B_im": _A_in["B_im"],
        "A_C_re": _A_in["C_re"],
        "A_C_im": _A_in["C_im"],
        "A_log_dt": _A_in["log_dt"],
        "A_Dskip": _A_in["Dskip"],
        "B_x": _B_in["x"],
        "B_W_gate": _B_in["W_gate"],
        "B_W_up": _B_in["W_up"],
        "B_W_down": _B_in["W_down"],
    }

def reference(A_u, A_A_re, A_A_im, A_B_re, A_B_im, A_C_re, A_C_im, A_log_dt, A_Dskip, B_x, B_W_gate, B_W_up, B_W_down):
    def _A_ref(u, A_re, A_im, B_re, B_im, C_re, C_im, log_dt, Dskip):
        Bsz, L, D = u.shape
        dt = torch.exp(log_dt)[:, None]
        A = A_re + 1j * A_im
        Bc = B_re + 1j * B_im
        Cc = C_re + 1j * C_im
        logdA = dt * A
        dB = dt * Bc
        l = (lambda x, dt: x.to(dt))(torch.arange(L), A_re.dtype)
        P = torch.exp(logdA[:, :, None] * l[None, None, :])
        K = torch.einsum("dn,dnl,dn->dl", Cc, P, dB).real
        L2 = 2 * L
        Kp = _pad(K, ((0, 0), (0, L)))
        up = (lambda x, *d: x.permute(*d))(u, 0, 2, 1)
        up = _pad(up, ((0, 0), (0, 0), (0, L)))
        Kf = (lambda x, axes=(-2,-1): torch.fft.rfft2(x.float(), dim=axes))(Kp[:, None, :], axes=(-2, -1))
        Uf = (lambda x, axes=(-2,-1): torch.fft.rfft2(x.float(), dim=axes))(up[:, :, None, :], axes=(-2, -1))
        Yf = Uf * Kf[None, :, :, :]
        y = (lambda x, s, axes=(-2,-1): torch.fft.irfft2(x, s=s, dim=axes).to(torch.bfloat16))(Yf, (1, L2), axes=(-2, -1))[:, :, 0, :L]
        y = (lambda x, *d: x.permute(*d))(y, 0, 2, 1) + u * Dskip[None, None, :]
        return y

    def _B_ref(x, W_gate, W_up, W_down):
        gate = torch.einsum("bsd,df->bsf", x, W_gate)
        up = torch.einsum("bsd,df->bsf", x, W_up)
        gate = gate * (lambda x, dt: x.to(dt))(gate > 0, gate.dtype)
        h = gate * up
        return torch.einsum("bsf,fd->bsd", h, W_down)

    x = A_u
    xn = _layernorm(x, axis=-1)
    return x + _A_ref(xn, A_A_re, A_A_im, A_B_re, A_B_im, A_C_re, A_C_im, A_log_dt, A_Dskip) + _B_ref(xn, B_W_gate, B_W_up, B_W_down)
```

```asm
; @launch grid=(256,1,1) block=(512,1,1) lds=163840
.amdgcn_target "amdgcn-amd-amdhsa--gfx950"
.text
.globl parallel_sum__ssm_conv_s4__glu_gated_reglu__prompt_kernel
.p2align 8
.type parallel_sum__ssm_conv_s4__glu_gated_reglu__prompt_kernel,@function
parallel_sum__ssm_conv_s4__glu_gated_reglu__prompt_kernel:
    s_cmp_ge_u32 s2, 256
    s_cbranch_scc1 L_exit
    s_load_dwordx16 s[64:79], s[0:1], 0
    s_load_dwordx16 s[80:95], s[0:1], 64
    s_memrealtime s[60:61]
    v_lshrrev_b32 v1, 6, v0
    v_and_b32 v0, 63, v0
    v_readfirstlane_b32 s3, v1
    s_and_b32 s44, s2, 7
    s_lshr_b32 s8, s2, 3
    s_lshr_b32 s46, s44, 1
    s_and_b32 s47, s44, 1
    s_mul_i32 s48, s46, 27
    s_add_u32 s48, s48, s8
    s_lshr_b32 s5, s48, 2
    s_and_b32 s48, s48, 3
    s_lshl_b32 s49, s47, 2
    s_add_u32 s4, s48, s49
    s_mul_i32 s48, s46, 28
    s_add_u32 s48, s48, s8
    s_mul_i32 s49, s48, 13108
    s_lshr_b32 s6, s49, 16
    s_mul_i32 s49, s6, 5
    s_sub_u32 s48, s48, s49
    s_mul_i32 s49, s47, 5
    s_add_u32 s7, s48, s49
    s_cmp_lt_u32 s8, 28
    s_cselect_b32 s58, 1, 0
    s_cmp_lt_u32 s6, 22
    s_cselect_b32 s58, s58, 0
    s_mul_i32 s48, s44, 80
    s_mul_i32 s49, s8, 3
    s_lshl_b32 s50, s8, 1
    s_add_u32 s50, s50, 16
    s_cmp_lt_u32 s8, 16
    s_cselect_b32 s49, s49, s50
    s_cselect_b32 s10, 3, 2
    s_add_u32 s9, s48, s49
    s_getpc_b64 s[44:45]
L_pc0_h:
    s_sub_u32 s44, s44, L_pc0_h-parallel_sum__ssm_conv_s4__glu_gated_reglu__prompt_kernel
    s_subb_u32 s45, s45, 0
    s_lshl_b32 s46, s8, 3
    s_add_u32 s46, s46, s3
    s_lshl_b32 s46, s46, 10
    v_lshl_add_u32 v1, v0, 4, s46
    v_min_u32 v1, L_end-parallel_sum__ssm_conv_s4__glu_gated_reglu__prompt_kernel-16, v1
    global_load_dwordx4 v[248:251], v1, s[44:45]
    s_cmp_ge_u32 s8, 27
    s_cbranch_scc1 L_spare
    s_cmp_lt_u32 s3, 4
    s_cbranch_scc1 L_mat
    s_sub_u32 s44, s3, 4
    v_lshrrev_b32 v8, 3, v0
    v_and_b32 v9, 7, v0
    v_bfe_u32 v10, v0, 4, 1
    v_lshlrev_b32 v10, 1, v10
    v_xor_b32 v10, v10, v9
    s_lshl_b32 s46, s44, 4
    v_add_u32 v11, s46, v8
    v_mul_u32_u24 v11, 3456, v11
    s_lshl_b32 s47, s5, 7
    v_add_u32 v11, s47, v11
    s_lshl_b32 s52, s44, 11
    v_lshl_add_u32 v2, v10, 4, v11
    v_xor_b32 v10, 4, v10
    v_lshl_add_u32 v3, v10, 4, v11
    v_add_u32 v3, 27648, v3
    s_lshl_b32 s46, s4, 8
    s_lshl_b32 s47, s44, 6
    s_add_u32 s46, s46, s47
    v_add_u32 v11, s46, v8
    v_mul_u32_u24 v11, 1280, v11
    v_lshrrev_b32 v10, 4, v0
    v_xor_b32 v10, v10, v9
    v_lshl_add_u32 v4, v10, 4, v11
    v_xor_b32 v5, 64, v4
    v_add_u32 v5, 10240, v5
    s_lshl_b32 s53, s44, 13
    s_add_u32 s53, s53, 49152
    s_waitcnt lgkmcnt(0)
    s_mov_b32 s16, s84
    s_mov_b32 s17, s85
    s_mov_b32 s18, 0x21c000
    s_mov_b32 s19, 0x20000
    s_mov_b32 s20, s86
    s_mov_b32 s21, s87
    s_mov_b32 s22, 0x21c000
    s_mov_b32 s23, 0x20000
    s_mov_b32 s12, s64
    s_mov_b32 s13, s65
    s_mov_b32 s14, 0x280000
    s_mov_b32 s15, 0x20000
    s_and_b32 s44, s3, 3
    s_lshl_b32 s44, s44, 5
    v_bfe_u32 v10, v0, 2, 1
    v_lshlrev_b32 v10, 4, v10
    v_lshrrev_b32 v11, 4, v0
    v_lshl_add_u32 v10, v11, 2, v10
    v_and_b32 v11, 3, v0
    v_add3_u32 v10, v10, v11, s44
    v_and_b32 v11, 15, v0
    v_cvt_f32_u32 v50, v11
    v_bfe_u32 v11, v0, 3, 1
    v_add_u32 v11, s9, v11
    v_lshrrev_b32 v14, 7, v11
    v_lshlrev_b32 v14, 7, v14
    v_and_b32 v15, 63, v11
    v_lshl_add_u32 v14, v15, 1, v14
    v_bfe_u32 v15, v11, 6, 1
    v_add_lshl_u32 v11, v14, v15, 1
    v_lshlrev_b32 v1, 7, v11
    v_lshl_add_u32 v10, v10, 1, v1
    global_load_ushort v108, v10, s[66:67]
    global_load_ushort v109, v10, s[68:69]
    global_load_ushort v110, v10, s[70:71]
    global_load_ushort v111, v10, s[72:73]
    global_load_ushort v112, v10, s[74:75]
    global_load_ushort v113, v10, s[76:77]
    global_load_ushort v114, v11, s[78:79]
    global_load_ushort v115, v11, s[80:81]
    s_add_u32 m0, s52, 0
    s_mov_b32 s45, 0
    buffer_load_dwordx4 v2, s[16:19], s45 offen lds
    s_add_u32 m0, s52, 8192
    s_mov_b32 s45, 0
    buffer_load_dwordx4 v2, s[20:23], s45 offen lds
    s_add_u32 m0, s52, 1024
    s_mov_b32 s45, 0
    buffer_load_dwordx4 v3, s[16:19], s45 offen lds
    s_add_u32 m0, s52, 9216
    s_mov_b32 s45, 0
    buffer_load_dwordx4 v3, s[20:23], s45 offen lds
    s_add_u32 m0, s53, 0
    s_mov_b32 s45, 0
    buffer_load_dwordx4 v4, s[12:15], s45 offen lds
    s_add_u32 m0, s53, 1024
    s_mov_b32 s45, 0
    buffer_load_dwordx4 v5, s[12:15], s45 offen lds
    s_add_u32 m0, s53, 2048
    s_mov_b32 s45, 20480
    buffer_load_dwordx4 v4, s[12:15], s45 offen lds
    s_add_u32 m0, s53, 3072
    s_mov_b32 s45, 20480
    buffer_load_dwordx4 v5, s[12:15], s45 offen lds
    s_add_u32 m0, s53, 4096
    s_mov_b32 s45, 40960
    buffer_load_dwordx4 v4, s[12:15], s45 offen lds
    s_add_u32 m0, s53, 5120
    s_mov_b32 s45, 40960
    buffer_load_dwordx4 v5, s[12:15], s45 offen lds
    s_add_u32 m0, s53, 6144
    s_mov_b32 s45, 61440
    buffer_load_dwordx4 v4, s[12:15], s45 offen lds
    s_add_u32 m0, s53, 7168
    s_mov_b32 s45, 61440
    buffer_load_dwordx4 v5, s[12:15], s45 offen lds
    s_mov_b32 s36, s92
    s_mov_b32 s37, s93
    s_mov_b32 s38, 0x100
    s_mov_b32 s39, 0x20000
    s_lshl_b32 s44, s2, 3
    s_add_u32 s44, s44, s3
    s_cmp_eq_u32 s44, 4
    s_cselect_b32 s45, 0, 0x1000
    s_or_b32 s60, s60, 1
    v_mov_b32 v252, s60
    v_mov_b32 v253, s45
    s_mov_b64 exec, 1
    buffer_store_dword v252, v253, s[36:39], 0 offen sc1
    s_mov_b64 exec, -1
    s_add_u32 m0, s52, 16384
    s_mov_b32 s45, 221184
    buffer_load_dwordx4 v2, s[16:19], s45 offen lds
    s_waitcnt vmcnt(14)
    v_lshlrev_b32 v114, 16, v114
    v_lshlrev_b32 v108, 16, v108
    v_lshlrev_b32 v109, 16, v109
    v_lshlrev_b32 v110, 16, v110
    v_lshlrev_b32 v111, 16, v111
    v_lshlrev_b32 v112, 16, v112
    v_lshlrev_b32 v113, 16, v113
    v_lshlrev_b32 v115, 16, v115
    v_mul_f32 v114, 0x3fb8aa3b, v114
    v_exp_f32 v114, v114
    s_add_u32 m0, s52, 24576
    s_mov_b32 s45, 221184
    buffer_load_dwordx4 v2, s[20:23], s45 offen lds
    v_readlane_b32 s97, v115, 0
    v_readlane_b32 s98, v115, 8
    v_cvt_pk_bf16_f32 v114, v114, v114
    v_lshlrev_b32 v114, 16, v114
    v_mul_f32 v108, v114, v108
    v_mul_f32 v109, v114, v109
    v_mul_f32 v110, v114, v110
    v_mul_f32 v111, v114, v111
    v_mul_f32 v40, 0x3fb8aa3b, v108
    v_mul_f32 v109, 0x3e22f983, v109
    s_add_u32 m0, s52, 17408
    s_mov_b32 s45, 221184
    buffer_load_dwordx4 v3, s[16:19], s45 offen lds
    v_rndne_f32 v116, v109
    v_sub_f32 v41, v109, v116
    v_mul_f32 v42, v112, v110
    v_mul_f32 v43, v112, v111
    v_fma_f32 v42, -v113, v111, v42
    v_fmac_f32 v43, v113, v110
    s_and_b32 s44, s3, 3
    s_cmp_eq_u32 s44, 0
    s_cselect_b32 s97, s97, 0
    s_cselect_b32 s98, s98, 0
    v_mul_f32 v117, 0x43800000, v41
    v_mul_f32 v116, 0x43800000, v40
    v_fract_f32 v117, v117
    s_add_u32 m0, s52, 25600
    s_mov_b32 s45, 221184
    buffer_load_dwordx4 v3, s[20:23], s45 offen lds
    v_exp_f32 v116, v116
    v_cos_f32 v118, v117
    v_sin_f32 v119, v117
    s_nop 0
    v_mul_f32 v118, v116, v118
    v_mul_f32 v119, v116, v119
    v_mul_f32 v44, v42, v118
    v_mul_f32 v45, v42, v119
    v_fma_f32 v44, -v43, v119, v44
    v_fmac_f32 v45, v43, v118
    s_add_u32 m0, s53, 32768
    s_mov_b32 s45, 128
    buffer_load_dwordx4 v4, s[12:15], s45 offen lds
    v_mul_f32 v117, 0x44000000, v41
    v_mul_f32 v116, 0x44000000, v40
    v_fract_f32 v117, v117
    v_exp_f32 v116, v116
    v_cos_f32 v118, v117
    v_sin_f32 v119, v117
    s_nop 0
    v_mul_f32 v118, v116, v118
    v_mul_f32 v119, v116, v119
    v_mul_f32 v46, v42, v118
    s_add_u32 m0, s53, 33792
    s_mov_b32 s45, 128
    buffer_load_dwordx4 v5, s[12:15], s45 offen lds
    v_mul_f32 v47, v42, v119
    v_fma_f32 v46, -v43, v119, v46
    v_fmac_f32 v47, v43, v118
    v_mul_f32 v117, 0x44c00000, v41
    v_mul_f32 v116, 0x44c00000, v40
    v_fract_f32 v117, v117
    v_exp_f32 v116, v116
    v_cos_f32 v118, v117
    v_sin_f32 v119, v117
    s_nop 0
    s_add_u32 m0, s53, 34816
    s_mov_b32 s45, 20608
    buffer_load_dwordx4 v4, s[12:15], s45 offen lds
    v_mul_f32 v118, v116, v118
    v_mul_f32 v119, v116, v119
    v_mul_f32 v48, v42, v118
    v_mul_f32 v49, v42, v119
    v_fma_f32 v48, -v43, v119, v48
    v_fmac_f32 v49, v43, v118
    v_mul_f32_dpp v121, v40, v50 row_newbcast:0 row_mask:0xf bank_mask:0xf
    v_mul_f32_dpp v127, v40, v50 row_newbcast:1 row_mask:0xf bank_mask:0xf
    v_mul_f32_dpp v120, v41, v50 row_newbcast:0 row_mask:0xf bank_mask:0xf
    v_mul_f32_dpp v126, v41, v50 row_newbcast:1 row_mask:0xf bank_mask:0xf
    s_add_u32 m0, s53, 35840
    s_mov_b32 s45, 20608
    buffer_load_dwordx4 v5, s[12:15], s45 offen lds
    v_exp_f32 v121, v121
    v_exp_f32 v127, v127
    v_cos_f32 v122, v120
    v_cos_f32 v128, v126
    v_sin_f32 v123, v120
    v_sin_f32 v129, v126
    v_mul_f32 v122, v121, v122
    v_mul_f32 v128, v127, v128
    v_mul_f32 v123, v121, v123
    v_mul_f32 v129, v127, v129
    s_add_u32 m0, s53, 36864
    s_mov_b32 s45, 41088
    buffer_load_dwordx4 v4, s[12:15], s45 offen lds
    v_cvt_pk_bf16_f32 v52, v122, v123
    v_cvt_pk_bf16_f32 v53, v128, v129
    v_pk_mul_f32 v[124:125], v[122:123], v[122:123] op_sel:[1,1] op_sel_hi:[0,1]
    v_pk_mul_f32 v[130:131], v[128:129], v[128:129] op_sel:[1,1] op_sel_hi:[0,1]
    v_pk_fma_f32 v[122:123], v[122:123], v[122:123], v[124:125] op_sel:[0,0,0] op_sel_hi:[0,1,1] neg_lo:[0,0,1]
    v_pk_fma_f32 v[128:129], v[128:129], v[128:129], v[130:131] op_sel:[0,0,0] op_sel_hi:[0,1,1] neg_lo:[0,0,1]
    v_pk_mul_f32 v[124:125], v[122:123], v[122:123] op_sel:[1,1] op_sel_hi:[0,1]
    v_pk_mul_f32 v[130:131], v[128:129], v[128:129] op_sel:[1,1] op_sel_hi:[0,1]
    v_pk_fma_f32 v[122:123], v[122:123], v[122:123], v[124:125] op_sel:[0,0,0] op_sel_hi:[0,1,1] neg_lo:[0,0,1]
    v_pk_fma_f32 v[128:129], v[128:129], v[128:129], v[130:131] op_sel:[0,0,0] op_sel_hi:[0,1,1] neg_lo:[0,0,1]
    s_add_u32 m0, s53, 37888
    s_mov_b32 s45, 41088
    buffer_load_dwordx4 v5, s[12:15], s45 offen lds
    v_cvt_pk_bf16_f32 v56, v122, v123
    v_cvt_pk_bf16_f32 v57, v128, v129
    v_pk_mul_f32 v[124:125], v[122:123], v[122:123] op_sel:[1,1] op_sel_hi:[0,1]
    v_pk_mul_f32 v[130:131], v[128:129], v[128:129] op_sel:[1,1] op_sel_hi:[0,1]
    v_pk_fma_f32 v[122:123], v[122:123], v[122:123], v[124:125] op_sel:[0,0,0] op_sel_hi:[0,1,1] neg_lo:[0,0,1]
    v_pk_fma_f32 v[128:129], v[128:129], v[128:129], v[130:131] op_sel:[0,0,0] op_sel_hi:[0,1,1] neg_lo:[0,0,1]
    v_pk_mul_f32 v[124:125], v[122:123], v[122:123] op_sel:[1,1] op_sel_hi:[0,1]
    v_pk_mul_f32 v[130:131], v[128:129], v[128:129] op_sel:[1,1] op_sel_hi:[0,1]
    v_pk_fma_f32 v[122:123], v[122:123], v[122:123], v[124:125] op_sel:[0,0,0] op_sel_hi:[0,1,1] neg_lo:[0,0,1]
    v_pk_fma_f32 v[128:129], v[128:129], v[128:129], v[130:131] op_sel:[0,0,0] op_sel_hi:[0,1,1] neg_lo:[0,0,1]
    s_add_u32 m0, s53, 38912
    s_mov_b32 s45, 61568
    buffer_load_dwordx4 v4, s[12:15], s45 offen lds
    v_mul_f32_dpp v124, v42, v122 row_newbcast:0 row_mask:0xf bank_mask:0xf
    v_mul_f32_dpp v130, v42, v128 row_newbcast:1 row_mask:0xf bank_mask:0xf
    v_mul_f32_dpp v125, -v42, v123 row_newbcast:0 row_mask:0xf bank_mask:0xf
    v_mul_f32_dpp v131, -v42, v129 row_newbcast:1 row_mask:0xf bank_mask:0xf
    v_fmac_f32_dpp v124, -v43, v123 row_newbcast:0 row_mask:0xf bank_mask:0xf
    v_fmac_f32_dpp v130, -v43, v129 row_newbcast:1 row_mask:0xf bank_mask:0xf
    v_fmac_f32_dpp v125, -v43, v122 row_newbcast:0 row_mask:0xf bank_mask:0xf
    v_fmac_f32_dpp v131, -v43, v128 row_newbcast:1 row_mask:0xf bank_mask:0xf
    v_cvt_pk_bf16_f32 v60, v124, v125
    v_cvt_pk_bf16_f32 v61, v130, v131
    s_add_u32 m0, s53, 39936
    s_mov_b32 s45, 61568
    buffer_load_dwordx4 v5, s[12:15], s45 offen lds
    v_mul_f32_dpp v124, v44, v122 row_newbcast:0 row_mask:0xf bank_mask:0xf
    v_mul_f32_dpp v130, v44, v128 row_newbcast:1 row_mask:0xf bank_mask:0xf
    v_mul_f32_dpp v125, -v44, v123 row_newbcast:0 row_mask:0xf bank_mask:0xf
    v_mul_f32_dpp v131, -v44, v129 row_newbcast:1 row_mask:0xf bank_mask:0xf
    v_fmac_f32_dpp v124, -v45, v123 row_newbcast:0 row_mask:0xf bank_mask:0xf
    v_fmac_f32_dpp v130, -v45, v129 row_newbcast:1 row_mask:0xf bank_mask:0xf
    v_fmac_f32_dpp v125, -v45, v122 row_newbcast:0 row_mask:0xf bank_mask:0xf
    v_fmac_f32_dpp v131, -v45, v128 row_newbcast:1 row_mask:0xf bank_mask:0xf
    v_cvt_pk_bf16_f32 v64, v124, v125
    v_cvt_pk_bf16_f32 v65, v130, v131
    s_mov_b32 s28, s94
    s_mov_b32 s29, s95
    s_mov_b32 s30, 0x10000000
    s_mov_b32 s31, 0x20000
    s_mov_b32 s24, s88
    s_mov_b32 s25, s89
    s_mov_b32 s26, 0x21c000
    s_mov_b32 s27, 0x20000
    s_mul_i32 s26, s26, s58
    s_mov_b32 s32, s90
    s_mov_b32 s33, s91
    s_mov_b32 s34, 0x280000
    s_mov_b32 s35, 0x20000
    v_lshlrev_b32 v252, 2, v0
    v_add_u32 v252, 162304, v252
    v_mov_b32 v253, 0
    s_mov_b64 exec, 0xff
    ds_write_b32 v252, v253
    s_mov_b64 exec, -1
    s_and_b32 s44, s3, 3
    s_and_b32 s45, s44, 1
    s_lshl_b32 s45, s45, 1
    v_bfe_u32 v10, v0, 4, 1
    v_or_b32 v10, s45, v10
    v_lshlrev_b32 v10, 1, v10
    v_and_b32 v11, 7, v0
    v_xor_b32 v10, v10, v11
    v_lshrrev_b32 v11, 3, v0
    s_lshl_b32 s45, s44, 3
    v_add_u32 v11, s45, v11
    v_mul_u32_u24 v11, 1280, v11
    v_lshl_add_u32 v11, v10, 4, v11
    s_lshl_b32 s45, s7, 7
    v_add_u32 v6, s45, v11
    s_and_b32 s44, s3, 3
    s_mul_i32 s45, s44, 192
    s_lshl_b32 s100, s9, 4
    s_add_u32 s100, s100, 0x100000
    s_mov_b32 s48, 1431655766
    v_add_u32 v10, s45, v0
    v_add_u32 v10, 0, v10
    v_mul_hi_u32 v11, v10, s48
    v_mul_u32_u24 v1, 3, v11
    v_sub_u32 v10, v10, v1
    v_mul_u32_u24 v11, 10240, v11
    v_lshl_add_u32 v36, v10, 4, v11
    v_add_u32 v10, s45, v0
    v_add_u32 v10, 64, v10
    v_mul_hi_u32 v11, v10, s48
    v_mul_u32_u24 v1, 3, v11
    v_sub_u32 v10, v10, v1
    v_mul_u32_u24 v11, 10240, v11
    v_lshl_add_u32 v37, v10, 4, v11
    v_add_u32 v10, s45, v0
    v_add_u32 v10, 128, v10
    v_mul_hi_u32 v11, v10, s48
    v_mul_u32_u24 v1, 3, v11
    v_sub_u32 v10, v10, v1
    v_mul_u32_u24 v11, 10240, v11
    v_lshl_add_u32 v38, v10, 4, v11
    v_lshlrev_b32 v7, 4, v0
    s_lshl_b32 s44, s4, 11
    s_add_u32 s44, s44, 0x10000
    s_sub_u32 s45, s3, 4
    s_lshl_b32 s45, s45, 9
    s_add_u32 s96, s44, s45
    v_lshrrev_b32 v10, 4, v0
    v_mul_u32_u24 v10, 6912, v10
    v_and_b32 v11, 15, v0
    v_lshl_add_u32 v39, v11, 4, v10
    s_lshl_b32 s46, s5, 8
    s_add_u32 s99, s46, 0x20000
    s_add_u32 s57, s45, 159744
    s_waitcnt vmcnt(13) lgkmcnt(0)
    s_barrier
    s_add_u32 m0, s52, 32768
    s_mov_b32 s45, 442368
    buffer_load_dwordx4 v2, s[16:19], s45 offen lds
    v_pk_mul_f32 v[124:125], v[122:123], v[122:123] op_sel:[1,1] op_sel_hi:[0,1]
    v_pk_mul_f32 v[130:131], v[128:129], v[128:129] op_sel:[1,1] op_sel_hi:[0,1]
    v_pk_fma_f32 v[122:123], v[122:123], v[122:123], v[124:125] op_sel:[0,0,0] op_sel_hi:[0,1,1] neg_lo:[0,0,1]
    v_pk_fma_f32 v[128:129], v[128:129], v[128:129], v[130:131] op_sel:[0,0,0] op_sel_hi:[0,1,1] neg_lo:[0,0,1]
    v_pk_mul_f32 v[124:125], v[122:123], v[122:123] op_sel:[1,1] op_sel_hi:[0,1]
    v_pk_mul_f32 v[130:131], v[128:129], v[128:129] op_sel:[1,1] op_sel_hi:[0,1]
    v_pk_fma_f32 v[122:123], v[122:123], v[122:123], v[124:125] op_sel:[0,0,0] op_sel_hi:[0,1,1] neg_lo:[0,0,1]
    v_pk_fma_f32 v[128:129], v[128:129], v[128:129], v[130:131] op_sel:[0,0,0] op_sel_hi:[0,1,1] neg_lo:[0,0,1]
    s_add_u32 m0, s52, 40960
    s_mov_b32 s45, 442368
    buffer_load_dwordx4 v2, s[20:23], s45 offen lds
    v_mul_f32_dpp v124, v46, v122 row_newbcast:0 row_mask:0xf bank_mask:0xf
    v_mul_f32_dpp v130, v46, v128 row_newbcast:1 row_mask:0xf bank_mask:0xf
    v_mul_f32_dpp v125, -v46, v123 row_newbcast:0 row_mask:0xf bank_mask:0xf
    v_mul_f32_dpp v131, -v46, v129 row_newbcast:1 row_mask:0xf bank_mask:0xf
    v_fmac_f32_dpp v124, -v47, v123 row_newbcast:0 row_mask:0xf bank_mask:0xf
    v_fmac_f32_dpp v130, -v47, v129 row_newbcast:1 row_mask:0xf bank_mask:0xf
    v_fmac_f32_dpp v125, -v47, v122 row_newbcast:0 row_mask:0xf bank_mask:0xf
    v_fmac_f32_dpp v131, -v47, v128 row_newbcast:1 row_mask:0xf bank_mask:0xf
    s_add_u32 m0, s52, 33792
    s_mov_b32 s45, 442368
    buffer_load_dwordx4 v3, s[16:19], s45 offen lds
    v_cvt_pk_bf16_f32 v68, v124, v125
    v_cvt_pk_bf16_f32 v69, v130, v131
    v_mul_f32_dpp v124, v48, v122 row_newbcast:0 row_mask:0xf bank_mask:0xf
    v_mul_f32_dpp v130, v48, v128 row_newbcast:1 row_mask:0xf bank_mask:0xf
    v_mul_f32_dpp v125, -v48, v123 row_newbcast:0 row_mask:0xf bank_mask:0xf
    v_mul_f32_dpp v131, -v48, v129 row_newbcast:1 row_mask:0xf bank_mask:0xf
    v_fmac_f32_dpp v124, -v49, v123 row_newbcast:0 row_mask:0xf bank_mask:0xf
    v_fmac_f32_dpp v130, -v49, v129 row_newbcast:1 row_mask:0xf bank_mask:0xf
    s_add_u32 m0, s52, 41984
    s_mov_b32 s45, 442368
    buffer_load_dwordx4 v3, s[20:23], s45 offen lds
    v_fmac_f32_dpp v125, -v49, v122 row_newbcast:0 row_mask:0xf bank_mask:0xf
    v_fmac_f32_dpp v131, -v49, v128 row_newbcast:1 row_mask:0xf bank_mask:0xf
    v_cvt_pk_bf16_f32 v72, v124, v125
    v_cvt_pk_bf16_f32 v73, v130, v131
    v_mul_f32_dpp v121, v40, v50 row_newbcast:2 row_mask:0xf bank_mask:0xf
    v_mul_f32_dpp v127, v40, v50 row_newbcast:3 row_mask:0xf bank_mask:0xf
    v_mul_f32_dpp v120, v41, v50 row_newbcast:2 row_mask:0xf bank_mask:0xf
    v_mul_f32_dpp v126, v41, v50 row_newbcast:3 row_mask:0xf bank_mask:0xf
    s_add_u32 m0, s53, 65536
    s_mov_b32 s45, 256
    buffer_load_dwordx4 v4, s[12:15], s45 offen lds
    v_exp_f32 v121, v121
    v_exp_f32 v127, v127
    v_cos_f32 v122, v120
    v_cos_f32 v128, v126
    v_sin_f32 v123, v120
    v_sin_f32 v129, v126
    v_mul_f32 v122, v121, v122
    v_mul_f32 v128, v127, v128
    s_add_u32 m0, s53, 66560
    s_mov_b32 s45, 256
    buffer_load_dwordx4 v5, s[12:15], s45 offen lds
    v_mul_f32 v123, v121, v123
    v_mul_f32 v129, v127, v129
    v_cvt_pk_bf16_f32 v54, v122, v123
    v_cvt_pk_bf16_f32 v55, v128, v129
    v_mul_f32 v120, v123, v123
    v_mul_f32 v126, v129, v129
    v_mul_f32_e64 v123, v122, v123 mul:2
    v_mul_f32_e64 v129, v128, v129 mul:2
    s_add_u32 m0, s53, 67584
    s_mov_b32 s45, 20736
    buffer_load_dwordx4 v4, s[12:15], s45 offen lds
    v_fma_f32 v122, v122, v122, -v120
    v_fma_f32 v128, v128, v128, -v126
    v_mul_f32 v120, v123, v123
    v_mul_f32 v126, v129, v129
    v_mul_f32_e64 v123, v122, v123 mul:2
    v_mul_f32_e64 v129, v128, v129 mul:2
    v_fma_f32 v122, v122, v122, -v120
    v_fma_f32 v128, v128, v128, -v126
    s_add_u32 m0, s53, 68608
    s_mov_b32 s45, 20736
    buffer_load_dwordx4 v5, s[12:15], s45 offen lds
    v_cvt_pk_bf16_f32 v58, v122, v123
    v_cvt_pk_bf16_f32 v59, v128, v129
    v_mul_f32 v120, v123, v123
    v_mul_f32 v126, v129, v129
    v_mul_f32_e64 v123, v122, v123 mul:2
    v_mul_f32_e64 v129, v128, v129 mul:2
    v_fma_f32 v122, v122, v122, -v120
    v_fma_f32 v128, v128, v128, -v126
    s_add_u32 m0, s53, 69632
    s_mov_b32 s45, 41216
    buffer_load_dwordx4 v4, s[12:15], s45 offen lds
    v_mul_f32 v120, v123, v123
    v_mul_f32 v126, v129, v129
    v_mul_f32_e64 v123, v122, v123 mul:2
    v_mul_f32_e64 v129, v128, v129 mul:2
    v_fma_f32 v122, v122, v122, -v120
    v_fma_f32 v128, v128, v128, -v126
    v_mul_f32_dpp v124, v42, v122 row_newbcast:2 row_mask:0xf bank_mask:0xf
    v_mul_f32_dpp v130, v42, v128 row_newbcast:3 row_mask:0xf bank_mask:0xf
    s_add_u32 m0, s53, 70656
    s_mov_b32 s45, 41216
    buffer_load_dwordx4 v5, s[12:15], s45 offen lds
    v_mul_f32_dpp v125, -v42, v123 row_newbcast:2 row_mask:0xf bank_mask:0xf
    v_mul_f32_dpp v131, -v42, v129 row_newbcast:3 row_mask:0xf bank_mask:0xf
    v_fmac_f32_dpp v124, -v43, v123 row_newbcast:2 row_mask:0xf bank_mask:0xf
    v_fmac_f32_dpp v130, -v43, v129 row_newbcast:3 row_mask:0xf bank_mask:0xf
    v_fmac_f32_dpp v125, -v43, v122 row_newbcast:2 row_mask:0xf bank_mask:0xf
    v_fmac_f32_dpp v131, -v43, v128 row_newbcast:3 row_mask:0xf bank_mask:0xf
    v_cvt_pk_bf16_f32 v62, v124, v125
    v_cvt_pk_bf16_f32 v63, v130, v131
    s_add_u32 m0, s53, 71680
    s_mov_b32 s45, 61696
    buffer_load_dwordx4 v4, s[12:15], s45 offen lds
    v_mul_f32_dpp v124, v44, v122 row_newbcast:2 row_mask:0xf bank_mask:0xf
    v_mul_f32_dpp v130, v44, v128 row_newbcast:3 row_mask:0xf bank_mask:0xf
    v_mul_f32_dpp v125, -v44, v123 row_newbcast:2 row_mask:0xf bank_mask:0xf
    v_mul_f32_dpp v131, -v44, v129 row_newbcast:3 row_mask:0xf bank_mask:0xf
    v_fmac_f32_dpp v124, -v45, v123 row_newbcast:2 row_mask:0xf bank_mask:0xf
    v_fmac_f32_dpp v130, -v45, v129 row_newbcast:3 row_mask:0xf bank_mask:0xf
    v_fmac_f32_dpp v125, -v45, v122 row_newbcast:2 row_mask:0xf bank_mask:0xf
    v_fmac_f32_dpp v131, -v45, v128 row_newbcast:3 row_mask:0xf bank_mask:0xf
    s_add_u32 m0, s53, 72704
    s_mov_b32 s45, 61696
    buffer_load_dwordx4 v5, s[12:15], s45 offen lds
    v_cvt_pk_bf16_f32 v66, v124, v125
    v_cvt_pk_bf16_f32 v67, v130, v131
    v_mul_f32 v120, v123, v123
    v_mul_f32 v126, v129, v129
    v_mul_f32_e64 v123, v122, v123 mul:2
    v_mul_f32_e64 v129, v128, v129 mul:2
    v_fma_f32 v122, v122, v122, -v120
    v_fma_f32 v128, v128, v128, -v126
    s_waitcnt vmcnt(12)
    s_barrier
    s_add_u32 m0, s52, 0
    s_mov_b32 s45, 663552
    buffer_load_dwordx4 v2, s[16:19], s45 offen lds
    v_mul_f32 v120, v123, v123
    v_mul_f32 v126, v129, v129
    v_mul_f32_e64 v123, v122, v123 mul:2
    v_mul_f32_e64 v129, v128, v129 mul:2
    v_fma_f32 v122, v122, v122, -v120
    s_add_u32 m0, s52, 8192
    s_mov_b32 s45, 663552
    buffer_load_dwordx4 v2, s[20:23], s45 offen lds
    v_fma_f32 v128, v128, v128, -v126
    v_mul_f32_dpp v124, v46, v122 row_newbcast:2 row_mask:0xf bank_mask:0xf
    v_mul_f32_dpp v130, v46, v128 row_newbcast:3 row_mask:0xf bank_mask:0xf
    v_mul_f32_dpp v125, -v46, v123 row_newbcast:2 row_mask:0xf bank_mask:0xf
    v_mul_f32_dpp v131, -v46, v129 row_newbcast:3 row_mask:0xf bank_mask:0xf
    s_add_u32 m0, s52, 1024
    s_mov_b32 s45, 663552
    buffer_load_dwordx4 v3, s[16:19], s45 offen lds
    v_fmac_f32_dpp v124, -v47, v123 row_newbcast:2 row_mask:0xf bank_mask:0xf
    v_fmac_f32_dpp v130, -v47, v129 row_newbcast:3 row_mask:0xf bank_mask:0xf
    v_fmac_f32_dpp v125, -v47, v122 row_newbcast:2 row_mask:0xf bank_mask:0xf
    v_fmac_f32_dpp v131, -v47, v128 row_newbcast:3 row_mask:0xf bank_mask:0xf
    v_cvt_pk_bf16_f32 v70, v124, v125
    s_add_u32 m0, s52, 9216
    s_mov_b32 s45, 663552
    buffer_load_dwordx4 v3, s[20:23], s45 offen lds
    v_cvt_pk_bf16_f32 v71, v130, v131
    v_mul_f32_dpp v124, v48, v122 row_newbcast:2 row_mask:0xf bank_mask:0xf
    v_mul_f32_dpp v130, v48, v128 row_newbcast:3 row_mask:0xf bank_mask:0xf
    v_mul_f32_dpp v125, -v48, v123 row_newbcast:2 row_mask:0xf bank_mask:0xf
    v_mul_f32_dpp v131, -v48, v129 row_newbcast:3 row_mask:0xf bank_mask:0xf
    s_add_u32 m0, s53, 0
    s_mov_b32 s45, 384
    buffer_load_dwordx4 v4, s[12:15], s45 offen lds
    v_fmac_f32_dpp v124, -v49, v123 row_newbcast:2 row_mask:0xf bank_mask:0xf
    v_fmac_f32_dpp v130, -v49, v129 row_newbcast:3 row_mask:0xf bank_mask:0xf
    v_fmac_f32_dpp v125, -v49, v122 row_newbcast:2 row_mask:0xf bank_mask:0xf
    v_fmac_f32_dpp v131, -v49, v128 row_newbcast:3 row_mask:0xf bank_mask:0xf
    v_cvt_pk_bf16_f32 v74, v124, v125
    s_add_u32 m0, s53, 1024
    s_mov_b32 s45, 384
    buffer_load_dwordx4 v5, s[12:15], s45 offen lds
    v_cvt_pk_bf16_f32 v75, v130, v131
    s_setprio 3
    s_nop 0
    v_mfma_f32_16x16x32_bf16 v[76:79], v[52:55], v[60:63], 0
    v_mfma_f32_16x16x32_bf16 v[84:87], v[52:55], v[64:67], 0
    v_mfma_f32_16x16x32_bf16 v[80:83], v[56:59], v[68:71], 0
    s_add_u32 m0, s53, 2048
    s_mov_b32 s45, 20864
    buffer_load_dwordx4 v4, s[12:15], s45 offen lds
    v_mfma_f32_16x16x32_bf16 v[88:91], v[56:59], v[72:75], 0
    s_setprio 0
    v_mul_f32_dpp v121, v40, v50 row_newbcast:4 row_mask:0xf bank_mask:0xf
    v_mul_f32_dpp v127, v40, v50 row_newbcast:5 row_mask:0xf bank_mask:0xf
    v_mul_f32_dpp v120, v41, v50 row_newbcast:4 row_mask:0xf bank_mask:0xf
    v_mul_f32_dpp v126, v41, v50 row_newbcast:5 row_mask:0xf bank_mask:0xf
    s_add_u32 m0, s53, 3072
    s_mov_b32 s45, 20864
    buffer_load_dwordx4 v5, s[12:15], s45 offen lds
    v_exp_f32 v121, v121
    v_exp_f32 v127, v127
    v_cos_f32 v122, v120
    v_cos_f32 v128, v126
    v_sin_f32 v123, v120
    s_add_u32 m0, s53, 4096
    s_mov_b32 s45, 41344
    buffer_load_dwordx4 v4, s[12:15], s45 offen lds
    v_sin_f32 v129, v126
    v_mul_f32 v122, v121, v122
    v_mul_f32 v128, v127, v128
    v_mul_f32 v123, v121, v123
    v_mul_f32 v129, v127, v129
    s_add_u32 m0, s53, 5120
    s_mov_b32 s45, 41344
    buffer_load_dwordx4 v5, s[12:15], s45 offen lds
    v_cvt_pk_bf16_f32 v52, v122, v123
    v_cvt_pk_bf16_f32 v53, v128, v129
    v_mul_f32 v120, v123, v123
    v_mul_f32 v126, v129, v129
    v_mul_f32_e64 v123, v122, v123 mul:2
    s_add_u32 m0, s53, 6144
    s_mov_b32 s45, 61824
    buffer_load_dwordx4 v4, s[12:15], s45 offen lds
    v_mul_f32_e64 v129, v128, v129 mul:2
    v_fma_f32 v122, v122, v122, -v120
    v_fma_f32 v128, v128, v128, -v126
    v_mul_f32 v120, v123, v123
    v_mul_f32 v126, v129, v129
    s_add_u32 m0, s53, 7168
    s_mov_b32 s45, 61824
    buffer_load_dwordx4 v5, s[12:15], s45 offen lds
    v_mul_f32_e64 v123, v122, v123 mul:2
    v_mul_f32_e64 v129, v128, v129 mul:2
    v_fma_f32 v122, v122, v122, -v120
    v_fma_f32 v128, v128, v128, -v126
    v_cvt_pk_bf16_f32 v56, v122, v123
    v_cvt_pk_bf16_f32 v57, v128, v129
    v_mul_f32 v120, v123, v123
    v_mul_f32 v126, v129, v129
    v_mul_f32_e64 v123, v122, v123 mul:2
    v_mul_f32_e64 v129, v128, v129 mul:2
    v_fma_f32 v122, v122, v122, -v120
    v_fma_f32 v128, v128, v128, -v126
    v_mul_f32 v120, v123, v123
    v_mul_f32 v126, v129, v129
    v_mul_f32_e64 v123, v122, v123 mul:2
    s_waitcnt vmcnt(12)
    s_barrier
    v_mov_b32 v8, 0
    buffer_load_dword v8, v8, s[36:39], 0 offen sc1
    s_add_u32 m0, s52, 16384
    s_mov_b32 s45, 884736
    buffer_load_dwordx4 v2, s[16:19], s45 offen lds
    v_mul_f32_e64 v129, v128, v129 mul:2
    v_fma_f32 v122, v122, v122, -v120
    v_fma_f32 v128, v128, v128, -v126
    v_mul_f32_dpp v124, v42, v122 row_newbcast:4 row_mask:0xf bank_mask:0xf
    v_mul_f32_dpp v130, v42, v128 row_newbcast:5 row_mask:0xf bank_mask:0xf
    s_add_u32 m0, s52, 24576
    s_mov_b32 s45, 884736
    buffer_load_dwordx4 v2, s[20:23], s45 offen lds
    v_mul_f32_dpp v125, -v42, v123 row_newbcast:4 row_mask:0xf bank_mask:0xf
    v_mul_f32_dpp v131, -v42, v129 row_newbcast:5 row_mask:0xf bank_mask:0xf
    v_fmac_f32_dpp v124, -v43, v123 row_newbcast:4 row_mask:0xf bank_mask:0xf
    v_fmac_f32_dpp v130, -v43, v129 row_newbcast:5 row_mask:0xf bank_mask:0xf
    v_fmac_f32_dpp v125, -v43, v122 row_newbcast:4 row_mask:0xf bank_mask:0xf
    s_add_u32 m0, s52, 17408
    s_mov_b32 s45, 884736
    buffer_load_dwordx4 v3, s[16:19], s45 offen lds
    v_fmac_f32_dpp v131, -v43, v128 row_newbcast:5 row_mask:0xf bank_mask:0xf
    v_cvt_pk_bf16_f32 v60, v124, v125
    v_cvt_pk_bf16_f32 v61, v130, v131
    v_mul_f32_dpp v124, v44, v122 row_newbcast:4 row_mask:0xf bank_mask:0xf
    v_mul_f32_dpp v130, v44, v128 row_newbcast:5 row_mask:0xf bank_mask:0xf
    s_add_u32 m0, s52, 25600
    s_mov_b32 s45, 884736
    buffer_load_dwordx4 v3, s[20:23], s45 offen lds
    v_mul_f32_dpp v125, -v44, v123 row_newbcast:4 row_mask:0xf bank_mask:0xf
    v_mul_f32_dpp v131, -v44, v129 row_newbcast:5 row_mask:0xf bank_mask:0xf
    v_fmac_f32_dpp v124, -v45, v123 row_newbcast:4 row_mask:0xf bank_mask:0xf
    v_fmac_f32_dpp v130, -v45, v129 row_newbcast:5 row_mask:0xf bank_mask:0xf
    v_fmac_f32_dpp v125, -v45, v122 row_newbcast:4 row_mask:0xf bank_mask:0xf
    s_add_u32 m0, s53, 32768
    s_mov_b32 s45, 512
    buffer_load_dwordx4 v4, s[12:15], s45 offen lds
    v_fmac_f32_dpp v131, -v45, v128 row_newbcast:5 row_mask:0xf bank_mask:0xf
    v_cvt_pk_bf16_f32 v64, v124, v125
    v_cvt_pk_bf16_f32 v65, v130, v131
    v_mul_f32 v120, v123, v123
    v_mul_f32 v126, v129, v129
    s_add_u32 m0, s53, 33792
    s_mov_b32 s45, 512
    buffer_load_dwordx4 v5, s[12:15], s45 offen lds
    v_mul_f32_e64 v123, v122, v123 mul:2
    v_mul_f32_e64 v129, v128, v129 mul:2
    v_fma_f32 v122, v122, v122, -v120
    v_fma_f32 v128, v128, v128, -v126
    v_mul_f32 v120, v123, v123
    s_add_u32 m0, s53, 34816
    s_mov_b32 s45, 20992
    buffer_load_dwordx4 v4, s[12:15], s45 offen lds
    v_mul_f32 v126, v129, v129
    v_mul_f32_e64 v123, v122, v123 mul:2
    v_mul_f32_e64 v129, v128, v129 mul:2
    v_fma_f32 v122, v122, v122, -v120
    v_fma_f32 v128, v128, v128, -v126
    s_add_u32 m0, s53, 35840
    s_mov_b32 s45, 20992
    buffer_load_dwordx4 v5, s[12:15], s45 offen lds
    v_mul_f32_dpp v124, v46, v122 row_newbcast:4 row_mask:0xf bank_mask:0xf
    v_mul_f32_dpp v130, v46, v128 row_newbcast:5 row_mask:0xf bank_mask:0xf
    v_mul_f32_dpp v125, -v46, v123 row_newbcast:4 row_mask:0xf bank_mask:0xf
    v_mul_f32_dpp v131, -v46, v129 row_newbcast:5 row_mask:0xf bank_mask:0xf
    v_fmac_f32_dpp v124, -v47, v123 row_newbcast:4 row_mask:0xf bank_mask:0xf
    s_add_u32 m0, s53, 36864
    s_mov_b32 s45, 41472
    buffer_load_dwordx4 v4, s[12:15], s45 offen lds
    v_fmac_f32_dpp v130, -v47, v129 row_newbcast:5 row_mask:0xf bank_mask:0xf
    v_fmac_f32_dpp v125, -v47, v122 row_newbcast:4 row_mask:0xf bank_mask:0xf
    v_fmac_f32_dpp v131, -v47, v128 row_newbcast:5 row_mask:0xf bank_mask:0xf
    v_cvt_pk_bf16_f32 v68, v124, v125
    v_cvt_pk_bf16_f32 v69, v130, v131
    s_add_u32 m0, s53, 37888
    s_mov_b32 s45, 41472
    buffer_load_dwordx4 v5, s[12:15], s45 offen lds
    v_mul_f32_dpp v124, v48, v122 row_newbcast:4 row_mask:0xf bank_mask:0xf
    v_mul_f32_dpp v130, v48, v128 row_newbcast:5 row_mask:0xf bank_mask:0xf
    v_mul_f32_dpp v125, -v48, v123 row_newbcast:4 row_mask:0xf bank_mask:0xf
    v_mul_f32_dpp v131, -v48, v129 row_newbcast:5 row_mask:0xf bank_mask:0xf
    v_fmac_f32_dpp v124, -v49, v123 row_newbcast:4 row_mask:0xf bank_mask:0xf
    s_add_u32 m0, s53, 38912
    s_mov_b32 s45, 61952
    buffer_load_dwordx4 v4, s[12:15], s45 offen lds
    v_fmac_f32_dpp v130, -v49, v129 row_newbcast:5 row_mask:0xf bank_mask:0xf
    v_fmac_f32_dpp v125, -v49, v122 row_newbcast:4 row_mask:0xf bank_mask:0xf
    v_fmac_f32_dpp v131, -v49, v128 row_newbcast:5 row_mask:0xf bank_mask:0xf
    v_cvt_pk_bf16_f32 v72, v124, v125
    v_cvt_pk_bf16_f32 v73, v130, v131
    s_add_u32 m0, s53, 39936
    s_mov_b32 s45, 61952
    buffer_load_dwordx4 v5, s[12:15], s45 offen lds
    v_mul_f32_dpp v121, v40, v50 row_newbcast:6 row_mask:0xf bank_mask:0xf
    v_mul_f32_dpp v127, v40, v50 row_newbcast:7 row_mask:0xf bank_mask:0xf
    v_mul_f32_dpp v120, v41, v50 row_newbcast:6 row_mask:0xf bank_mask:0xf
    v_mul_f32_dpp v126, v41, v50 row_newbcast:7 row_mask:0xf bank_mask:0xf
    v_exp_f32 v121, v121
    v_exp_f32 v127, v127
    v_cos_f32 v122, v120
    v_cos_f32 v128, v126
    v_sin_f32 v123, v120
    v_sin_f32 v129, v126
    v_mul_f32 v122, v121, v122
    v_mul_f32 v128, v127, v128
    v_mul_f32 v123, v121, v123
    v_mul_f32 v129, v127, v129
    v_cvt_pk_bf16_f32 v54, v122, v123
    s_waitcnt vmcnt(13)
    s_barrier
    s_add_u32 m0, s52, 32768
    s_mov_b32 s45, 1105920
    buffer_load_dwordx4 v2, s[16:19], s45 offen lds
    v_cvt_pk_bf16_f32 v55, v128, v129
    v_mul_f32 v120, v123, v123
    v_mul_f32 v126, v129, v129
    v_mul_f32_e64 v123, v122, v123 mul:2
    v_mul_f32_e64 v129, v128, v129 mul:2
    s_add_u32 m0, s52, 40960
    s_mov_b32 s45, 1105920
    buffer_load_dwordx4 v2, s[20:23], s45 offen lds
    v_fma_f32 v122, v122, v122, -v120
    v_fma_f32 v128, v128, v128, -v126
    v_mul_f32 v120, v123, v123
    v_mul_f32 v126, v129, v129
    v_mul_f32_e64 v123, v122, v123 mul:2
    s_add_u32 m0, s52, 33792
    s_mov_b32 s45, 1105920
    buffer_load_dwordx4 v3, s[16:19], s45 offen lds
    v_mul_f32_e64 v129, v128, v129 mul:2
    v_fma_f32 v122, v122, v122, -v120
    v_fma_f32 v128, v128, v128, -v126
    v_cvt_pk_bf16_f32 v58, v122, v123
    v_cvt_pk_bf16_f32 v59, v128, v129
    s_add_u32 m0, s52, 41984
    s_mov_b32 s45, 1105920
    buffer_load_dwordx4 v3, s[20:23], s45 offen lds
    v_mul_f32 v120, v123, v123
    v_mul_f32 v126, v129, v129
    v_mul_f32_e64 v123, v122, v123 mul:2
    v_mul_f32_e64 v129, v128, v129 mul:2
    v_fma_f32 v122, v122, v122, -v120
    s_add_u32 m0, s53, 65536
    s_mov_b32 s45, 640
    buffer_load_dwordx4 v4, s[12:15], s45 offen lds
    v_fma_f32 v128, v128, v128, -v126
    v_mul_f32 v120, v123, v123
    v_mul_f32 v126, v129, v129
    v_mul_f32_e64 v123, v122, v123 mul:2
    v_mul_f32_e64 v129, v128, v129 mul:2
    s_add_u32 m0, s53, 66560
    s_mov_b32 s45, 640
    buffer_load_dwordx4 v5, s[12:15], s45 offen lds
    v_fma_f32 v122, v122, v122, -v120
    v_fma_f32 v128, v128, v128, -v126
    v_mul_f32_dpp v124, v42, v122 row_newbcast:6 row_mask:0xf bank_mask:0xf
    v_mul_f32_dpp v130, v42, v128 row_newbcast:7 row_mask:0xf bank_mask:0xf
    v_mul_f32_dpp v125, -v42, v123 row_newbcast:6 row_mask:0xf bank_mask:0xf
    s_add_u32 m0, s53, 67584
    s_mov_b32 s45, 21120
    buffer_load_dwordx4 v4, s[12:15], s45 offen lds
    v_mul_f32_dpp v131, -v42, v129 row_newbcast:7 row_mask:0xf bank_mask:0xf
    v_fmac_f32_dpp v124, -v43, v123 row_newbcast:6 row_mask:0xf bank_mask:0xf
    v_fmac_f32_dpp v130, -v43, v129 row_newbcast:7 row_mask:0xf bank_mask:0xf
    v_fmac_f32_dpp v125, -v43, v122 row_newbcast:6 row_mask:0xf bank_mask:0xf
    v_fmac_f32_dpp v131, -v43, v128 row_newbcast:7 row_mask:0xf bank_mask:0xf
    s_add_u32 m0, s53, 68608
    s_mov_b32 s45, 21120
    buffer_load_dwordx4 v5, s[12:15], s45 offen lds
    v_cvt_pk_bf16_f32 v62, v124, v125
    v_cvt_pk_bf16_f32 v63, v130, v131
    v_mul_f32_dpp v124, v44, v122 row_newbcast:6 row_mask:0xf bank_mask:0xf
    v_mul_f32_dpp v130, v44, v128 row_newbcast:7 row_mask:0xf bank_mask:0xf
    v_mul_f32_dpp v125, -v44, v123 row_newbcast:6 row_mask:0xf bank_mask:0xf
    s_add_u32 m0, s53, 69632
    s_mov_b32 s45, 41600
    buffer_load_dwordx4 v4, s[12:15], s45 offen lds
    v_mul_f32_dpp v131, -v44, v129 row_newbcast:7 row_mask:0xf bank_mask:0xf
    v_fmac_f32_dpp v124, -v45, v123 row_newbcast:6 row_mask:0xf bank_mask:0xf
    v_fmac_f32_dpp v130, -v45, v129 row_newbcast:7 row_mask:0xf bank_mask:0xf
    v_fmac_f32_dpp v125, -v45, v122 row_newbcast:6 row_mask:0xf bank_mask:0xf
    v_fmac_f32_dpp v131, -v45, v128 row_newbcast:7 row_mask:0xf bank_mask:0xf
    s_add_u32 m0, s53, 70656
    s_mov_b32 s45, 41600
    buffer_load_dwordx4 v5, s[12:15], s45 offen lds
    v_cvt_pk_bf16_f32 v66, v124, v125
    v_cvt_pk_bf16_f32 v67, v130, v131
    v_mul_f32 v120, v123, v123
    v_mul_f32 v126, v129, v129
    v_mul_f32_e64 v123, v122, v123 mul:2
    s_add_u32 m0, s53, 71680
    s_mov_b32 s45, 62080
    buffer_load_dwordx4 v4, s[12:15], s45 offen lds
    v_mul_f32_e64 v129, v128, v129 mul:2
    v_fma_f32 v122, v122, v122, -v120
    v_fma_f32 v128, v128, v128, -v126
    v_mul_f32 v120, v123, v123
    v_mul_f32 v126, v129, v129
    s_add_u32 m0, s53, 72704
    s_mov_b32 s45, 62080
    buffer_load_dwordx4 v5, s[12:15], s45 offen lds
    v_mul_f32_e64 v123, v122, v123 mul:2
    v_mul_f32_e64 v129, v128, v129 mul:2
    v_fma_f32 v122, v122, v122, -v120
    v_fma_f32 v128, v128, v128, -v126
    v_mul_f32_dpp v124, v46, v122 row_newbcast:6 row_mask:0xf bank_mask:0xf
    v_mul_f32_dpp v130, v46, v128 row_newbcast:7 row_mask:0xf bank_mask:0xf
    v_mul_f32_dpp v125, -v46, v123 row_newbcast:6 row_mask:0xf bank_mask:0xf
    v_mul_f32_dpp v131, -v46, v129 row_newbcast:7 row_mask:0xf bank_mask:0xf
    v_fmac_f32_dpp v124, -v47, v123 row_newbcast:6 row_mask:0xf bank_mask:0xf
    v_fmac_f32_dpp v130, -v47, v129 row_newbcast:7 row_mask:0xf bank_mask:0xf
    v_fmac_f32_dpp v125, -v47, v122 row_newbcast:6 row_mask:0xf bank_mask:0xf
    v_fmac_f32_dpp v131, -v47, v128 row_newbcast:7 row_mask:0xf bank_mask:0xf
    v_cvt_pk_bf16_f32 v70, v124, v125
    v_cvt_pk_bf16_f32 v71, v130, v131
    v_mul_f32_dpp v124, v48, v122 row_newbcast:6 row_mask:0xf bank_mask:0xf
    s_waitcnt vmcnt(12)
    s_barrier
    v_readfirstlane_b32 s11, v8
    s_cmp_eq_u32 s11, 0
    s_cbranch_scc1 L_slow_x_1
L_back_x_1:
    s_add_u32 m0, s52, 0
    s_mov_b32 s45, 1327104
    buffer_load_dwordx4 v2, s[16:19], s45 offen lds
    v_mul_f32_dpp v130, v48, v128 row_newbcast:7 row_mask:0xf bank_mask:0xf
    v_mul_f32_dpp v125, -v48, v123 row_newbcast:6 row_mask:0xf bank_mask:0xf
    v_mul_f32_dpp v131, -v48, v129 row_newbcast:7 row_mask:0xf bank_mask:0xf
    v_fmac_f32_dpp v124, -v49, v123 row_newbcast:6 row_mask:0xf bank_mask:0xf
    v_fmac_f32_dpp v130, -v49, v129 row_newbcast:7 row_mask:0xf bank_mask:0xf
    s_add_u32 m0, s52, 8192
    s_mov_b32 s45, 1327104
    buffer_load_dwordx4 v2, s[20:23], s45 offen lds
    v_fmac_f32_dpp v125, -v49, v122 row_newbcast:6 row_mask:0xf bank_mask:0xf
    v_fmac_f32_dpp v131, -v49, v128 row_newbcast:7 row_mask:0xf bank_mask:0xf
    v_cvt_pk_bf16_f32 v74, v124, v125
    v_cvt_pk_bf16_f32 v75, v130, v131
    s_setprio 3
    s_nop 0
    s_add_u32 m0, s52, 1024
    s_mov_b32 s45, 1327104
    buffer_load_dwordx4 v3, s[16:19], s45 offen lds
    v_mfma_f32_16x16x32_bf16 v[76:79], v[52:55], v[60:63], v[76:79]
    v_mfma_f32_16x16x32_bf16 v[84:87], v[52:55], v[64:67], v[84:87]
    v_mfma_f32_16x16x32_bf16 v[80:83], v[56:59], v[68:71], v[80:83]
    v_mfma_f32_16x16x32_bf16 v[88:91], v[56:59], v[72:75], v[88:91]
    s_setprio 0
    v_mul_f32_dpp v121, v40, v50 row_newbcast:8 row_mask:0xf bank_mask:0xf
    s_add_u32 m0, s52, 9216
    s_mov_b32 s45, 1327104
    buffer_load_dwordx4 v3, s[20:23], s45 offen lds
    v_mul_f32_dpp v127, v40, v50 row_newbcast:9 row_mask:0xf bank_mask:0xf
    v_mul_f32_dpp v120, v41, v50 row_newbcast:8 row_mask:0xf bank_mask:0xf
    v_mul_f32_dpp v126, v41, v50 row_newbcast:9 row_mask:0xf bank_mask:0xf
    v_exp_f32 v121, v121
    v_exp_f32 v127, v127
    s_add_u32 m0, s53, 0
    s_mov_b32 s45, 768
    buffer_load_dwordx4 v4, s[12:15], s45 offen lds
    v_cos_f32 v122, v120
    v_cos_f32 v128, v126
    v_sin_f32 v123, v120
    v_sin_f32 v129, v126
    v_mul_f32 v122, v121, v122
    s_add_u32 m0, s53, 1024
    s_mov_b32 s45, 768
    buffer_load_dwordx4 v5, s[12:15], s45 offen lds
    v_mul_f32 v128, v127, v128
    v_mul_f32 v123, v121, v123
    v_mul_f32 v129, v127, v129
    v_cvt_pk_bf16_f32 v52, v122, v123
    v_cvt_pk_bf16_f32 v53, v128, v129
    s_add_u32 m0, s53, 2048
    s_mov_b32 s45, 21248
    buffer_load_dwordx4 v4, s[12:15], s45 offen lds
    v_mul_f32 v120, v123, v123
    v_mul_f32 v126, v129, v129
    v_mul_f32_e64 v123, v122, v123 mul:2
    v_mul_f32_e64 v129, v128, v129 mul:2
    v_fma_f32 v122, v122, v122, -v120
    s_add_u32 m0, s53, 3072
    s_mov_b32 s45, 21248
    buffer_load_dwordx4 v5, s[12:15], s45 offen lds
    v_fma_f32 v128, v128, v128, -v126
    v_mul_f32 v120, v123, v123
    v_mul_f32 v126, v129, v129
    v_mul_f32_e64 v123, v122, v123 mul:2
    v_mul_f32_e64 v129, v128, v129 mul:2
    s_add_u32 m0, s53, 4096
    s_mov_b32 s45, 41728
    buffer_load_dwordx4 v4, s[12:15], s45 offen lds
    v_fma_f32 v122, v122, v122, -v120
    v_fma_f32 v128, v128, v128, -v126
    v_cvt_pk_bf16_f32 v56, v122, v123
    v_cvt_pk_bf16_f32 v57, v128, v129
    v_mul_f32 v120, v123, v123
    s_add_u32 m0, s53, 5120
    s_mov_b32 s45, 41728
    buffer_load_dwordx4 v5, s[12:15], s45 offen lds
    v_mul_f32 v126, v129, v129
    v_mul_f32_e64 v123, v122, v123 mul:2
    v_mul_f32_e64 v129, v128, v129 mul:2
    v_fma_f32 v122, v122, v122, -v120
    v_fma_f32 v128, v128, v128, -v126
    s_add_u32 m0, s53, 6144
    s_mov_b32 s45, 62208
    buffer_load_dwordx4 v4, s[12:15], s45 offen lds
    v_mul_f32 v120, v123, v123
    v_mul_f32 v126, v129, v129
    v_mul_f32_e64 v123, v122, v123 mul:2
    v_mul_f32_e64 v129, v128, v129 mul:2
    v_fma_f32 v122, v122, v122, -v120
    s_add_u32 m0, s53, 7168
    s_mov_b32 s45, 62208
    buffer_load_dwordx4 v5, s[12:15], s45 offen lds
    v_fma_f32 v128, v128, v128, -v126
    v_mul_f32_dpp v124, v42, v122 row_newbcast:8 row_mask:0xf bank_mask:0xf
    v_mul_f32_dpp v130, v42, v128 row_newbcast:9 row_mask:0xf bank_mask:0xf
    v_mul_f32_dpp v125, -v42, v123 row_newbcast:8 row_mask:0xf bank_mask:0xf
    v_mul_f32_dpp v131, -v42, v129 row_newbcast:9 row_mask:0xf bank_mask:0xf
    v_fmac_f32_dpp v124, -v43, v123 row_newbcast:8 row_mask:0xf bank_mask:0xf
    v_fmac_f32_dpp v130, -v43, v129 row_newbcast:9 row_mask:0xf bank_mask:0xf
    v_fmac_f32_dpp v125, -v43, v122 row_newbcast:8 row_mask:0xf bank_mask:0xf
    v_fmac_f32_dpp v131, -v43, v128 row_newbcast:9 row_mask:0xf bank_mask:0xf
    v_cvt_pk_bf16_f32 v60, v124, v125
    v_cvt_pk_bf16_f32 v61, v130, v131
    v_mul_f32_dpp v124, v44, v122 row_newbcast:8 row_mask:0xf bank_mask:0xf
    v_mul_f32_dpp v130, v44, v128 row_newbcast:9 row_mask:0xf bank_mask:0xf
    v_mul_f32_dpp v125, -v44, v123 row_newbcast:8 row_mask:0xf bank_mask:0xf
    v_mul_f32_dpp v131, -v44, v129 row_newbcast:9 row_mask:0xf bank_mask:0xf
    s_waitcnt vmcnt(12)
    s_barrier
    s_add_u32 m0, s52, 16384
    s_mov_b32 s45, 1548288
    buffer_load_dwordx4 v2, s[16:19], s45 offen lds
    v_fmac_f32_dpp v124, -v45, v123 row_newbcast:8 row_mask:0xf bank_mask:0xf
    v_fmac_f32_dpp v130, -v45, v129 row_newbcast:9 row_mask:0xf bank_mask:0xf
    v_fmac_f32_dpp v125, -v45, v122 row_newbcast:8 row_mask:0xf bank_mask:0xf
    v_fmac_f32_dpp v131, -v45, v128 row_newbcast:9 row_mask:0xf bank_mask:0xf
    v_cvt_pk_bf16_f32 v64, v124, v125
    s_add_u32 m0, s52, 24576
    s_mov_b32 s45, 1548288
    buffer_load_dwordx4 v2, s[20:23], s45 offen lds
    v_cvt_pk_bf16_f32 v65, v130, v131
    v_mul_f32 v120, v123, v123
    v_mul_f32 v126, v129, v129
    v_mul_f32_e64 v123, v122, v123 mul:2
    v_mul_f32_e64 v129, v128, v129 mul:2
    s_add_u32 m0, s52, 17408
    s_mov_b32 s45, 1548288
    buffer_load_dwordx4 v3, s[16:19], s45 offen lds
    v_fma_f32 v122, v122, v122, -v120
    v_fma_f32 v128, v128, v128, -v126
    v_mul_f32 v120, v123, v123
    v_mul_f32 v126, v129, v129
    v_mul_f32_e64 v123, v122, v123 mul:2
    s_add_u32 m0, s52, 25600
    s_mov_b32 s45, 1548288
    buffer_load_dwordx4 v3, s[20:23], s45 offen lds
    v_mul_f32_e64 v129, v128, v129 mul:2
    v_fma_f32 v122, v122, v122, -v120
    v_fma_f32 v128, v128, v128, -v126
    v_mul_f32_dpp v124, v46, v122 row_newbcast:8 row_mask:0xf bank_mask:0xf
    v_mul_f32_dpp v130, v46, v128 row_newbcast:9 row_mask:0xf bank_mask:0xf
    s_add_u32 m0, s53, 32768
    s_mov_b32 s45, 896
    buffer_load_dwordx4 v4, s[12:15], s45 offen lds
    v_mul_f32_dpp v125, -v46, v123 row_newbcast:8 row_mask:0xf bank_mask:0xf
    v_mul_f32_dpp v131, -v46, v129 row_newbcast:9 row_mask:0xf bank_mask:0xf
    v_fmac_f32_dpp v124, -v47, v123 row_newbcast:8 row_mask:0xf bank_mask:0xf
    v_fmac_f32_dpp v130, -v47, v129 row_newbcast:9 row_mask:0xf bank_mask:0xf
    v_fmac_f32_dpp v125, -v47, v122 row_newbcast:8 row_mask:0xf bank_mask:0xf
    s_add_u32 m0, s53, 33792
    s_mov_b32 s45, 896
    buffer_load_dwordx4 v5, s[12:15], s45 offen lds
    v_fmac_f32_dpp v131, -v47, v128 row_newbcast:9 row_mask:0xf bank_mask:0xf
    v_cvt_pk_bf16_f32 v68, v124, v125
    v_cvt_pk_bf16_f32 v69, v130, v131
    v_mul_f32_dpp v124, v48, v122 row_newbcast:8 row_mask:0xf bank_mask:0xf
    v_mul_f32_dpp v130, v48, v128 row_newbcast:9 row_mask:0xf bank_mask:0xf
    s_add_u32 m0, s53, 34816
    s_mov_b32 s45, 21376
    buffer_load_dwordx4 v4, s[12:15], s45 offen lds
    v_mul_f32_dpp v125, -v48, v123 row_newbcast:8 row_mask:0xf bank_mask:0xf
    v_mul_f32_dpp v131, -v48, v129 row_newbcast:9 row_mask:0xf bank_mask:0xf
    v_fmac_f32_dpp v124, -v49, v123 row_newbcast:8 row_mask:0xf bank_mask:0xf
    v_fmac_f32_dpp v130, -v49, v129 row_newbcast:9 row_mask:0xf bank_mask:0xf
    v_fmac_f32_dpp v125, -v49, v122 row_newbcast:8 row_mask:0xf bank_mask:0xf
    s_add_u32 m0, s53, 35840
    s_mov_b32 s45, 21376
    buffer_load_dwordx4 v5, s[12:15], s45 offen lds
    v_fmac_f32_dpp v131, -v49, v128 row_newbcast:9 row_mask:0xf bank_mask:0xf
    v_cvt_pk_bf16_f32 v72, v124, v125
    v_cvt_pk_bf16_f32 v73, v130, v131
    v_mul_f32_dpp v121, v40, v50 row_newbcast:10 row_mask:0xf bank_mask:0xf
    v_mul_f32_dpp v127, v40, v50 row_newbcast:11 row_mask:0xf bank_mask:0xf
    s_add_u32 m0, s53, 36864
    s_mov_b32 s45, 41856
    buffer_load_dwordx4 v4, s[12:15], s45 offen lds
    v_mul_f32_dpp v120, v41, v50 row_newbcast:10 row_mask:0xf bank_mask:0xf
    v_mul_f32_dpp v126, v41, v50 row_newbcast:11 row_mask:0xf bank_mask:0xf
    v_exp_f32 v121, v121
    v_exp_f32 v127, v127
    v_cos_f32 v122, v120
    s_add_u32 m0, s53, 37888
    s_mov_b32 s45, 41856
    buffer_load_dwordx4 v5, s[12:15], s45 offen lds
    v_cos_f32 v128, v126
    v_sin_f32 v123, v120
    v_sin_f32 v129, v126
    v_mul_f32 v122, v121, v122
    v_mul_f32 v128, v127, v128
    s_add_u32 m0, s53, 38912
    s_mov_b32 s45, 62336
    buffer_load_dwordx4 v4, s[12:15], s45 offen lds
    v_mul_f32 v123, v121, v123
    v_mul_f32 v129, v127, v129
    v_cvt_pk_bf16_f32 v54, v122, v123
    v_cvt_pk_bf16_f32 v55, v128, v129
    v_mul_f32 v120, v123, v123
    s_add_u32 m0, s53, 39936
    s_mov_b32 s45, 62336
    buffer_load_dwordx4 v5, s[12:15], s45 offen lds
    v_mul_f32 v126, v129, v129
    v_mul_f32_e64 v123, v122, v123 mul:2
    v_mul_f32_e64 v129, v128, v129 mul:2
    v_fma_f32 v122, v122, v122, -v120
    v_fma_f32 v128, v128, v128, -v126
    v_mul_f32 v120, v123, v123
    v_mul_f32 v126, v129, v129
    v_mul_f32_e64 v123, v122, v123 mul:2
    v_mul_f32_e64 v129, v128, v129 mul:2
    v_fma_f32 v122, v122, v122, -v120
    v_fma_f32 v128, v128, v128, -v126
    v_cvt_pk_bf16_f32 v58, v122, v123
    v_cvt_pk_bf16_f32 v59, v128, v129
    v_mul_f32 v120, v123, v123
    v_mul_f32 v126, v129, v129
    s_waitcnt vmcnt(12)
    s_barrier
    s_add_u32 m0, s52, 32768
    s_mov_b32 s45, 1769472
    buffer_load_dwordx4 v2, s[16:19], s45 offen lds
    v_mul_f32_e64 v123, v122, v123 mul:2
    v_mul_f32_e64 v129, v128, v129 mul:2
    v_fma_f32 v122, v122, v122, -v120
    v_fma_f32 v128, v128, v128, -v126
    v_mul_f32 v120, v123, v123
    s_add_u32 m0, s52, 40960
    s_mov_b32 s45, 1769472
    buffer_load_dwordx4 v2, s[20:23], s45 offen lds
    v_mul_f32 v126, v129, v129
    v_mul_f32_e64 v123, v122, v123 mul:2
    v_mul_f32_e64 v129, v128, v129 mul:2
    v_fma_f32 v122, v122, v122, -v120
    v_fma_f32 v128, v128, v128, -v126
    s_add_u32 m0, s52, 33792
    s_mov_b32 s45, 1769472
    buffer_load_dwordx4 v3, s[16:19], s45 offen lds
    v_mul_f32_dpp v124, v42, v122 row_newbcast:10 row_mask:0xf bank_mask:0xf
    v_mul_f32_dpp v130, v42, v128 row_newbcast:11 row_mask:0xf bank_mask:0xf
    v_mul_f32_dpp v125, -v42, v123 row_newbcast:10 row_mask:0xf bank_mask:0xf
    v_mul_f32_dpp v131, -v42, v129 row_newbcast:11 row_mask:0xf bank_mask:0xf
    v_fmac_f32_dpp v124, -v43, v123 row_newbcast:10 row_mask:0xf bank_mask:0xf
    s_add_u32 m0, s52, 41984
    s_mov_b32 s45, 1769472
    buffer_load_dwordx4 v3, s[20:23], s45 offen lds
    v_fmac_f32_dpp v130, -v43, v129 row_newbcast:11 row_mask:0xf bank_mask:0xf
    v_fmac_f32_dpp v125, -v43, v122 row_newbcast:10 row_mask:0xf bank_mask:0xf
    v_fmac_f32_dpp v131, -v43, v128 row_newbcast:11 row_mask:0xf bank_mask:0xf
    v_cvt_pk_bf16_f32 v62, v124, v125
    v_cvt_pk_bf16_f32 v63, v130, v131
    s_add_u32 m0, s53, 65536
    s_mov_b32 s45, 1024
    buffer_load_dwordx4 v4, s[12:15], s45 offen lds
    v_mul_f32_dpp v124, v44, v122 row_newbcast:10 row_mask:0xf bank_mask:0xf
    v_mul_f32_dpp v130, v44, v128 row_newbcast:11 row_mask:0xf bank_mask:0xf
    v_mul_f32_dpp v125, -v44, v123 row_newbcast:10 row_mask:0xf bank_mask:0xf
    v_mul_f32_dpp v131, -v44, v129 row_newbcast:11 row_mask:0xf bank_mask:0xf
    v_fmac_f32_dpp v124, -v45, v123 row_newbcast:10 row_mask:0xf bank_mask:0xf
    s_add_u32 m0, s53, 66560
    s_mov_b32 s45, 1024
    buffer_load_dwordx4 v5, s[12:15], s45 offen lds
    v_fmac_f32_dpp v130, -v45, v129 row_newbcast:11 row_mask:0xf bank_mask:0xf
    v_fmac_f32_dpp v125, -v45, v122 row_newbcast:10 row_mask:0xf bank_mask:0xf
    v_fmac_f32_dpp v131, -v45, v128 row_newbcast:11 row_mask:0xf bank_mask:0xf
    v_cvt_pk_bf16_f32 v66, v124, v125
    v_cvt_pk_bf16_f32 v67, v130, v131
    s_add_u32 m0, s53, 67584
    s_mov_b32 s45, 21504
    buffer_load_dwordx4 v4, s[12:15], s45 offen lds
    v_mul_f32 v120, v123, v123
    v_mul_f32 v126, v129, v129
    v_mul_f32_e64 v123, v122, v123 mul:2
    v_mul_f32_e64 v129, v128, v129 mul:2
    v_fma_f32 v122, v122, v122, -v120
    s_add_u32 m0, s53, 68608
    s_mov_b32 s45, 21504
    buffer_load_dwordx4 v5, s[12:15], s45 offen lds
    v_fma_f32 v128, v128, v128, -v126
    v_mul_f32 v120, v123, v123
    v_mul_f32 v126, v129, v129
    v_mul_f32_e64 v123, v122, v123 mul:2
    v_mul_f32_e64 v129, v128, v129 mul:2
    s_add_u32 m0, s53, 69632
    s_mov_b32 s45, 41984
    buffer_load_dwordx4 v4, s[12:15], s45 offen lds
    v_fma_f32 v122, v122, v122, -v120
    v_fma_f32 v128, v128, v128, -v126
    v_mul_f32_dpp v124, v46, v122 row_newbcast:10 row_mask:0xf bank_mask:0xf
    v_mul_f32_dpp v130, v46, v128 row_newbcast:11 row_mask:0xf bank_mask:0xf
    v_mul_f32_dpp v125, -v46, v123 row_newbcast:10 row_mask:0xf bank_mask:0xf
    s_add_u32 m0, s53, 70656
    s_mov_b32 s45, 41984
    buffer_load_dwordx4 v5, s[12:15], s45 offen lds
    v_mul_f32_dpp v131, -v46, v129 row_newbcast:11 row_mask:0xf bank_mask:0xf
    v_fmac_f32_dpp v124, -v47, v123 row_newbcast:10 row_mask:0xf bank_mask:0xf
    v_fmac_f32_dpp v130, -v47, v129 row_newbcast:11 row_mask:0xf bank_mask:0xf
    v_fmac_f32_dpp v125, -v47, v122 row_newbcast:10 row_mask:0xf bank_mask:0xf
    v_fmac_f32_dpp v131, -v47, v128 row_newbcast:11 row_mask:0xf bank_mask:0xf
    s_add_u32 m0, s53, 71680
    s_mov_b32 s45, 62464
    buffer_load_dwordx4 v4, s[12:15], s45 offen lds
    v_cvt_pk_bf16_f32 v70, v124, v125
    v_cvt_pk_bf16_f32 v71, v130, v131
    v_mul_f32_dpp v124, v48, v122 row_newbcast:10 row_mask:0xf bank_mask:0xf
    v_mul_f32_dpp v130, v48, v128 row_newbcast:11 row_mask:0xf bank_mask:0xf
    v_mul_f32_dpp v125, -v48, v123 row_newbcast:10 row_mask:0xf bank_mask:0xf
    s_add_u32 m0, s53, 72704
    s_mov_b32 s45, 62464
    buffer_load_dwordx4 v5, s[12:15], s45 offen lds
    v_mul_f32_dpp v131, -v48, v129 row_newbcast:11 row_mask:0xf bank_mask:0xf
    v_fmac_f32_dpp v124, -v49, v123 row_newbcast:10 row_mask:0xf bank_mask:0xf
    v_fmac_f32_dpp v130, -v49, v129 row_newbcast:11 row_mask:0xf bank_mask:0xf
    v_fmac_f32_dpp v125, -v49, v122 row_newbcast:10 row_mask:0xf bank_mask:0xf
    v_fmac_f32_dpp v131, -v49, v128 row_newbcast:11 row_mask:0xf bank_mask:0xf
    v_cvt_pk_bf16_f32 v74, v124, v125
    v_cvt_pk_bf16_f32 v75, v130, v131
    s_setprio 3
    s_nop 0
    v_mfma_f32_16x16x32_bf16 v[92:95], v[52:55], v[60:63], 0
    v_mfma_f32_16x16x32_bf16 v[100:103], v[52:55], v[64:67], 0
    v_mfma_f32_16x16x32_bf16 v[96:99], v[56:59], v[68:71], 0
    v_mfma_f32_16x16x32_bf16 v[104:107], v[56:59], v[72:75], 0
    s_setprio 0
    v_mul_f32_dpp v121, v40, v50 row_newbcast:12 row_mask:0xf bank_mask:0xf
    v_mul_f32_dpp v127, v40, v50 row_newbcast:13 row_mask:0xf bank_mask:0xf
    v_mul_f32_dpp v120, v41, v50 row_newbcast:12 row_mask:0xf bank_mask:0xf
    s_waitcnt vmcnt(12)
    s_barrier
    s_add_u32 m0, s52, 0
    s_mov_b32 s45, 1990656
    buffer_load_dwordx4 v2, s[16:19], s45 offen lds
    v_mul_f32_dpp v126, v41, v50 row_newbcast:13 row_mask:0xf bank_mask:0xf
    v_exp_f32 v121, v121
    v_exp_f32 v127, v127
    v_cos_f32 v122, v120
    v_cos_f32 v128, v126
    s_add_u32 m0, s52, 8192
    s_mov_b32 s45, 1990656
    buffer_load_dwordx4 v2, s[20:23], s45 offen lds
    v_sin_f32 v123, v120
    v_sin_f32 v129, v126
    v_mul_f32 v122, v121, v122
    v_mul_f32 v128, v127, v128
    v_mul_f32 v123, v121, v123
    s_add_u32 m0, s52, 1024
    s_mov_b32 s45, 1990656
    buffer_load_dwordx4 v3, s[16:19], s45 offen lds
    v_mul_f32 v129, v127, v129
    v_cvt_pk_bf16_f32 v52, v122, v123
    v_cvt_pk_bf16_f32 v53, v128, v129
    v_mul_f32 v120, v123, v123
    v_mul_f32 v126, v129, v129
    s_add_u32 m0, s52, 9216
    s_mov_b32 s45, 1990656
    buffer_load_dwordx4 v3, s[20:23], s45 offen lds
    v_mul_f32_e64 v123, v122, v123 mul:2
    v_mul_f32_e64 v129, v128, v129 mul:2
    v_fma_f32 v122, v122, v122, -v120
    v_fma_f32 v128, v128, v128, -v126
    v_mul_f32 v120, v123, v123
    s_add_u32 m0, s53, 0
    s_mov_b32 s45, 1152
    buffer_load_dwordx4 v4, s[12:15], s45 offen lds
    v_mul_f32 v126, v129, v129
    v_mul_f32_e64 v123, v122, v123 mul:2
    v_mul_f32_e64 v129, v128, v129 mul:2
    v_fma_f32 v122, v122, v122, -v120
    v_fma_f32 v128, v128, v128, -v126
    s_add_u32 m0, s53, 1024
    s_mov_b32 s45, 1152
    buffer_load_dwordx4 v5, s[12:15], s45 offen lds
    v_cvt_pk_bf16_f32 v56, v122, v123
    v_cvt_pk_bf16_f32 v57, v128, v129
    v_mul_f32 v120, v123, v123
    v_mul_f32 v126, v129, v129
    v_mul_f32_e64 v123, v122, v123 mul:2
    s_add_u32 m0, s53, 2048
    s_mov_b32 s45, 21632
    buffer_load_dwordx4 v4, s[12:15], s45 offen lds
    v_mul_f32_e64 v129, v128, v129 mul:2
    v_fma_f32 v122, v122, v122, -v120
    v_fma_f32 v128, v128, v128, -v126
    v_mul_f32 v120, v123, v123
    v_mul_f32 v126, v129, v129
    s_add_u32 m0, s53, 3072
    s_mov_b32 s45, 21632
    buffer_load_dwordx4 v5, s[12:15], s45 offen lds
    v_mul_f32_e64 v123, v122, v123 mul:2
    v_mul_f32_e64 v129, v128, v129 mul:2
    v_fma_f32 v122, v122, v122, -v120
    v_fma_f32 v128, v128, v128, -v126
    v_mul_f32_dpp v124, v42, v122 row_newbcast:12 row_mask:0xf bank_mask:0xf
    s_add_u32 m0, s53, 4096
    s_mov_b32 s45, 42112
    buffer_load_dwordx4 v4, s[12:15], s45 offen lds
    v_mul_f32_dpp v130, v42, v128 row_newbcast:13 row_mask:0xf bank_mask:0xf
    v_mul_f32_dpp v125, -v42, v123 row_newbcast:12 row_mask:0xf bank_mask:0xf
    v_mul_f32_dpp v131, -v42, v129 row_newbcast:13 row_mask:0xf bank_mask:0xf
    v_fmac_f32_dpp v124, -v43, v123 row_newbcast:12 row_mask:0xf bank_mask:0xf
    v_fmac_f32_dpp v130, -v43, v129 row_newbcast:13 row_mask:0xf bank_mask:0xf
    s_add_u32 m0, s53, 5120
    s_mov_b32 s45, 42112
    buffer_load_dwordx4 v5, s[12:15], s45 offen lds
    v_fmac_f32_dpp v125, -v43, v122 row_newbcast:12 row_mask:0xf bank_mask:0xf
    v_fmac_f32_dpp v131, -v43, v128 row_newbcast:13 row_mask:0xf bank_mask:0xf
    v_cvt_pk_bf16_f32 v60, v124, v125
    v_cvt_pk_bf16_f32 v61, v130, v131
    v_mul_f32_dpp v124, v44, v122 row_newbcast:12 row_mask:0xf bank_mask:0xf
    s_add_u32 m0, s53, 6144
    s_mov_b32 s45, 62592
    buffer_load_dwordx4 v4, s[12:15], s45 offen lds
    v_mul_f32_dpp v130, v44, v128 row_newbcast:13 row_mask:0xf bank_mask:0xf
    v_mul_f32_dpp v125, -v44, v123 row_newbcast:12 row_mask:0xf bank_mask:0xf
    v_mul_f32_dpp v131, -v44, v129 row_newbcast:13 row_mask:0xf bank_mask:0xf
    v_fmac_f32_dpp v124, -v45, v123 row_newbcast:12 row_mask:0xf bank_mask:0xf
    v_fmac_f32_dpp v130, -v45, v129 row_newbcast:13 row_mask:0xf bank_mask:0xf
    s_add_u32 m0, s53, 7168
    s_mov_b32 s45, 62592
    buffer_load_dwordx4 v5, s[12:15], s45 offen lds
    v_fmac_f32_dpp v125, -v45, v122 row_newbcast:12 row_mask:0xf bank_mask:0xf
    v_fmac_f32_dpp v131, -v45, v128 row_newbcast:13 row_mask:0xf bank_mask:0xf
    v_cvt_pk_bf16_f32 v64, v124, v125
    v_cvt_pk_bf16_f32 v65, v130, v131
    v_mul_f32 v120, v123, v123
    v_mul_f32 v126, v129, v129
    v_mul_f32_e64 v123, v122, v123 mul:2
    v_mul_f32_e64 v129, v128, v129 mul:2
    v_fma_f32 v122, v122, v122, -v120
    v_fma_f32 v128, v128, v128, -v126
    v_mul_f32 v120, v123, v123
    v_mul_f32 v126, v129, v129
    v_mul_f32_e64 v123, v122, v123 mul:2
    v_mul_f32_e64 v129, v128, v129 mul:2
    v_fma_f32 v122, v122, v122, -v120
    s_waitcnt vmcnt(12)
    s_barrier
    s_getpc_b64 s[44:45]
L_pc_x:
    s_add_u32 s44, s44, L_table-L_pc_x
    s_addc_u32 s45, s45, 0
    s_and_b32 s46, s3, 3
    s_mul_i32 s46, s46, 3072
    v_mul_u32_u24 v1, 48, v0
    v_add_u32 v1, s46, v1
    global_load_dwordx4 v[144:147], v1, s[44:45] offset:0
    global_load_dwordx4 v[148:151], v1, s[44:45] offset:16
    global_load_dwordx4 v[152:155], v1, s[44:45] offset:32
    v_min_u32 v9, 39, v0
    v_lshlrev_b32 v9, 2, v9
    s_and_b32 s56, s2, 7
    s_mul_i32 s56, s56, 256
    s_add_u32 s56, s56, 0x0
    s_cmp_eq_u32 s3, 4
    s_cselect_b32 s44, 0, 0x20000000
    v_or_b32 v9, s44, v9
    buffer_load_dword v12, v9, s[28:31], s56 offen sc1
    v_fma_f32 v128, v128, v128, -v126
    v_mul_f32_dpp v124, v46, v122 row_newbcast:12 row_mask:0xf bank_mask:0xf
    v_mul_f32_dpp v130, v46, v128 row_newbcast:13 row_mask:0xf bank_mask:0xf
    v_mul_f32_dpp v125, -v46, v123 row_newbcast:12 row_mask:0xf bank_mask:0xf
    v_mul_f32_dpp v131, -v46, v129 row_newbcast:13 row_mask:0xf bank_mask:0xf
    v_fmac_f32_dpp v124, -v47, v123 row_newbcast:12 row_mask:0xf bank_mask:0xf
    v_fmac_f32_dpp v130, -v47, v129 row_newbcast:13 row_mask:0xf bank_mask:0xf
    v_fmac_f32_dpp v125, -v47, v122 row_newbcast:12 row_mask:0xf bank_mask:0xf
    v_fmac_f32_dpp v131, -v47, v128 row_newbcast:13 row_mask:0xf bank_mask:0xf
    v_cvt_pk_bf16_f32 v68, v124, v125
    v_cvt_pk_bf16_f32 v69, v130, v131
    v_mul_f32_dpp v124, v48, v122 row_newbcast:12 row_mask:0xf bank_mask:0xf
    v_mul_f32_dpp v130, v48, v128 row_newbcast:13 row_mask:0xf bank_mask:0xf
    v_mul_f32_dpp v125, -v48, v123 row_newbcast:12 row_mask:0xf bank_mask:0xf
    v_mul_f32_dpp v131, -v48, v129 row_newbcast:13 row_mask:0xf bank_mask:0xf
    v_fmac_f32_dpp v124, -v49, v123 row_newbcast:12 row_mask:0xf bank_mask:0xf
    v_fmac_f32_dpp v130, -v49, v129 row_newbcast:13 row_mask:0xf bank_mask:0xf
    v_fmac_f32_dpp v125, -v49, v122 row_newbcast:12 row_mask:0xf bank_mask:0xf
    v_fmac_f32_dpp v131, -v49, v128 row_newbcast:13 row_mask:0xf bank_mask:0xf
    v_cvt_pk_bf16_f32 v72, v124, v125
    v_cvt_pk_bf16_f32 v73, v130, v131
    v_mul_f32_dpp v121, v40, v50 row_newbcast:14 row_mask:0xf bank_mask:0xf
    v_mul_f32_dpp v127, v40, v50 row_newbcast:15 row_mask:0xf bank_mask:0xf
    v_mul_f32_dpp v120, v41, v50 row_newbcast:14 row_mask:0xf bank_mask:0xf
    v_mul_f32_dpp v126, v41, v50 row_newbcast:15 row_mask:0xf bank_mask:0xf
    v_exp_f32 v121, v121
    v_exp_f32 v127, v127
    v_cos_f32 v122, v120
    v_cos_f32 v128, v126
    v_sin_f32 v123, v120
    v_sin_f32 v129, v126
    v_mul_f32 v122, v121, v122
    v_mul_f32 v128, v127, v128
    v_mul_f32 v123, v121, v123
    v_mul_f32 v129, v127, v129
    v_cvt_pk_bf16_f32 v54, v122, v123
    v_cvt_pk_bf16_f32 v55, v128, v129
    v_mul_f32 v120, v123, v123
    v_mul_f32 v126, v129, v129
    v_mul_f32_e64 v123, v122, v123 mul:2
    v_mul_f32_e64 v129, v128, v129 mul:2
    v_fma_f32 v122, v122, v122, -v120
    v_fma_f32 v128, v128, v128, -v126
    v_mul_f32 v120, v123, v123
    v_mul_f32 v126, v129, v129
    v_mul_f32_e64 v123, v122, v123 mul:2
    v_mul_f32_e64 v129, v128, v129 mul:2
    v_fma_f32 v122, v122, v122, -v120
    v_fma_f32 v128, v128, v128, -v126
    v_cvt_pk_bf16_f32 v58, v122, v123
    v_cvt_pk_bf16_f32 v59, v128, v129
    v_mul_f32 v120, v123, v123
    v_mul_f32 v126, v129, v129
    v_mul_f32_e64 v123, v122, v123 mul:2
    v_mul_f32_e64 v129, v128, v129 mul:2
    v_fma_f32 v122, v122, v122, -v120
    v_fma_f32 v128, v128, v128, -v126
    v_mul_f32 v120, v123, v123
    v_mul_f32 v126, v129, v129
    v_mul_f32_e64 v123, v122, v123 mul:2
    v_mul_f32_e64 v129, v128, v129 mul:2
    v_fma_f32 v122, v122, v122, -v120
    v_fma_f32 v128, v128, v128, -v126
    v_mul_f32_dpp v124, v42, v122 row_newbcast:14 row_mask:0xf bank_mask:0xf
    v_mul_f32_dpp v130, v42, v128 row_newbcast:15 row_mask:0xf bank_mask:0xf
    v_mul_f32_dpp v125, -v42, v123 row_newbcast:14 row_mask:0xf bank_mask:0xf
    v_mul_f32_dpp v131, -v42, v129 row_newbcast:15 row_mask:0xf bank_mask:0xf
    v_fmac_f32_dpp v124, -v43, v123 row_newbcast:14 row_mask:0xf bank_mask:0xf
    v_fmac_f32_dpp v130, -v43, v129 row_newbcast:15 row_mask:0xf bank_mask:0xf
    v_fmac_f32_dpp v125, -v43, v122 row_newbcast:14 row_mask:0xf bank_mask:0xf
    v_fmac_f32_dpp v131, -v43, v128 row_newbcast:15 row_mask:0xf bank_mask:0xf
    v_cvt_pk_bf16_f32 v62, v124, v125
    v_cvt_pk_bf16_f32 v63, v130, v131
    v_mul_f32_dpp v124, v44, v122 row_newbcast:14 row_mask:0xf bank_mask:0xf
    v_mul_f32_dpp v130, v44, v128 row_newbcast:15 row_mask:0xf bank_mask:0xf
    v_mul_f32_dpp v125, -v44, v123 row_newbcast:14 row_mask:0xf bank_mask:0xf
    v_mul_f32_dpp v131, -v44, v129 row_newbcast:15 row_mask:0xf bank_mask:0xf
    v_fmac_f32_dpp v124, -v45, v123 row_newbcast:14 row_mask:0xf bank_mask:0xf
    v_fmac_f32_dpp v130, -v45, v129 row_newbcast:15 row_mask:0xf bank_mask:0xf
    v_fmac_f32_dpp v125, -v45, v122 row_newbcast:14 row_mask:0xf bank_mask:0xf
    s_waitcnt vmcnt(0)
    v_xor_b32 v12, s11, v12
    v_cmp_ne_u32 vcc, 0, v12
    s_cmp_lg_u64 vcc, 0
    s_cselect_b32 s44, 4, -1
    s_cmp_eq_u32 s44, s3
    s_cbranch_scc0 L_back_x_2
    s_mov_b32 s61, 0
L_retry_x_2:
    s_add_u32 s61, s61, 1
    s_cmp_gt_u32 s61, 50000
    s_cbranch_scc1 L_back_x_2
    s_sleep 1
    buffer_load_dword v12, v9, s[28:31], s56 offen sc1
    s_waitcnt vmcnt(0)
    v_xor_b32 v12, s11, v12
    v_cmp_ne_u32 vcc, 0, v12
    s_cmp_lg_u64 vcc, 0
    s_cbranch_scc1 L_retry_x_2
L_back_x_2:
    s_barrier
    s_mov_b32 exec_hi, 0
    buffer_load_dwordx4 v[16:19], v7, s[28:31], s96 offen sc1
    buffer_load_dwordx4 v[20:23], v39, s[28:31], s99 offen sc1
    s_add_u32 s99, s99, 13824
    buffer_load_dwordx4 v[24:27], v39, s[28:31], s99 offen sc1
    s_add_u32 s99, s99, 13824
    buffer_load_dwordx4 v[28:31], v39, s[28:31], s99 offen sc1
    s_add_u32 s99, s99, 13824
    buffer_load_dwordx4 v[32:35], v39, s[28:31], s99 offen sc1
    s_mov_b32 exec_hi, -1
    buffer_load_dwordx4 v[132:135], v36, s[28:31], s100 offen sc1
    buffer_load_dwordx4 v[136:139], v37, s[28:31], s100 offen sc1
    buffer_load_dwordx4 v[140:143], v38, s[28:31], s100 offen sc1
    v_fmac_f32_dpp v131, -v45, v128 row_newbcast:15 row_mask:0xf bank_mask:0xf
    v_cvt_pk_bf16_f32 v66, v124, v125
    v_cvt_pk_bf16_f32 v67, v130, v131
    v_mul_f32 v120, v123, v123
    v_mul_f32 v126, v129, v129
    v_mul_f32_e64 v123, v122, v123 mul:2
    v_mul_f32_e64 v129, v128, v129 mul:2
    v_fma_f32 v122, v122, v122, -v120
    v_fma_f32 v128, v128, v128, -v126
    v_mul_f32 v120, v123, v123
    v_mul_f32 v126, v129, v129
    v_mul_f32_e64 v123, v122, v123 mul:2
    v_mul_f32_e64 v129, v128, v129 mul:2
    v_fma_f32 v122, v122, v122, -v120
    v_fma_f32 v128, v128, v128, -v126
    v_mul_f32_dpp v124, v46, v122 row_newbcast:14 row_mask:0xf bank_mask:0xf
    v_mul_f32_dpp v130, v46, v128 row_newbcast:15 row_mask:0xf bank_mask:0xf
    v_mul_f32_dpp v125, -v46, v123 row_newbcast:14 row_mask:0xf bank_mask:0xf
    v_mul_f32_dpp v131, -v46, v129 row_newbcast:15 row_mask:0xf bank_mask:0xf
    v_fmac_f32_dpp v124, -v47, v123 row_newbcast:14 row_mask:0xf bank_mask:0xf
    v_fmac_f32_dpp v130, -v47, v129 row_newbcast:15 row_mask:0xf bank_mask:0xf
    v_fmac_f32_dpp v125, -v47, v122 row_newbcast:14 row_mask:0xf bank_mask:0xf
    v_fmac_f32_dpp v131, -v47, v128 row_newbcast:15 row_mask:0xf bank_mask:0xf
    v_cvt_pk_bf16_f32 v70, v124, v125
    v_cvt_pk_bf16_f32 v71, v130, v131
    v_mul_f32_dpp v124, v48, v122 row_newbcast:14 row_mask:0xf bank_mask:0xf
    v_mul_f32_dpp v130, v48, v128 row_newbcast:15 row_mask:0xf bank_mask:0xf
    v_mul_f32_dpp v125, -v48, v123 row_newbcast:14 row_mask:0xf bank_mask:0xf
    v_mul_f32_dpp v131, -v48, v129 row_newbcast:15 row_mask:0xf bank_mask:0xf
    v_fmac_f32_dpp v124, -v49, v123 row_newbcast:14 row_mask:0xf bank_mask:0xf
    v_fmac_f32_dpp v130, -v49, v129 row_newbcast:15 row_mask:0xf bank_mask:0xf
    v_fmac_f32_dpp v125, -v49, v122 row_newbcast:14 row_mask:0xf bank_mask:0xf
    v_fmac_f32_dpp v131, -v49, v128 row_newbcast:15 row_mask:0xf bank_mask:0xf
    v_cvt_pk_bf16_f32 v74, v124, v125
    v_cvt_pk_bf16_f32 v75, v130, v131
    s_setprio 3
    s_nop 0
    v_mfma_f32_16x16x32_bf16 v[92:95], v[52:55], v[60:63], v[92:95]
    v_mfma_f32_16x16x32_bf16 v[100:103], v[52:55], v[64:67], v[100:103]
    v_mfma_f32_16x16x32_bf16 v[96:99], v[56:59], v[68:71], v[96:99]
    v_mfma_f32_16x16x32_bf16 v[104:107], v[56:59], v[72:75], v[104:107]
    s_setprio 0
    s_nop 7
    s_and_b32 s44, s3, 3
    s_mul_i32 s44, s44, 3072
    s_add_u32 s44, s44, 81920
    v_lshl_add_u32 v1, v0, 4, s44
    s_mov_b64 exec, 1
    v_add_f32 v76, s97, v76
    v_add_f32 v92, s98, v92
    s_mov_b64 exec, -1
    v_mov_b32 v85, v86
    v_mov_b32 v86, v88
    v_mov_b32 v87, v90
    ds_write_b128 v1, v[76:79] offset:0
    ds_write_b128 v1, v[80:83] offset:1024
    ds_write_b128 v1, v[84:87] offset:2048
    v_mov_b32 v101, v102
    v_mov_b32 v102, v104
    v_mov_b32 v103, v106
    ds_write_b128 v1, v[92:95] offset:12288
    ds_write_b128 v1, v[96:99] offset:13312
    ds_write_b128 v1, v[100:103] offset:14336
    v_mov_b32 v12, 0
    v_mov_b32 v13, 0
    v_mov_b32 v14, 0
    v_mov_b32 v15, 0
    s_waitcnt lgkmcnt(0)
    s_barrier
    s_and_b32 s44, s3, 3
    s_and_b32 s45, s44, 1
    s_lshr_b32 s46, s44, 1
    s_lshl_b32 s47, s46, 10
    s_lshl_b32 s48, s46, 3
    s_add_u32 s48, s48, 2048
    s_cmp_eq_u32 s45, 0
    s_cselect_b32 s47, s47, s48
    v_lshl_add_u32 v2, v0, 4, s47
    v_add_u32 v5, 147456, v2
    v_add_u32 v2, 81920, v2
    ds_read_b64 v[44:45], v2 offset:0
    ds_read_b64 v[46:47], v2 offset:8
    ds_read_b64 v[48:49], v2 offset:3072
    ds_read_b64 v[50:51], v2 offset:3080
    ds_read_b64 v[52:53], v2 offset:6144
    ds_read_b64 v[54:55], v2 offset:6152
    ds_read_b64 v[56:57], v2 offset:9216
    ds_read_b64 v[58:59], v2 offset:9224
    ds_read_b64 v[60:61], v2 offset:12288
    ds_read_b64 v[62:63], v2 offset:12296
    ds_read_b64 v[64:65], v2 offset:15360
    ds_read_b64 v[66:67], v2 offset:15368
    ds_read_b64 v[68:69], v2 offset:18432
    ds_read_b64 v[70:71], v2 offset:18440
    ds_read_b64 v[72:73], v2 offset:21504
    ds_read_b64 v[74:75], v2 offset:21512
    ds_read_b64 v[76:77], v5 offset:0
    ds_read_b64 v[78:79], v5 offset:8
    ds_read_b64 v[80:81], v5 offset:3072
    ds_read_b64 v[82:83], v5 offset:3080
    ds_read_b64 v[84:85], v5 offset:6144
    ds_read_b64 v[86:87], v5 offset:6152
    ds_read_b64 v[88:89], v5 offset:9216
    ds_read_b64 v[90:91], v5 offset:9224
    v_and_b32 v3, 15, v0
    v_lshlrev_b32 v3, 5, v3
    v_lshrrev_b32 v4, 4, v0
    v_lshl_add_u32 v3, v4, 3, v3
    s_lshl_b32 s44, s44, 9
    s_add_u32 s44, s44, 114688
    v_add_u32 v3, s44, v3
    s_cmp_lg_u32 s45, 0
    s_cselect_b64 vcc, -1, 0
    s_waitcnt lgkmcnt(0)
    v_pk_add_f32 v[44:45], v[44:45], v[48:49]
    v_pk_add_f32 v[52:53], v[52:53], v[56:57]
    v_pk_add_f32 v[46:47], v[46:47], v[50:51]
    v_pk_add_f32 v[54:55], v[54:55], v[58:59]
    v_pk_add_f32 v[44:45], v[44:45], v[52:53]
    v_pk_add_f32 v[46:47], v[46:47], v[54:55]
    v_cndmask_b32 v46, v46, v45, vcc
    v_cndmask_b32 v45, v45, v15, vcc
    v_cndmask_b32 v47, v47, v15, vcc
    v_cvt_pk_bf16_f32 v48, v44, v45
    v_cvt_pk_bf16_f32 v49, v46, v47
    ds_write_b64 v3, v[48:49] offset:0
    v_pk_add_f32 v[60:61], v[60:61], v[64:65]
    v_pk_add_f32 v[68:69], v[68:69], v[72:73]
    v_pk_add_f32 v[62:63], v[62:63], v[66:67]
    v_pk_add_f32 v[70:71], v[70:71], v[74:75]
    v_pk_add_f32 v[60:61], v[60:61], v[68:69]
    v_pk_add_f32 v[62:63], v[62:63], v[70:71]
    v_cndmask_b32 v62, v62, v61, vcc
    v_cndmask_b32 v61, v61, v15, vcc
    v_cndmask_b32 v63, v63, v15, vcc
    v_cvt_pk_bf16_f32 v64, v60, v61
    v_cvt_pk_bf16_f32 v65, v62, v63
    ds_write_b64 v3, v[64:65] offset:2048
    v_pk_add_f32 v[76:77], v[76:77], v[80:81]
    v_pk_add_f32 v[84:85], v[84:85], v[88:89]
    v_pk_add_f32 v[78:79], v[78:79], v[82:83]
    v_pk_add_f32 v[86:87], v[86:87], v[90:91]
    v_pk_add_f32 v[76:77], v[76:77], v[84:85]
    v_pk_add_f32 v[78:79], v[78:79], v[86:87]
    v_cndmask_b32 v78, v78, v77, vcc
    v_cndmask_b32 v77, v77, v15, vcc
    v_cndmask_b32 v79, v79, v15, vcc
    v_cvt_pk_bf16_f32 v80, v76, v77
    v_cvt_pk_bf16_f32 v81, v78, v79
    ds_write_b64 v3, v[80:81] offset:4096
    s_waitcnt vmcnt(3)
    v_add_f32 v20, v20, v24
    v_add_f32 v21, v21, v25
    v_add_f32 v22, v22, v26
    v_add_f32 v23, v23, v27
    v_add_f32 v28, v28, v32
    v_add_f32 v29, v29, v33
    v_add_f32 v30, v30, v34
    v_add_f32 v31, v31, v35
    v_add_f32 v20, v20, v28
    v_add_f32 v21, v21, v29
    v_add_f32 v22, v22, v30
    v_add_f32 v23, v23, v31
    s_mov_b32 exec_hi, 0
    v_add_u32 v10, s57, v7
    ds_write_b128 v10, v[16:19]
    v_add_u32 v10, 161792, v7
    ds_write_b128 v10, v[20:23]
    s_mov_b32 exec_hi, -1
L_x_post:
    s_waitcnt vmcnt(0)
    s_and_b32 s44, s3, 3
    s_mul_i32 s44, s44, 3072
    s_add_u32 s44, s44, 51360
    v_lshl_add_u32 v1, v0, 4, s44
    ds_write_b128 v1, v[132:135] offset:0
    ds_write_b128 v1, v[136:139] offset:1024
    ds_write_b128 v1, v[140:143] offset:2048
    v_lshlrev_b32 v1, 4, v0
    v_add_u32 v1, 49920, v1
    ds_write_b128 v1, v[12:15]
    s_mov_b64 exec, 0x3ffffff
    ds_write_b128 v1, v[12:15] offset:1024
    s_mov_b64 exec, -1
    s_waitcnt lgkmcnt(0)
    s_barrier
    ds_read_u16 v16, v144 offset:0
    ds_read_u16 v17, v145 offset:0
    ds_read_u16 v18, v146 offset:0
    ds_read_u16 v19, v147 offset:0
    ds_read_u16 v20, v148 offset:0
    ds_read_u16 v21, v149 offset:0
    ds_read_u16 v22, v150 offset:0
    ds_read_u16 v23, v151 offset:0
    ds_read_u16 v24, v152 offset:0
    ds_read_u16 v25, v153 offset:0
    ds_read_u16 v26, v154 offset:0
    ds_read_u16 v48, v144 offset:2048
    ds_read_u16 v49, v145 offset:2048
    ds_read_u16 v50, v146 offset:2048
    ds_read_u16 v51, v147 offset:2048
    ds_read_u16 v52, v148 offset:2048
    ds_read_u16 v53, v149 offset:2048
    ds_read_u16 v54, v150 offset:2048
    ds_read_u16 v55, v151 offset:2048
    ds_read_u16 v56, v152 offset:2048
    ds_read_u16 v57, v153 offset:2048
    ds_read_u16 v58, v154 offset:2048
    ds_read_u16 v80, v144 offset:4096
    ds_read_u16 v81, v145 offset:4096
    ds_read_u16 v82, v146 offset:4096
    ds_read_u16 v83, v147 offset:4096
    ds_read_u16 v84, v148 offset:4096
    ds_read_u16 v85, v149 offset:4096
    ds_read_u16 v86, v150 offset:4096
    ds_read_u16 v87, v151 offset:4096
    ds_read_u16 v88, v152 offset:4096
    ds_read_u16 v89, v153 offset:4096
    ds_read_u16 v90, v154 offset:4096
    s_and_b32 s44, s3, 3
    s_lshl_b32 s44, s44, 10
    s_add_u32 s44, s44, 0
    v_lshl_add_u32 v2, v0, 4, s44
    s_waitcnt lgkmcnt(15)
    v_lshl_or_b32 v28, v17, 16, v16
    v_lshl_or_b32 v29, v19, 16, v18
    v_lshl_or_b32 v30, v21, 16, v20
    v_lshl_or_b32 v31, v23, 16, v22
    ds_write_b128 v2, v[28:31] offset:0
    v_lshl_or_b32 v32, v18, 16, v17
    v_lshl_or_b32 v33, v20, 16, v19
    v_lshl_or_b32 v34, v22, 16, v21
    v_lshl_or_b32 v35, v24, 16, v23
    ds_write_b128 v2, v[32:35] offset:4160
    v_lshl_or_b32 v36, v19, 16, v18
    v_lshl_or_b32 v37, v21, 16, v20
    v_lshl_or_b32 v38, v23, 16, v22
    v_lshl_or_b32 v39, v25, 16, v24
    ds_write_b128 v2, v[36:39] offset:8320
    v_lshl_or_b32 v40, v20, 16, v19
    v_lshl_or_b32 v41, v22, 16, v21
    v_lshl_or_b32 v42, v24, 16, v23
    v_lshl_or_b32 v43, v26, 16, v25
    ds_write_b128 v2, v[40:43] offset:12480
    s_waitcnt lgkmcnt(15)
    v_lshl_or_b32 v60, v49, 16, v48
    v_lshl_or_b32 v61, v51, 16, v50
    v_lshl_or_b32 v62, v53, 16, v52
    v_lshl_or_b32 v63, v55, 16, v54
    ds_write_b128 v2, v[60:63] offset:16640
    v_lshl_or_b32 v64, v50, 16, v49
    v_lshl_or_b32 v65, v52, 16, v51
    v_lshl_or_b32 v66, v54, 16, v53
    v_lshl_or_b32 v67, v56, 16, v55
    ds_write_b128 v2, v[64:67] offset:20800
    v_lshl_or_b32 v68, v51, 16, v50
    v_lshl_or_b32 v69, v53, 16, v52
    v_lshl_or_b32 v70, v55, 16, v54
    v_lshl_or_b32 v71, v57, 16, v56
    ds_write_b128 v2, v[68:71] offset:24960
    v_lshl_or_b32 v72, v52, 16, v51
    v_lshl_or_b32 v73, v54, 16, v53
    v_lshl_or_b32 v74, v56, 16, v55
    v_lshl_or_b32 v75, v58, 16, v57
    ds_write_b128 v2, v[72:75] offset:29120
    s_waitcnt lgkmcnt(8)
    v_lshl_or_b32 v92, v81, 16, v80
    v_lshl_or_b32 v93, v83, 16, v82
    v_lshl_or_b32 v94, v85, 16, v84
    v_lshl_or_b32 v95, v87, 16, v86
    ds_write_b128 v2, v[92:95] offset:33280
    v_lshl_or_b32 v96, v82, 16, v81
    v_lshl_or_b32 v97, v84, 16, v83
    v_lshl_or_b32 v98, v86, 16, v85
    v_lshl_or_b32 v99, v88, 16, v87
    ds_write_b128 v2, v[96:99] offset:37440
    v_lshl_or_b32 v100, v83, 16, v82
    v_lshl_or_b32 v101, v85, 16, v84
    v_lshl_or_b32 v102, v87, 16, v86
    v_lshl_or_b32 v103, v89, 16, v88
    ds_write_b128 v2, v[100:103] offset:41600
    v_lshl_or_b32 v104, v84, 16, v83
    v_lshl_or_b32 v105, v86, 16, v85
    v_lshl_or_b32 v106, v88, 16, v87
    v_lshl_or_b32 v107, v90, 16, v89
    ds_write_b128 v2, v[104:107] offset:45760
    v_lshrrev_b32 v1, 1, v0
    v_mul_u32_u24 v1, 4160, v1
    v_and_b32 v10, 1, v0
    v_lshl_add_u32 v1, v10, 4, v1
    v_add_u32 v1, 4096, v1
    s_mov_b64 exec, 0xffffff
    ds_write_b128 v1, v[12:15]
    s_mov_b64 exec, -1
    s_waitcnt lgkmcnt(0)
    s_barrier
    s_cmp_eq_u32 s58, 0
    s_cbranch_scc1 L_x_end
    s_and_b32 s46, s3, 3
    s_lshl_b32 s46, s46, 10
    s_add_u32 m0, s46, 81920
    s_mov_b32 s44, 0
    buffer_load_dwordx4 v6, s[24:27], s44 offen  lds
    s_and_b32 s46, s3, 3
    s_lshl_b32 s46, s46, 10
    s_add_u32 m0, s46, 86016
    s_mov_b32 s44, 40960
    buffer_load_dwordx4 v6, s[24:27], s44 offen  lds
    s_and_b32 s46, s3, 3
    s_lshl_b32 s46, s46, 10
    s_add_u32 m0, s46, 90112
    s_mov_b32 s44, 81920
    buffer_load_dwordx4 v6, s[24:27], s44 offen  lds
    s_and_b32 s46, s3, 3
    s_lshl_b32 s46, s46, 10
    s_add_u32 m0, s46, 94208
    s_mov_b32 s44, 122880
    buffer_load_dwordx4 v6, s[24:27], s44 offen  lds
    s_and_b32 s46, s3, 3
    s_lshl_b32 s46, s46, 10
    s_add_u32 m0, s46, 98304
    s_mov_b32 s44, 163840
    buffer_load_dwordx4 v6, s[24:27], s44 offen  lds
    s_and_b32 s46, s3, 3
    s_lshl_b32 s46, s46, 10
    s_add_u32 m0, s46, 102400
    s_mov_b32 s44, 204800
    buffer_load_dwordx4 v6, s[24:27], s44 offen  lds
    s_and_b32 s46, s3, 3
    s_lshl_b32 s46, s46, 10
    s_add_u32 m0, s46, 106496
    s_mov_b32 s44, 245760
    buffer_load_dwordx4 v6, s[24:27], s44 offen  lds
    s_and_b32 s46, s3, 3
    s_lshl_b32 s46, s46, 10
    s_add_u32 m0, s46, 110592
    s_mov_b32 s44, 286720
    buffer_load_dwordx4 v6, s[24:27], s44 offen  lds
    s_and_b32 s46, s3, 3
    s_lshl_b32 s46, s46, 10
    s_add_u32 m0, s46, 114688
    s_mov_b32 s44, 327680
    buffer_load_dwordx4 v6, s[24:27], s44 offen  lds
    s_and_b32 s46, s3, 3
    s_lshl_b32 s46, s46, 10
    s_add_u32 m0, s46, 118784
    s_mov_b32 s44, 368640
    buffer_load_dwordx4 v6, s[24:27], s44 offen  lds
    s_and_b32 s46, s3, 3
    s_lshl_b32 s46, s46, 10
    s_add_u32 m0, s46, 122880
    s_mov_b32 s44, 409600
    buffer_load_dwordx4 v6, s[24:27], s44 offen  lds
    s_and_b32 s46, s3, 3
    s_lshl_b32 s46, s46, 10
    s_add_u32 m0, s46, 126976
    s_mov_b32 s44, 450560
    buffer_load_dwordx4 v6, s[24:27], s44 offen  lds
    s_and_b32 s46, s3, 3
    s_lshl_b32 s46, s46, 10
    s_add_u32 m0, s46, 131072
    s_mov_b32 s44, 491520
    buffer_load_dwordx4 v6, s[24:27], s44 offen  lds
    s_and_b32 s46, s3, 3
    s_lshl_b32 s46, s46, 10
    s_add_u32 m0, s46, 135168
    s_mov_b32 s44, 532480
    buffer_load_dwordx4 v6, s[24:27], s44 offen  lds
    s_and_b32 s46, s3, 3
    s_lshl_b32 s46, s46, 10
    s_add_u32 m0, s46, 139264
    s_mov_b32 s44, 573440
    buffer_load_dwordx4 v6, s[24:27], s44 offen  lds
    s_and_b32 s46, s3, 3
    s_lshl_b32 s46, s46, 10
    s_add_u32 m0, s46, 143360
    s_mov_b32 s44, 614400
    buffer_load_dwordx4 v6, s[24:27], s44 offen  lds
    s_mov_b32 s45, 819200
    buffer_load_dwordx4 v[156:159], v6, s[24:27], s45 offen
    s_mov_b32 s45, 860160
    buffer_load_dwordx4 v[160:163], v6, s[24:27], s45 offen
    s_mov_b32 s45, 901120
    buffer_load_dwordx4 v[164:167], v6, s[24:27], s45 offen
    s_mov_b32 s45, 942080
    buffer_load_dwordx4 v[168:171], v6, s[24:27], s45 offen
    s_mov_b32 s45, 983040
    buffer_load_dwordx4 v[172:175], v6, s[24:27], s45 offen
    s_mov_b32 s45, 1024000
    buffer_load_dwordx4 v[176:179], v6, s[24:27], s45 offen
    s_mov_b32 s45, 1064960
    buffer_load_dwordx4 v[180:183], v6, s[24:27], s45 offen
    s_mov_b32 s45, 1105920
    buffer_load_dwordx4 v[184:187], v6, s[24:27], s45 offen
    s_mov_b32 s45, 1146880
    buffer_load_dwordx4 v[188:191], v6, s[24:27], s45 offen
    s_mov_b32 s45, 1187840
    buffer_load_dwordx4 v[192:195], v6, s[24:27], s45 offen
    s_mov_b32 s45, 1228800
    buffer_load_dwordx4 v[196:199], v6, s[24:27], s45 offen
    s_mov_b32 s45, 1269760
    buffer_load_dwordx4 v[200:203], v6, s[24:27], s45 offen
    s_mov_b32 s45, 1310720
    buffer_load_dwordx4 v[204:207], v6, s[24:27], s45 offen
    s_mov_b32 s45, 1351680
    buffer_load_dwordx4 v[208:211], v6, s[24:27], s45 offen
    s_mov_b32 s45, 1392640
    buffer_load_dwordx4 v[212:215], v6, s[24:27], s45 offen
    s_mov_b32 s45, 1433600
    buffer_load_dwordx4 v[216:219], v6, s[24:27], s45 offen
    s_and_b32 s46, s3, 3
    s_lshl_b32 s46, s46, 10
    s_add_u32 m0, s46, 65536
    s_mov_b32 s44, 655360
    buffer_load_dwordx4 v6, s[24:27], s44 offen  lds
    s_add_u32 m0, s46, 69632
    s_mov_b32 s44, 696320
    buffer_load_dwordx4 v6, s[24:27], s44 offen  lds
    s_add_u32 m0, s46, 73728
    s_mov_b32 s44, 737280
    buffer_load_dwordx4 v6, s[24:27], s44 offen  lds
    s_add_u32 m0, s46, 77824
    s_mov_b32 s44, 778240
    buffer_load_dwordx4 v6, s[24:27], s44 offen  lds
    s_and_b32 s44, s3, 3
    s_mul_i32 s45, s44, 24
    s_mul_i32 s47, s6, 96
    s_add_u32 s45, s45, s47
    s_mul_i32 s46, s44, 3072
    s_add_u32 s46, s46, 147456
    v_lshrrev_b32 v10, 3, v0
    v_lshrrev_b32 v11, 4, v0
    v_and_b32 v1, 7, v0
    v_xor_b32 v1, v1, v11
    v_lshlrev_b32 v1, 4, v1
    v_mul_u32_u24 v10, 1280, v10
    v_add_u32 v10, v10, v1
    s_mul_i32 s47, s45, 1280
    s_lshl_b32 s48, s7, 7
    s_add_u32 s47, s47, s48
    s_and_b32 s48, s44, 1
    s_lshl_b32 s48, s48, 6
    v_xor_b32 v10, s48, v10
    s_add_u32 m0, s46, 0
    s_nop 0
    buffer_load_dwordx4 v10, s[12:15], s47 offen lds
    s_add_u32 s47, s47, 10240
    v_xor_b32 v10, 64, v10
    s_add_u32 m0, s46, 1024
    s_nop 0
    buffer_load_dwordx4 v10, s[12:15], s47 offen lds
    s_add_u32 s47, s47, 10240
    v_xor_b32 v10, 64, v10
    s_add_u32 m0, s46, 2048
    s_nop 0
    buffer_load_dwordx4 v10, s[12:15], s47 offen lds
    s_lshl_b32 s45, s45, 3
    s_add_u32 s45, s45, 0x10000
    s_mul_i32 s46, s44, 192
    s_add_u32 m0, s46, 159744
    v_lshlrev_b32 v10, 4, v0
    s_mov_b64 exec, 0xfff
    buffer_load_dwordx4 v10, s[28:31], s45 offen sc1 lds
    s_mov_b64 exec, -1
    s_mul_i32 s44, s6, 96
    s_add_u32 s45, s44, 95
    s_lshr_b32 s44, s44, 8
    s_lshr_b32 s45, s45, 8
    s_min_u32 s45, s45, 7
    s_sub_u32 s45, s45, s44
    v_and_b32 v9, 31, v0
    v_min_u32 v9, 26, v9
    v_lshrrev_b32 v1, 5, v0
    v_mul_u32_u24 v1, s45, v1
    v_add_u32 v1, s44, v1
    v_lshl_add_u32 v9, v1, 5, v9
    v_lshlrev_b32 v9, 2, v9
    s_mul_i32 s56, s7, 1024
    s_add_u32 s56, s56, 0x1000
    s_cmp_eq_u32 s3, 4
    s_cselect_b32 s44, 0, 0x20000000
    v_or_b32 v9, s44, v9
    buffer_load_dword v12, v9, s[28:31], s56 offen sc1
    s_mov_b32 s45, 1474560
    buffer_load_dwordx4 v[220:223], v6, s[24:27], s45 offen
    s_mov_b32 s45, 1515520
    buffer_load_dwordx4 v[224:227], v6, s[24:27], s45 offen
    s_mov_b32 s45, 1556480
    buffer_load_dwordx4 v[228:231], v6, s[24:27], s45 offen
    s_mov_b32 s45, 1597440
    buffer_load_dwordx4 v[232:235], v6, s[24:27], s45 offen
    s_mov_b32 s45, 1638400
    buffer_load_dwordx4 v[236:239], v6, s[24:27], s45 offen
    s_mov_b32 s45, 1679360
    buffer_load_dwordx4 v[240:243], v6, s[24:27], s45 offen
    s_mov_b32 s45, 1720320
    buffer_load_dwordx4 v[244:247], v6, s[24:27], s45 offen
    s_mov_b32 s45, 1761280
    buffer_load_dwordx4 v[248:251], v6, s[24:27], s45 offen
    s_mov_b32 s45, 1802240
    buffer_load_dwordx4 v[76:79], v6, s[24:27], s45 offen
    s_mov_b32 s45, 1843200
    buffer_load_dwordx4 v[80:83], v6, s[24:27], s45 offen
    s_mov_b32 s45, 1884160
    buffer_load_dwordx4 v[84:87], v6, s[24:27], s45 offen
    s_mov_b32 s45, 1925120
    buffer_load_dwordx4 v[88:91], v6, s[24:27], s45 offen
    s_mov_b32 s45, 1966080
    buffer_load_dwordx4 v[92:95], v6, s[24:27], s45 offen
    s_mov_b32 s45, 2007040
    buffer_load_dwordx4 v[96:99], v6, s[24:27], s45 offen
    s_mov_b32 s45, 2048000
    buffer_load_dwordx4 v[100:103], v6, s[24:27], s45 offen
    s_mov_b32 s45, 2088960
    buffer_load_dwordx4 v[104:107], v6, s[24:27], s45 offen
    s_mov_b32 s45, 2129920
    buffer_load_dwordx4 v[108:111], v6, s[24:27], s45 offen
    s_mov_b32 s45, 2170880
    buffer_load_dwordx4 v[112:115], v6, s[24:27], s45 offen
    s_waitcnt vmcnt(18)
    v_xor_b32 v12, s11, v12
    v_cmp_ne_u32 vcc, 0, v12
    s_cmp_lg_u64 vcc, 0
    s_cselect_b32 s44, 4, -1
    s_cmp_eq_u32 s44, s3
    s_cbranch_scc0 L_back_px_1
    s_mov_b32 s61, 0
L_retry_px_1:
    s_add_u32 s61, s61, 1
    s_cmp_gt_u32 s61, 50000
    s_cbranch_scc1 L_back_px_1
    s_sleep 1
    buffer_load_dword v12, v9, s[28:31], s56 offen sc1
    s_waitcnt vmcnt(0)
    v_xor_b32 v12, s11, v12
    v_cmp_ne_u32 vcc, 0, v12
    s_cmp_lg_u64 vcc, 0
    s_cbranch_scc1 L_retry_px_1
L_back_px_1:
    s_barrier
    s_and_b32 s44, s3, 3
    s_lshl_b32 s44, s44, 10
    v_lshl_add_u32 v2, v0, 4, s44
    v_add_u32 v3, 0x10000, v2
    v_add_u32 v4, 0x20000, v2
    ds_write_b128 v2, v[156:159] offset:0
    ds_write_b128 v2, v[160:163] offset:4096
    ds_write_b128 v2, v[164:167] offset:8192
    ds_write_b128 v2, v[168:171] offset:12288
    ds_write_b128 v2, v[172:175] offset:16384
    ds_write_b128 v2, v[176:179] offset:20480
    ds_write_b128 v2, v[180:183] offset:24576
    ds_write_b128 v2, v[184:187] offset:28672
    ds_write_b128 v2, v[188:191] offset:32768
    ds_write_b128 v2, v[192:195] offset:36864
    ds_write_b128 v2, v[196:199] offset:40960
    ds_write_b128 v2, v[200:203] offset:45056
    ds_write_b128 v2, v[204:207] offset:49152
    ds_write_b128 v2, v[208:211] offset:53248
    ds_write_b128 v2, v[212:215] offset:57344
    ds_write_b128 v2, v[216:219] offset:61440
    s_waitcnt lgkmcnt(0)
    s_barrier
    s_waitcnt vmcnt(0)
    ds_write_b128 v3, v[220:223] offset:16384
    ds_write_b128 v3, v[224:227] offset:20480
    ds_write_b128 v3, v[228:231] offset:24576
    ds_write_b128 v3, v[232:235] offset:28672
    s_waitcnt lgkmcnt(0)
    s_barrier
    ds_write_b128 v3, v[236:239] offset:32768
    ds_write_b128 v3, v[240:243] offset:36864
    ds_write_b128 v3, v[244:247] offset:40960
    ds_write_b128 v3, v[248:251] offset:45056
    s_waitcnt lgkmcnt(0)
    s_barrier
    ds_write_b128 v3, v[76:79] offset:49152
    ds_write_b128 v3, v[80:83] offset:53248
    ds_write_b128 v3, v[84:87] offset:57344
    ds_write_b128 v3, v[88:91] offset:61440
    s_waitcnt lgkmcnt(0)
    s_barrier
    ds_write_b128 v4, v[92:95] offset:0
    ds_write_b128 v4, v[96:99] offset:4096
    ds_write_b128 v4, v[100:103] offset:8192
    ds_write_b128 v4, v[104:107] offset:12288
    s_waitcnt lgkmcnt(0)
    s_barrier
    ds_write_b128 v3, v[108:111] offset:0
    ds_write_b128 v3, v[112:115] offset:4096
    s_waitcnt lgkmcnt(0)
    s_barrier
    s_waitcnt lgkmcnt(0)
    s_barrier
    v_lshlrev_b32 v9, 4, v0
    s_and_b32 s56, s2, 7
    s_mul_i32 s56, s56, 1024
    s_add_u32 s56, s56, 0x4000
    s_cmp_eq_u32 s3, 4
    s_cselect_b32 s44, 0, 0x20000000
    v_or_b32 v9, s44, v9
    buffer_load_dwordx4 v[12:15], v9, s[28:31], s56 offen sc1
    s_waitcnt lgkmcnt(0)
    s_barrier
    s_waitcnt lgkmcnt(0)
    s_barrier
    s_waitcnt vmcnt(0)
    v_xor_b32 v12, s11, v12
    v_xor_b32 v13, s11, v13
    v_xor_b32 v14, s11, v14
    v_xor_b32 v15, s11, v15
    v_or_b32 v12, v12, v13
    v_or3_b32 v12, v12, v14, v15
    v_cmp_ne_u32 vcc, 0, v12
    s_cmp_lg_u64 vcc, 0
    s_cselect_b32 s44, 4, -1
    s_cmp_eq_u32 s44, s3
    s_cbranch_scc0 L_back_px_2
    s_mov_b32 s61, 0
L_retry_px_2:
    s_add_u32 s61, s61, 1
    s_cmp_gt_u32 s61, 50000
    s_cbranch_scc1 L_back_px_2
    s_sleep 1
    buffer_load_dwordx4 v[12:15], v9, s[28:31], s56 offen sc1
    s_waitcnt vmcnt(0)
    v_xor_b32 v12, s11, v12
    v_xor_b32 v13, s11, v13
    v_xor_b32 v14, s11, v14
    v_xor_b32 v15, s11, v15
    v_or_b32 v12, v12, v13
    v_or3_b32 v12, v12, v14, v15
    v_cmp_ne_u32 vcc, 0, v12
    s_cmp_lg_u64 vcc, 0
    s_cbranch_scc1 L_retry_px_2
L_back_px_2:
    s_waitcnt lgkmcnt(0)
    s_barrier
    s_and_b32 s44, s3, 3
    s_mul_i32 s45, s44, 192
    s_mul_i32 s46, s44, 3072
    s_add_u32 s46, s46, 24576
    s_lshl_b32 s47, s7, 18
    s_mul_i32 s48, s6, 192
    s_add_u32 s47, s47, s48
    s_add_u32 s47, s47, 0x400000
    s_mov_b32 s48, 357913942
    v_add_u32 v10, s45, v0
    v_add_u32 v10, 0, v10
    v_mul_hi_u32 v11, v10, s48
    v_mul_u32_u24 v1, 12, v11
    v_sub_u32 v10, v10, v1
    v_lshlrev_b32 v11, 12, v11
    v_lshl_add_u32 v10, v10, 4, v11
    s_add_u32 m0, s46, 0
    s_nop 0
    buffer_load_dwordx4 v10, s[28:31], s47 offen sc1 lds
    v_add_u32 v10, s45, v0
    v_add_u32 v10, 64, v10
    v_mul_hi_u32 v11, v10, s48
    v_mul_u32_u24 v1, 12, v11
    v_sub_u32 v10, v10, v1
    v_lshlrev_b32 v11, 12, v11
    v_lshl_add_u32 v10, v10, 4, v11
    s_add_u32 m0, s46, 1024
    s_nop 0
    buffer_load_dwordx4 v10, s[28:31], s47 offen sc1 lds
    v_add_u32 v10, s45, v0
    v_add_u32 v10, 128, v10
    v_mul_hi_u32 v11, v10, s48
    v_mul_u32_u24 v1, 12, v11
    v_sub_u32 v10, v10, v1
    v_lshlrev_b32 v11, 12, v11
    v_lshl_add_u32 v10, v10, 4, v11
    s_add_u32 m0, s46, 2048
    s_nop 0
    buffer_load_dwordx4 v10, s[28:31], s47 offen sc1 lds
    s_waitcnt lgkmcnt(0)
    s_barrier
    v_and_b32 v10, 15, v0
    s_and_b32 s44, s3, 1
    s_mul_i32 s44, s44, 48
    v_add_u32 v11, s44, v10
    v_lshrrev_b32 v10, 1, v10
    v_lshrrev_b32 v1, 5, v0
    s_bfe_u32 s44, s3, 0x10001
    s_lshl_b32 s45, s44, 2
    v_or_b32 v1, s45, v1
    v_xor_b32 v10, v10, v1
    v_lshlrev_b32 v10, 4, v10
    v_lshl_add_u32 v11, v11, 7, v10
    v_bfe_u32 v10, v0, 4, 1
    v_lshl_add_u32 v11, v10, 3, v11
    v_add_u32 v11, 147456, v11
    v_xor_b32 v10, 32, v11
    ds_read_b64 v[40:41], v11 offset:0
    ds_read_b64 v[42:43], v10 offset:0
    ds_read_b64 v[44:45], v11 offset:2048
    ds_read_b64 v[46:47], v10 offset:2048
    ds_read_b64 v[48:49], v11 offset:4096
    ds_read_b64 v[50:51], v10 offset:4096
    v_lshrrev_b32 v64, 4, v0
    v_bfe_u32 v1, v0, 2, 2
    v_lshl_add_u32 v64, v64, 2, v1
    v_mul_u32_u24 v64, 192, v64
    v_and_b32 v1, 3, v0
    v_lshl_add_u32 v64, v1, 3, v64
    s_mul_i32 s44, s44, 6144
    s_and_b32 s45, s3, 1
    s_mul_i32 s45, s45, 96
    s_add_u32 s44, s44, s45
    s_add_u32 s44, s44, 24576
    v_add_u32 v64, s44, v64
    s_and_b32 s44, s3, 3
    s_mul_i32 s44, s44, 6144
    s_add_u32 s44, s44, 36864
    v_lshl_add_u32 v65, v0, 4, s44
    s_mov_b32 s47, 0xffff0000
    s_waitcnt lgkmcnt(0)
    v_lshlrev_b32 v16, 16, v40
    v_and_b32 v17, s47, v40
    v_lshlrev_b32 v18, 16, v41
    v_and_b32 v19, s47, v41
    v_lshlrev_b32 v20, 16, v42
    v_and_b32 v21, s47, v42
    v_lshlrev_b32 v22, 16, v43
    v_and_b32 v23, s47, v43
    v_lshlrev_b32 v24, 16, v44
    v_and_b32 v25, s47, v44
    v_lshlrev_b32 v26, 16, v45
    v_and_b32 v27, s47, v45
    v_lshlrev_b32 v28, 16, v46
    v_and_b32 v29, s47, v46
    v_lshlrev_b32 v30, 16, v47
    v_and_b32 v31, s47, v47
    v_lshlrev_b32 v32, 16, v48
    v_and_b32 v33, s47, v48
    v_lshlrev_b32 v34, 16, v49
    v_and_b32 v35, s47, v49
    v_lshlrev_b32 v36, 16, v50
    v_and_b32 v37, s47, v50
    v_lshlrev_b32 v38, 16, v51
    v_and_b32 v39, s47, v51
    s_waitcnt lgkmcnt(0)
    s_barrier
    s_waitcnt vmcnt(0)
    s_waitcnt lgkmcnt(0)
    s_barrier
    s_setprio 2
    ds_read_b64_tr_b16 v[52:53], v64 offset:0
    ds_read_b64_tr_b16 v[54:55], v64 offset:3072
    ds_read_b64_tr_b16 v[56:57], v64 offset:32
    ds_read_b64_tr_b16 v[58:59], v64 offset:3104
    ds_read_b64_tr_b16 v[60:61], v64 offset:64
    ds_read_b64_tr_b16 v[62:63], v64 offset:3136
    s_mov_b32 s47, 0xffff0000
    s_waitcnt lgkmcnt(5)
    v_lshlrev_b32 v68, 16, v52
    v_and_b32 v69, s47, v52
    v_lshlrev_b32 v70, 16, v53
    v_and_b32 v71, s47, v53
    v_add_f32 v16, v16, v68
    v_add_f32 v17, v17, v69
    v_add_f32 v18, v18, v70
    v_add_f32 v19, v19, v71
    ds_write_b128 v65, v[16:19] offset:0
    s_waitcnt lgkmcnt(5)
    v_lshlrev_b32 v72, 16, v54
    v_and_b32 v73, s47, v54
    v_lshlrev_b32 v74, 16, v55
    v_and_b32 v75, s47, v55
    v_add_f32 v20, v20, v72
    v_add_f32 v21, v21, v73
    v_add_f32 v22, v22, v74
    v_add_f32 v23, v23, v75
    ds_write_b128 v65, v[20:23] offset:1024
    s_waitcnt lgkmcnt(5)
    v_lshlrev_b32 v68, 16, v56
    v_and_b32 v69, s47, v56
    v_lshlrev_b32 v70, 16, v57
    v_and_b32 v71, s47, v57
    v_add_f32 v24, v24, v68
    v_add_f32 v25, v25, v69
    v_add_f32 v26, v26, v70
    v_add_f32 v27, v27, v71
    ds_write_b128 v65, v[24:27] offset:2048
    s_waitcnt lgkmcnt(5)
    v_lshlrev_b32 v72, 16, v58
    v_and_b32 v73, s47, v58
    v_lshlrev_b32 v74, 16, v59
    v_and_b32 v75, s47, v59
    v_add_f32 v28, v28, v72
    v_add_f32 v29, v29, v73
    v_add_f32 v30, v30, v74
    v_add_f32 v31, v31, v75
    ds_write_b128 v65, v[28:31] offset:3072
    s_waitcnt lgkmcnt(5)
    v_lshlrev_b32 v68, 16, v60
    v_and_b32 v69, s47, v60
    v_lshlrev_b32 v70, 16, v61
    v_and_b32 v71, s47, v61
    v_add_f32 v32, v32, v68
    v_add_f32 v33, v33, v69
    v_add_f32 v34, v34, v70
    v_add_f32 v35, v35, v71
    ds_write_b128 v65, v[32:35] offset:4096
    s_waitcnt lgkmcnt(5)
    v_lshlrev_b32 v72, 16, v62
    v_and_b32 v73, s47, v62
    v_lshlrev_b32 v74, 16, v63
    v_and_b32 v75, s47, v63
    v_add_f32 v36, v36, v72
    v_add_f32 v37, v37, v73
    v_add_f32 v38, v38, v74
    v_add_f32 v39, v39, v75
    ds_write_b128 v65, v[36:39] offset:5120
    s_waitcnt lgkmcnt(0)
    s_barrier
L_x_end:
    s_endpgm
L_mat:
    s_and_b32 s44, s3, 3
    s_lshl_b32 s44, s44, 5
    v_bfe_u32 v10, v0, 2, 1
    v_lshlrev_b32 v10, 4, v10
    v_lshrrev_b32 v11, 4, v0
    v_lshl_add_u32 v10, v11, 2, v10
    v_and_b32 v11, 3, v0
    v_add3_u32 v10, v10, v11, s44
    v_and_b32 v11, 15, v0
    v_cvt_f32_u32 v50, v11
    s_add_u32 s44, s9, s10
    s_sub_u32 s44, s44, 1
    v_mov_b32 v11, s44
    v_lshrrev_b32 v14, 7, v11
    v_lshlrev_b32 v14, 7, v14
    v_and_b32 v15, 63, v11
    v_lshl_add_u32 v14, v15, 1, v14
    v_bfe_u32 v15, v11, 6, 1
    v_add_lshl_u32 v11, v14, v15, 1
    v_lshlrev_b32 v1, 7, v11
    v_lshl_add_u32 v10, v10, 1, v1
    s_waitcnt lgkmcnt(0)
    global_load_ushort v108, v10, s[66:67]
    global_load_ushort v109, v10, s[68:69]
    global_load_ushort v110, v10, s[70:71]
    global_load_ushort v111, v10, s[72:73]
    global_load_ushort v112, v10, s[74:75]
    global_load_ushort v113, v10, s[76:77]
    global_load_ushort v114, v11, s[78:79]
    global_load_ushort v115, v11, s[80:81]
    s_mov_b32 s28, s94
    s_mov_b32 s29, s95
    s_mov_b32 s30, 0x10000000
    s_mov_b32 s31, 0x20000
    s_mov_b32 s36, s92
    s_mov_b32 s37, s93
    s_mov_b32 s38, 0x100
    s_mov_b32 s39, 0x20000
    s_mov_b32 s12, s64
    s_mov_b32 s13, s65
    s_mov_b32 s14, 0x280000
    s_mov_b32 s15, 0x20000
    s_mov_b32 s32, s90
    s_mov_b32 s33, s91
    s_mov_b32 s34, 0x280000
    s_mov_b32 s35, 0x20000
    v_lshrrev_b32 v10, 4, v0
    v_bfe_u32 v11, v0, 2, 2
    v_lshl_add_u32 v12, v10, 3, v11
    v_lshlrev_b32 v12, 7, v12
    v_and_b32 v13, 3, v0
    v_lshl_add_u32 v12, v13, 3, v12
    v_lshrrev_b32 v11, 1, v11
    v_and_b32 v10, 1, v10
    v_lshl_add_u32 v11, v10, 1, v11
    v_xor_b32 v1, 0, v11
    v_lshl_add_u32 v2, v1, 5, v12
    v_xor_b32 v1, 1, v11
    v_lshl_add_u32 v3, v1, 5, v12
    v_xor_b32 v1, 2, v11
    v_lshl_add_u32 v4, v1, 5, v12
    v_xor_b32 v1, 3, v11
    v_lshl_add_u32 v5, v1, 5, v12
    v_and_b32 v10, 15, v0
    v_lshrrev_b32 v11, 4, v0
    v_lshrrev_b32 v1, 1, v10
    v_xor_b32 v1, v1, v11
    v_lshlrev_b32 v1, 4, v1
    v_lshl_add_u32 v1, v10, 7, v1
    s_lshl_b32 s44, s3, 13
    s_add_u32 s44, s44, 49152
    v_add_u32 v6, s44, v1
    v_xor_b32 v7, 64, v6
    v_add_u32 v8, 0x10000, v6
    v_add_u32 v9, 0x10000, v7
    s_waitcnt vmcnt(0)
    v_mov_b32 v76, 0
    v_mov_b32 v77, 0
    v_mov_b32 v78, 0
    v_mov_b32 v79, 0
    v_mov_b32 v80, 0
    v_mov_b32 v81, 0
    v_mov_b32 v82, 0
    v_mov_b32 v83, 0
    v_mov_b32 v84, 0
    v_mov_b32 v85, 0
    v_mov_b32 v86, 0
    v_mov_b32 v87, 0
    v_mov_b32 v88, 0
    v_mov_b32 v89, 0
    v_mov_b32 v90, 0
    v_mov_b32 v91, 0
    s_mov_b32 s97, 0
    s_cmp_lt_u32 s10, 3
    s_cbranch_scc1 L_k3_skip_m
    v_lshlrev_b32 v114, 16, v114
    v_lshlrev_b32 v108, 16, v108
    v_lshlrev_b32 v109, 16, v109
    v_lshlrev_b32 v110, 16, v110
    v_lshlrev_b32 v111, 16, v111
    v_lshlrev_b32 v112, 16, v112
    v_lshlrev_b32 v113, 16, v113
    v_lshlrev_b32 v115, 16, v115
    v_mul_f32 v114, 0x3fb8aa3b, v114
    v_exp_f32 v114, v114
    v_readlane_b32 s97, v115, 0
    v_cvt_pk_bf16_f32 v114, v114, v114
    v_lshlrev_b32 v114, 16, v114
    v_mul_f32 v108, v114, v108
    v_mul_f32 v109, v114, v109
    v_mul_f32 v110, v114, v110
    v_mul_f32 v111, v114, v111
    v_mul_f32 v40, 0x3fb8aa3b, v108
    v_mul_f32 v109, 0x3e22f983, v109
    v_rndne_f32 v116, v109
    v_sub_f32 v41, v109, v116
    v_mul_f32 v42, v112, v110
    v_mul_f32 v43, v112, v111
    v_fma_f32 v42, -v113, v111, v42
    v_fmac_f32 v43, v113, v110
    s_and_b32 s44, s3, 3
    s_cmp_eq_u32 s44, 0
    s_cselect_b32 s97, s97, 0
    v_mul_f32 v117, 0x43800000, v41
    v_mul_f32 v116, 0x43800000, v40
    v_fract_f32 v117, v117
    v_exp_f32 v116, v116
    v_cos_f32 v118, v117
    v_sin_f32 v119, v117
    s_nop 0
    v_mul_f32 v118, v116, v118
    v_mul_f32 v119, v116, v119
    v_mul_f32 v44, v42, v118
    v_mul_f32 v45, v42, v119
    v_fma_f32 v44, -v43, v119, v44
    v_fmac_f32 v45, v43, v118
    v_mul_f32 v117, 0x44000000, v41
    v_mul_f32 v116, 0x44000000, v40
    v_fract_f32 v117, v117
    v_exp_f32 v116, v116
    v_cos_f32 v118, v117
    v_sin_f32 v119, v117
    s_nop 0
    v_mul_f32 v118, v116, v118
    v_mul_f32 v119, v116, v119
    v_mul_f32 v46, v42, v118
    v_mul_f32 v47, v42, v119
    v_fma_f32 v46, -v43, v119, v46
    v_fmac_f32 v47, v43, v118
    v_mul_f32 v117, 0x44c00000, v41
    v_mul_f32 v116, 0x44c00000, v40
    v_fract_f32 v117, v117
    v_exp_f32 v116, v116
    v_cos_f32 v118, v117
    v_sin_f32 v119, v117
    s_nop 0
    v_mul_f32 v118, v116, v118
    v_mul_f32 v119, v116, v119
    v_mul_f32 v48, v42, v118
    v_mul_f32 v49, v42, v119
    v_fma_f32 v48, -v43, v119, v48
    v_fmac_f32 v49, v43, v118
    v_mul_f32_dpp v121, v40, v50 row_newbcast:0 row_mask:0xf bank_mask:0xf
    v_mul_f32_dpp v127, v40, v50 row_newbcast:1 row_mask:0xf bank_mask:0xf
    v_mul_f32_dpp v120, v41, v50 row_newbcast:0 row_mask:0xf bank_mask:0xf
    v_mul_f32_dpp v126, v41, v50 row_newbcast:1 row_mask:0xf bank_mask:0xf
    v_exp_f32 v121, v121
    v_exp_f32 v127, v127
    v_cos_f32 v122, v120
    v_cos_f32 v128, v126
    v_sin_f32 v123, v120
    v_sin_f32 v129, v126
    v_mul_f32 v122, v121, v122
    v_mul_f32 v128, v127, v128
    v_mul_f32 v123, v121, v123
    v_mul_f32 v129, v127, v129
    v_cvt_pk_bf16_f32 v52, v122, v123
    v_cvt_pk_bf16_f32 v53, v128, v129
    v_pk_mul_f32 v[124:125], v[122:123], v[122:123] op_sel:[1,1] op_sel_hi:[0,1]
    v_pk_mul_f32 v[130:131], v[128:129], v[128:129] op_sel:[1,1] op_sel_hi:[0,1]
    v_pk_fma_f32 v[122:123], v[122:123], v[122:123], v[124:125] op_sel:[0,0,0] op_sel_hi:[0,1,1] neg_lo:[0,0,1]
    v_pk_fma_f32 v[128:129], v[128:129], v[128:129], v[130:131] op_sel:[0,0,0] op_sel_hi:[0,1,1] neg_lo:[0,0,1]
    v_pk_mul_f32 v[124:125], v[122:123], v[122:123] op_sel:[1,1] op_sel_hi:[0,1]
    v_pk_mul_f32 v[130:131], v[128:129], v[128:129] op_sel:[1,1] op_sel_hi:[0,1]
    v_pk_fma_f32 v[122:123], v[122:123], v[122:123], v[124:125] op_sel:[0,0,0] op_sel_hi:[0,1,1] neg_lo:[0,0,1]
    v_pk_fma_f32 v[128:129], v[128:129], v[128:129], v[130:131] op_sel:[0,0,0] op_sel_hi:[0,1,1] neg_lo:[0,0,1]
    v_cvt_pk_bf16_f32 v56, v122, v123
    v_cvt_pk_bf16_f32 v57, v128, v129
    v_pk_mul_f32 v[124:125], v[122:123], v[122:123] op_sel:[1,1] op_sel_hi:[0,1]
    v_pk_mul_f32 v[130:131], v[128:129], v[128:129] op_sel:[1,1] op_sel_hi:[0,1]
    v_pk_fma_f32 v[122:123], v[122:123], v[122:123], v[124:125] op_sel:[0,0,0] op_sel_hi:[0,1,1] neg_lo:[0,0,1]
    v_pk_fma_f32 v[128:129], v[128:129], v[128:129], v[130:131] op_sel:[0,0,0] op_sel_hi:[0,1,1] neg_lo:[0,0,1]
    v_pk_mul_f32 v[124:125], v[122:123], v[122:123] op_sel:[1,1] op_sel_hi:[0,1]
    v_pk_mul_f32 v[130:131], v[128:129], v[128:129] op_sel:[1,1] op_sel_hi:[0,1]
    v_pk_fma_f32 v[122:123], v[122:123], v[122:123], v[124:125] op_sel:[0,0,0] op_sel_hi:[0,1,1] neg_lo:[0,0,1]
    v_pk_fma_f32 v[128:129], v[128:129], v[128:129], v[130:131] op_sel:[0,0,0] op_sel_hi:[0,1,1] neg_lo:[0,0,1]
    v_mul_f32_dpp v124, v42, v122 row_newbcast:0 row_mask:0xf bank_mask:0xf
    v_mul_f32_dpp v130, v42, v128 row_newbcast:1 row_mask:0xf bank_mask:0xf
    v_mul_f32_dpp v125, -v42, v123 row_newbcast:0 row_mask:0xf bank_mask:0xf
    v_mul_f32_dpp v131, -v42, v129 row_newbcast:1 row_mask:0xf bank_mask:0xf
    v_fmac_f32_dpp v124, -v43, v123 row_newbcast:0 row_mask:0xf bank_mask:0xf
    v_fmac_f32_dpp v130, -v43, v129 row_newbcast:1 row_mask:0xf bank_mask:0xf
    v_fmac_f32_dpp v125, -v43, v122 row_newbcast:0 row_mask:0xf bank_mask:0xf
    v_fmac_f32_dpp v131, -v43, v128 row_newbcast:1 row_mask:0xf bank_mask:0xf
    v_cvt_pk_bf16_f32 v60, v124, v125
    v_cvt_pk_bf16_f32 v61, v130, v131
    v_mul_f32_dpp v124, v44, v122 row_newbcast:0 row_mask:0xf bank_mask:0xf
    v_mul_f32_dpp v130, v44, v128 row_newbcast:1 row_mask:0xf bank_mask:0xf
    v_mul_f32_dpp v125, -v44, v123 row_newbcast:0 row_mask:0xf bank_mask:0xf
    v_mul_f32_dpp v131, -v44, v129 row_newbcast:1 row_mask:0xf bank_mask:0xf
    v_fmac_f32_dpp v124, -v45, v123 row_newbcast:0 row_mask:0xf bank_mask:0xf
    v_fmac_f32_dpp v130, -v45, v129 row_newbcast:1 row_mask:0xf bank_mask:0xf
    v_fmac_f32_dpp v125, -v45, v122 row_newbcast:0 row_mask:0xf bank_mask:0xf
    v_fmac_f32_dpp v131, -v45, v128 row_newbcast:1 row_mask:0xf bank_mask:0xf
    v_cvt_pk_bf16_f32 v64, v124, v125
    v_cvt_pk_bf16_f32 v65, v130, v131
    v_pk_mul_f32 v[124:125], v[122:123], v[122:123] op_sel:[1,1] op_sel_hi:[0,1]
    v_pk_mul_f32 v[130:131], v[128:129], v[128:129] op_sel:[1,1] op_sel_hi:[0,1]
    v_pk_fma_f32 v[122:123], v[122:123], v[122:123], v[124:125] op_sel:[0,0,0] op_sel_hi:[0,1,1] neg_lo:[0,0,1]
    v_pk_fma_f32 v[128:129], v[128:129], v[128:129], v[130:131] op_sel:[0,0,0] op_sel_hi:[0,1,1] neg_lo:[0,0,1]
    v_pk_mul_f32 v[124:125], v[122:123], v[122:123] op_sel:[1,1] op_sel_hi:[0,1]
    v_pk_mul_f32 v[130:131], v[128:129], v[128:129] op_sel:[1,1] op_sel_hi:[0,1]
    v_pk_fma_f32 v[122:123], v[122:123], v[122:123], v[124:125] op_sel:[0,0,0] op_sel_hi:[0,1,1] neg_lo:[0,0,1]
    v_pk_fma_f32 v[128:129], v[128:129], v[128:129], v[130:131] op_sel:[0,0,0] op_sel_hi:[0,1,1] neg_lo:[0,0,1]
    v_mul_f32_dpp v124, v46, v122 row_newbcast:0 row_mask:0xf bank_mask:0xf
    v_mul_f32_dpp v130, v46, v128 row_newbcast:1 row_mask:0xf bank_mask:0xf
    v_mul_f32_dpp v125, -v46, v123 row_newbcast:0 row_mask:0xf bank_mask:0xf
    v_mul_f32_dpp v131, -v46, v129 row_newbcast:1 row_mask:0xf bank_mask:0xf
    v_fmac_f32_dpp v124, -v47, v123 row_newbcast:0 row_mask:0xf bank_mask:0xf
    v_fmac_f32_dpp v130, -v47, v129 row_newbcast:1 row_mask:0xf bank_mask:0xf
    v_fmac_f32_dpp v125, -v47, v122 row_newbcast:0 row_mask:0xf bank_mask:0xf
    v_fmac_f32_dpp v131, -v47, v128 row_newbcast:1 row_mask:0xf bank_mask:0xf
    v_cvt_pk_bf16_f32 v68, v124, v125
    v_cvt_pk_bf16_f32 v69, v130, v131
    v_mul_f32_dpp v124, v48, v122 row_newbcast:0 row_mask:0xf bank_mask:0xf
    v_mul_f32_dpp v130, v48, v128 row_newbcast:1 row_mask:0xf bank_mask:0xf
    v_mul_f32_dpp v125, -v48, v123 row_newbcast:0 row_mask:0xf bank_mask:0xf
    v_mul_f32_dpp v131, -v48, v129 row_newbcast:1 row_mask:0xf bank_mask:0xf
    v_fmac_f32_dpp v124, -v49, v123 row_newbcast:0 row_mask:0xf bank_mask:0xf
    v_fmac_f32_dpp v130, -v49, v129 row_newbcast:1 row_mask:0xf bank_mask:0xf
    v_fmac_f32_dpp v125, -v49, v122 row_newbcast:0 row_mask:0xf bank_mask:0xf
    v_fmac_f32_dpp v131, -v49, v128 row_newbcast:1 row_mask:0xf bank_mask:0xf
    v_cvt_pk_bf16_f32 v72, v124, v125
    v_cvt_pk_bf16_f32 v73, v130, v131
    v_mul_f32_dpp v121, v40, v50 row_newbcast:2 row_mask:0xf bank_mask:0xf
    v_mul_f32_dpp v127, v40, v50 row_newbcast:3 row_mask:0xf bank_mask:0xf
    v_mul_f32_dpp v120, v41, v50 row_newbcast:2 row_mask:0xf bank_mask:0xf
    v_mul_f32_dpp v126, v41, v50 row_newbcast:3 row_mask:0xf bank_mask:0xf
    v_exp_f32 v121, v121
    v_exp_f32 v127, v127
    v_cos_f32 v122, v120
    v_cos_f32 v128, v126
    v_sin_f32 v123, v120
    v_sin_f32 v129, v126
    v_mul_f32 v122, v121, v122
    v_mul_f32 v128, v127, v128
    v_mul_f32 v123, v121, v123
    v_mul_f32 v129, v127, v129
    v_cvt_pk_bf16_f32 v54, v122, v123
    v_cvt_pk_bf16_f32 v55, v128, v129
    v_pk_mul_f32 v[124:125], v[122:123], v[122:123] op_sel:[1,1] op_sel_hi:[0,1]
    v_pk_mul_f32 v[130:131], v[128:129], v[128:129] op_sel:[1,1] op_sel_hi:[0,1]
    v_pk_fma_f32 v[122:123], v[122:123], v[122:123], v[124:125] op_sel:[0,0,0] op_sel_hi:[0,1,1] neg_lo:[0,0,1]
    v_pk_fma_f32 v[128:129], v[128:129], v[128:129], v[130:131] op_sel:[0,0,0] op_sel_hi:[0,1,1] neg_lo:[0,0,1]
    v_pk_mul_f32 v[124:125], v[122:123], v[122:123] op_sel:[1,1] op_sel_hi:[0,1]
    v_pk_mul_f32 v[130:131], v[128:129], v[128:129] op_sel:[1,1] op_sel_hi:[0,1]
    v_pk_fma_f32 v[122:123], v[122:123], v[122:123], v[124:125] op_sel:[0,0,0] op_sel_hi:[0,1,1] neg_lo:[0,0,1]
    v_pk_fma_f32 v[128:129], v[128:129], v[128:129], v[130:131] op_sel:[0,0,0] op_sel_hi:[0,1,1] neg_lo:[0,0,1]
    v_cvt_pk_bf16_f32 v58, v122, v123
    v_cvt_pk_bf16_f32 v59, v128, v129
    v_pk_mul_f32 v[124:125], v[122:123], v[122:123] op_sel:[1,1] op_sel_hi:[0,1]
    v_pk_mul_f32 v[130:131], v[128:129], v[128:129] op_sel:[1,1] op_sel_hi:[0,1]
    v_pk_fma_f32 v[122:123], v[122:123], v[122:123], v[124:125] op_sel:[0,0,0] op_sel_hi:[0,1,1] neg_lo:[0,0,1]
    v_pk_fma_f32 v[128:129], v[128:129], v[128:129], v[130:131] op_sel:[0,0,0] op_sel_hi:[0,1,1] neg_lo:[0,0,1]
    v_pk_mul_f32 v[124:125], v[122:123], v[122:123] op_sel:[1,1] op_sel_hi:[0,1]
    v_pk_mul_f32 v[130:131], v[128:129], v[128:129] op_sel:[1,1] op_sel_hi:[0,1]
    v_pk_fma_f32 v[122:123], v[122:123], v[122:123], v[124:125] op_sel:[0,0,0] op_sel_hi:[0,1,1] neg_lo:[0,0,1]
    v_pk_fma_f32 v[128:129], v[128:129], v[128:129], v[130:131] op_sel:[0,0,0] op_sel_hi:[0,1,1] neg_lo:[0,0,1]
    v_mul_f32_dpp v124, v42, v122 row_newbcast:2 row_mask:0xf bank_mask:0xf
    v_mul_f32_dpp v130, v42, v128 row_newbcast:3 row_mask:0xf bank_mask:0xf
    v_mul_f32_dpp v125, -v42, v123 row_newbcast:2 row_mask:0xf bank_mask:0xf
    v_mul_f32_dpp v131, -v42, v129 row_newbcast:3 row_mask:0xf bank_mask:0xf
    v_fmac_f32_dpp v124, -v43, v123 row_newbcast:2 row_mask:0xf bank_mask:0xf
    v_fmac_f32_dpp v130, -v43, v129 row_newbcast:3 row_mask:0xf bank_mask:0xf
    v_fmac_f32_dpp v125, -v43, v122 row_newbcast:2 row_mask:0xf bank_mask:0xf
    v_fmac_f32_dpp v131, -v43, v128 row_newbcast:3 row_mask:0xf bank_mask:0xf
    v_cvt_pk_bf16_f32 v62, v124, v125
    v_cvt_pk_bf16_f32 v63, v130, v131
    v_mul_f32_dpp v124, v44, v122 row_newbcast:2 row_mask:0xf bank_mask:0xf
    v_mul_f32_dpp v130, v44, v128 row_newbcast:3 row_mask:0xf bank_mask:0xf
    v_mul_f32_dpp v125, -v44, v123 row_newbcast:2 row_mask:0xf bank_mask:0xf
    v_mul_f32_dpp v131, -v44, v129 row_newbcast:3 row_mask:0xf bank_mask:0xf
    v_fmac_f32_dpp v124, -v45, v123 row_newbcast:2 row_mask:0xf bank_mask:0xf
    v_fmac_f32_dpp v130, -v45, v129 row_newbcast:3 row_mask:0xf bank_mask:0xf
    v_fmac_f32_dpp v125, -v45, v122 row_newbcast:2 row_mask:0xf bank_mask:0xf
    v_fmac_f32_dpp v131, -v45, v128 row_newbcast:3 row_mask:0xf bank_mask:0xf
    v_cvt_pk_bf16_f32 v66, v124, v125
    v_cvt_pk_bf16_f32 v67, v130, v131
    v_pk_mul_f32 v[124:125], v[122:123], v[122:123] op_sel:[1,1] op_sel_hi:[0,1]
    v_pk_mul_f32 v[130:131], v[128:129], v[128:129] op_sel:[1,1] op_sel_hi:[0,1]
    v_pk_fma_f32 v[122:123], v[122:123], v[122:123], v[124:125] op_sel:[0,0,0] op_sel_hi:[0,1,1] neg_lo:[0,0,1]
    v_pk_fma_f32 v[128:129], v[128:129], v[128:129], v[130:131] op_sel:[0,0,0] op_sel_hi:[0,1,1] neg_lo:[0,0,1]
    v_pk_mul_f32 v[124:125], v[122:123], v[122:123] op_sel:[1,1] op_sel_hi:[0,1]
    v_pk_mul_f32 v[130:131], v[128:129], v[128:129] op_sel:[1,1] op_sel_hi:[0,1]
    v_pk_fma_f32 v[122:123], v[122:123], v[122:123], v[124:125] op_sel:[0,0,0] op_sel_hi:[0,1,1] neg_lo:[0,0,1]
    v_pk_fma_f32 v[128:129], v[128:129], v[128:129], v[130:131] op_sel:[0,0,0] op_sel_hi:[0,1,1] neg_lo:[0,0,1]
    v_mul_f32_dpp v124, v46, v122 row_newbcast:2 row_mask:0xf bank_mask:0xf
    v_mul_f32_dpp v130, v46, v128 row_newbcast:3 row_mask:0xf bank_mask:0xf
    v_mul_f32_dpp v125, -v46, v123 row_newbcast:2 row_mask:0xf bank_mask:0xf
    v_mul_f32_dpp v131, -v46, v129 row_newbcast:3 row_mask:0xf bank_mask:0xf
    v_fmac_f32_dpp v124, -v47, v123 row_newbcast:2 row_mask:0xf bank_mask:0xf
    v_fmac_f32_dpp v130, -v47, v129 row_newbcast:3 row_mask:0xf bank_mask:0xf
    v_fmac_f32_dpp v125, -v47, v122 row_newbcast:2 row_mask:0xf bank_mask:0xf
    v_fmac_f32_dpp v131, -v47, v128 row_newbcast:3 row_mask:0xf bank_mask:0xf
    v_cvt_pk_bf16_f32 v70, v124, v125
    v_cvt_pk_bf16_f32 v71, v130, v131
    v_mul_f32_dpp v124, v48, v122 row_newbcast:2 row_mask:0xf bank_mask:0xf
    v_mul_f32_dpp v130, v48, v128 row_newbcast:3 row_mask:0xf bank_mask:0xf
    v_mul_f32_dpp v125, -v48, v123 row_newbcast:2 row_mask:0xf bank_mask:0xf
    v_mul_f32_dpp v131, -v48, v129 row_newbcast:3 row_mask:0xf bank_mask:0xf
    v_fmac_f32_dpp v124, -v49, v123 row_newbcast:2 row_mask:0xf bank_mask:0xf
    v_fmac_f32_dpp v130, -v49, v129 row_newbcast:3 row_mask:0xf bank_mask:0xf
    v_fmac_f32_dpp v125, -v49, v122 row_newbcast:2 row_mask:0xf bank_mask:0xf
    v_fmac_f32_dpp v131, -v49, v128 row_newbcast:3 row_mask:0xf bank_mask:0xf
    v_cvt_pk_bf16_f32 v74, v124, v125
    v_cvt_pk_bf16_f32 v75, v130, v131
    s_nop 1
    v_mfma_f32_16x16x32_bf16 v[76:79], v[52:55], v[60:63], 0
    v_mfma_f32_16x16x32_bf16 v[84:87], v[52:55], v[64:67], 0
    v_mfma_f32_16x16x32_bf16 v[80:83], v[56:59], v[68:71], 0
    v_mfma_f32_16x16x32_bf16 v[88:91], v[56:59], v[72:75], 0
    v_mul_f32_dpp v121, v40, v50 row_newbcast:4 row_mask:0xf bank_mask:0xf
    v_mul_f32_dpp v127, v40, v50 row_newbcast:5 row_mask:0xf bank_mask:0xf
    v_mul_f32_dpp v120, v41, v50 row_newbcast:4 row_mask:0xf bank_mask:0xf
    v_mul_f32_dpp v126, v41, v50 row_newbcast:5 row_mask:0xf bank_mask:0xf
    v_exp_f32 v121, v121
    v_exp_f32 v127, v127
    v_cos_f32 v122, v120
    v_cos_f32 v128, v126
    v_sin_f32 v123, v120
    v_sin_f32 v129, v126
    v_mul_f32 v122, v121, v122
    v_mul_f32 v128, v127, v128
    v_mul_f32 v123, v121, v123
    v_mul_f32 v129, v127, v129
    v_cvt_pk_bf16_f32 v52, v122, v123
    v_cvt_pk_bf16_f32 v53, v128, v129
    v_pk_mul_f32 v[124:125], v[122:123], v[122:123] op_sel:[1,1] op_sel_hi:[0,1]
    v_pk_mul_f32 v[130:131], v[128:129], v[128:129] op_sel:[1,1] op_sel_hi:[0,1]
    v_pk_fma_f32 v[122:123], v[122:123], v[122:123], v[124:125] op_sel:[0,0,0] op_sel_hi:[0,1,1] neg_lo:[0,0,1]
    v_pk_fma_f32 v[128:129], v[128:129], v[128:129], v[130:131] op_sel:[0,0,0] op_sel_hi:[0,1,1] neg_lo:[0,0,1]
    v_pk_mul_f32 v[124:125], v[122:123], v[122:123] op_sel:[1,1] op_sel_hi:[0,1]
    v_pk_mul_f32 v[130:131], v[128:129], v[128:129] op_sel:[1,1] op_sel_hi:[0,1]
    v_pk_fma_f32 v[122:123], v[122:123], v[122:123], v[124:125] op_sel:[0,0,0] op_sel_hi:[0,1,1] neg_lo:[0,0,1]
    v_pk_fma_f32 v[128:129], v[128:129], v[128:129], v[130:131] op_sel:[0,0,0] op_sel_hi:[0,1,1] neg_lo:[0,0,1]
    v_cvt_pk_bf16_f32 v56, v122, v123
    v_cvt_pk_bf16_f32 v57, v128, v129
    v_pk_mul_f32 v[124:125], v[122:123], v[122:123] op_sel:[1,1] op_sel_hi:[0,1]
    v_pk_mul_f32 v[130:131], v[128:129], v[128:129] op_sel:[1,1] op_sel_hi:[0,1]
    v_pk_fma_f32 v[122:123], v[122:123], v[122:123], v[124:125] op_sel:[0,0,0] op_sel_hi:[0,1,1] neg_lo:[0,0,1]
    v_pk_fma_f32 v[128:129], v[128:129], v[128:129], v[130:131] op_sel:[0,0,0] op_sel_hi:[0,1,1] neg_lo:[0,0,1]
    v_pk_mul_f32 v[124:125], v[122:123], v[122:123] op_sel:[1,1] op_sel_hi:[0,1]
    v_pk_mul_f32 v[130:131], v[128:129], v[128:129] op_sel:[1,1] op_sel_hi:[0,1]
    v_pk_fma_f32 v[122:123], v[122:123], v[122:123], v[124:125] op_sel:[0,0,0] op_sel_hi:[0,1,1] neg_lo:[0,0,1]
    v_pk_fma_f32 v[128:129], v[128:129], v[128:129], v[130:131] op_sel:[0,0,0] op_sel_hi:[0,1,1] neg_lo:[0,0,1]
    v_mul_f32_dpp v124, v42, v122 row_newbcast:4 row_mask:0xf bank_mask:0xf
    v_mul_f32_dpp v130, v42, v128 row_newbcast:5 row_mask:0xf bank_mask:0xf
    v_mul_f32_dpp v125, -v42, v123 row_newbcast:4 row_mask:0xf bank_mask:0xf
    v_mul_f32_dpp v131, -v42, v129 row_newbcast:5 row_mask:0xf bank_mask:0xf
    v_fmac_f32_dpp v124, -v43, v123 row_newbcast:4 row_mask:0xf bank_mask:0xf
    v_fmac_f32_dpp v130, -v43, v129 row_newbcast:5 row_mask:0xf bank_mask:0xf
    v_fmac_f32_dpp v125, -v43, v122 row_newbcast:4 row_mask:0xf bank_mask:0xf
    v_fmac_f32_dpp v131, -v43, v128 row_newbcast:5 row_mask:0xf bank_mask:0xf
    v_cvt_pk_bf16_f32 v60, v124, v125
    v_cvt_pk_bf16_f32 v61, v130, v131
    v_mul_f32_dpp v124, v44, v122 row_newbcast:4 row_mask:0xf bank_mask:0xf
    v_mul_f32_dpp v130, v44, v128 row_newbcast:5 row_mask:0xf bank_mask:0xf
    v_mul_f32_dpp v125, -v44, v123 row_newbcast:4 row_mask:0xf bank_mask:0xf
    v_mul_f32_dpp v131, -v44, v129 row_newbcast:5 row_mask:0xf bank_mask:0xf
    v_fmac_f32_dpp v124, -v45, v123 row_newbcast:4 row_mask:0xf bank_mask:0xf
    v_fmac_f32_dpp v130, -v45, v129 row_newbcast:5 row_mask:0xf bank_mask:0xf
    v_fmac_f32_dpp v125, -v45, v122 row_newbcast:4 row_mask:0xf bank_mask:0xf
    v_fmac_f32_dpp v131, -v45, v128 row_newbcast:5 row_mask:0xf bank_mask:0xf
    v_cvt_pk_bf16_f32 v64, v124, v125
    v_cvt_pk_bf16_f32 v65, v130, v131
    v_pk_mul_f32 v[124:125], v[122:123], v[122:123] op_sel:[1,1] op_sel_hi:[0,1]
    v_pk_mul_f32 v[130:131], v[128:129], v[128:129] op_sel:[1,1] op_sel_hi:[0,1]
    v_pk_fma_f32 v[122:123], v[122:123], v[122:123], v[124:125] op_sel:[0,0,0] op_sel_hi:[0,1,1] neg_lo:[0,0,1]
    v_pk_fma_f32 v[128:129], v[128:129], v[128:129], v[130:131] op_sel:[0,0,0] op_sel_hi:[0,1,1] neg_lo:[0,0,1]
    v_pk_mul_f32 v[124:125], v[122:123], v[122:123] op_sel:[1,1] op_sel_hi:[0,1]
    v_pk_mul_f32 v[130:131], v[128:129], v[128:129] op_sel:[1,1] op_sel_hi:[0,1]
    v_pk_fma_f32 v[122:123], v[122:123], v[122:123], v[124:125] op_sel:[0,0,0] op_sel_hi:[0,1,1] neg_lo:[0,0,1]
    v_pk_fma_f32 v[128:129], v[128:129], v[128:129], v[130:131] op_sel:[0,0,0] op_sel_hi:[0,1,1] neg_lo:[0,0,1]
    v_mul_f32_dpp v124, v46, v122 row_newbcast:4 row_mask:0xf bank_mask:0xf
    v_mul_f32_dpp v130, v46, v128 row_newbcast:5 row_mask:0xf bank_mask:0xf
    v_mul_f32_dpp v125, -v46, v123 row_newbcast:4 row_mask:0xf bank_mask:0xf
    v_mul_f32_dpp v131, -v46, v129 row_newbcast:5 row_mask:0xf bank_mask:0xf
    v_fmac_f32_dpp v124, -v47, v123 row_newbcast:4 row_mask:0xf bank_mask:0xf
    v_fmac_f32_dpp v130, -v47, v129 row_newbcast:5 row_mask:0xf bank_mask:0xf
    v_fmac_f32_dpp v125, -v47, v122 row_newbcast:4 row_mask:0xf bank_mask:0xf
    v_fmac_f32_dpp v131, -v47, v128 row_newbcast:5 row_mask:0xf bank_mask:0xf
    v_cvt_pk_bf16_f32 v68, v124, v125
    v_cvt_pk_bf16_f32 v69, v130, v131
    v_mul_f32_dpp v124, v48, v122 row_newbcast:4 row_mask:0xf bank_mask:0xf
    v_mul_f32_dpp v130, v48, v128 row_newbcast:5 row_mask:0xf bank_mask:0xf
    v_mul_f32_dpp v125, -v48, v123 row_newbcast:4 row_mask:0xf bank_mask:0xf
    v_mul_f32_dpp v131, -v48, v129 row_newbcast:5 row_mask:0xf bank_mask:0xf
    v_fmac_f32_dpp v124, -v49, v123 row_newbcast:4 row_mask:0xf bank_mask:0xf
    v_fmac_f32_dpp v130, -v49, v129 row_newbcast:5 row_mask:0xf bank_mask:0xf
    v_fmac_f32_dpp v125, -v49, v122 row_newbcast:4 row_mask:0xf bank_mask:0xf
    v_fmac_f32_dpp v131, -v49, v128 row_newbcast:5 row_mask:0xf bank_mask:0xf
    v_cvt_pk_bf16_f32 v72, v124, v125
    v_cvt_pk_bf16_f32 v73, v130, v131
    v_mul_f32_dpp v121, v40, v50 row_newbcast:6 row_mask:0xf bank_mask:0xf
    v_mul_f32_dpp v127, v40, v50 row_newbcast:7 row_mask:0xf bank_mask:0xf
    v_mul_f32_dpp v120, v41, v50 row_newbcast:6 row_mask:0xf bank_mask:0xf
    v_mul_f32_dpp v126, v41, v50 row_newbcast:7 row_mask:0xf bank_mask:0xf
    v_exp_f32 v121, v121
    v_exp_f32 v127, v127
    v_cos_f32 v122, v120
    v_cos_f32 v128, v126
    v_sin_f32 v123, v120
    v_sin_f32 v129, v126
    v_mul_f32 v122, v121, v122
    v_mul_f32 v128, v127, v128
    v_mul_f32 v123, v121, v123
    v_mul_f32 v129, v127, v129
    v_cvt_pk_bf16_f32 v54, v122, v123
    v_cvt_pk_bf16_f32 v55, v128, v129
    v_pk_mul_f32 v[124:125], v[122:123], v[122:123] op_sel:[1,1] op_sel_hi:[0,1]
    v_pk_mul_f32 v[130:131], v[128:129], v[128:129] op_sel:[1,1] op_sel_hi:[0,1]
    v_pk_fma_f32 v[122:123], v[122:123], v[122:123], v[124:125] op_sel:[0,0,0] op_sel_hi:[0,1,1] neg_lo:[0,0,1]
    v_pk_fma_f32 v[128:129], v[128:129], v[128:129], v[130:131] op_sel:[0,0,0] op_sel_hi:[0,1,1] neg_lo:[0,0,1]
    v_pk_mul_f32 v[124:125], v[122:123], v[122:123] op_sel:[1,1] op_sel_hi:[0,1]
    v_pk_mul_f32 v[130:131], v[128:129], v[128:129] op_sel:[1,1] op_sel_hi:[0,1]
    v_pk_fma_f32 v[122:123], v[122:123], v[122:123], v[124:125] op_sel:[0,0,0] op_sel_hi:[0,1,1] neg_lo:[0,0,1]
    v_pk_fma_f32 v[128:129], v[128:129], v[128:129], v[130:131] op_sel:[0,0,0] op_sel_hi:[0,1,1] neg_lo:[0,0,1]
    v_cvt_pk_bf16_f32 v58, v122, v123
    v_cvt_pk_bf16_f32 v59, v128, v129
    v_pk_mul_f32 v[124:125], v[122:123], v[122:123] op_sel:[1,1] op_sel_hi:[0,1]
    v_pk_mul_f32 v[130:131], v[128:129], v[128:129] op_sel:[1,1] op_sel_hi:[0,1]
    v_pk_fma_f32 v[122:123], v[122:123], v[122:123], v[124:125] op_sel:[0,0,0] op_sel_hi:[0,1,1] neg_lo:[0,0,1]
    v_pk_fma_f32 v[128:129], v[128:129], v[128:129], v[130:131] op_sel:[0,0,0] op_sel_hi:[0,1,1] neg_lo:[0,0,1]
    v_pk_mul_f32 v[124:125], v[122:123], v[122:123] op_sel:[1,1] op_sel_hi:[0,1]
    v_pk_mul_f32 v[130:131], v[128:129], v[128:129] op_sel:[1,1] op_sel_hi:[0,1]
    v_pk_fma_f32 v[122:123], v[122:123], v[122:123], v[124:125] op_sel:[0,0,0] op_sel_hi:[0,1,1] neg_lo:[0,0,1]
    v_pk_fma_f32 v[128:129], v[128:129], v[128:129], v[130:131] op_sel:[0,0,0] op_sel_hi:[0,1,1] neg_lo:[0,0,1]
    v_mul_f32_dpp v124, v42, v122 row_newbcast:6 row_mask:0xf bank_mask:0xf
    v_mul_f32_dpp v130, v42, v128 row_newbcast:7 row_mask:0xf bank_mask:0xf
    v_mul_f32_dpp v125, -v42, v123 row_newbcast:6 row_mask:0xf bank_mask:0xf
    v_mul_f32_dpp v131, -v42, v129 row_newbcast:7 row_mask:0xf bank_mask:0xf
    v_fmac_f32_dpp v124, -v43, v123 row_newbcast:6 row_mask:0xf bank_mask:0xf
    v_fmac_f32_dpp v130, -v43, v129 row_newbcast:7 row_mask:0xf bank_mask:0xf
    v_fmac_f32_dpp v125, -v43, v122 row_newbcast:6 row_mask:0xf bank_mask:0xf
    v_fmac_f32_dpp v131, -v43, v128 row_newbcast:7 row_mask:0xf bank_mask:0xf
    v_cvt_pk_bf16_f32 v62, v124, v125
    v_cvt_pk_bf16_f32 v63, v130, v131
    v_mul_f32_dpp v124, v44, v122 row_newbcast:6 row_mask:0xf bank_mask:0xf
    v_mul_f32_dpp v130, v44, v128 row_newbcast:7 row_mask:0xf bank_mask:0xf
    v_mul_f32_dpp v125, -v44, v123 row_newbcast:6 row_mask:0xf bank_mask:0xf
    v_mul_f32_dpp v131, -v44, v129 row_newbcast:7 row_mask:0xf bank_mask:0xf
    v_fmac_f32_dpp v124, -v45, v123 row_newbcast:6 row_mask:0xf bank_mask:0xf
    v_fmac_f32_dpp v130, -v45, v129 row_newbcast:7 row_mask:0xf bank_mask:0xf
    v_fmac_f32_dpp v125, -v45, v122 row_newbcast:6 row_mask:0xf bank_mask:0xf
    v_fmac_f32_dpp v131, -v45, v128 row_newbcast:7 row_mask:0xf bank_mask:0xf
    v_cvt_pk_bf16_f32 v66, v124, v125
    v_cvt_pk_bf16_f32 v67, v130, v131
    v_pk_mul_f32 v[124:125], v[122:123], v[122:123] op_sel:[1,1] op_sel_hi:[0,1]
    v_pk_mul_f32 v[130:131], v[128:129], v[128:129] op_sel:[1,1] op_sel_hi:[0,1]
    v_pk_fma_f32 v[122:123], v[122:123], v[122:123], v[124:125] op_sel:[0,0,0] op_sel_hi:[0,1,1] neg_lo:[0,0,1]
    v_pk_fma_f32 v[128:129], v[128:129], v[128:129], v[130:131] op_sel:[0,0,0] op_sel_hi:[0,1,1] neg_lo:[0,0,1]
    v_pk_mul_f32 v[124:125], v[122:123], v[122:123] op_sel:[1,1] op_sel_hi:[0,1]
    v_pk_mul_f32 v[130:131], v[128:129], v[128:129] op_sel:[1,1] op_sel_hi:[0,1]
    v_pk_fma_f32 v[122:123], v[122:123], v[122:123], v[124:125] op_sel:[0,0,0] op_sel_hi:[0,1,1] neg_lo:[0,0,1]
    v_pk_fma_f32 v[128:129], v[128:129], v[128:129], v[130:131] op_sel:[0,0,0] op_sel_hi:[0,1,1] neg_lo:[0,0,1]
    v_mul_f32_dpp v124, v46, v122 row_newbcast:6 row_mask:0xf bank_mask:0xf
    v_mul_f32_dpp v130, v46, v128 row_newbcast:7 row_mask:0xf bank_mask:0xf
    v_mul_f32_dpp v125, -v46, v123 row_newbcast:6 row_mask:0xf bank_mask:0xf
    v_mul_f32_dpp v131, -v46, v129 row_newbcast:7 row_mask:0xf bank_mask:0xf
    v_fmac_f32_dpp v124, -v47, v123 row_newbcast:6 row_mask:0xf bank_mask:0xf
    v_fmac_f32_dpp v130, -v47, v129 row_newbcast:7 row_mask:0xf bank_mask:0xf
    v_fmac_f32_dpp v125, -v47, v122 row_newbcast:6 row_mask:0xf bank_mask:0xf
    v_fmac_f32_dpp v131, -v47, v128 row_newbcast:7 row_mask:0xf bank_mask:0xf
    v_cvt_pk_bf16_f32 v70, v124, v125
    v_cvt_pk_bf16_f32 v71, v130, v131
    v_mul_f32_dpp v124, v48, v122 row_newbcast:6 row_mask:0xf bank_mask:0xf
    v_mul_f32_dpp v130, v48, v128 row_newbcast:7 row_mask:0xf bank_mask:0xf
    v_mul_f32_dpp v125, -v48, v123 row_newbcast:6 row_mask:0xf bank_mask:0xf
    v_mul_f32_dpp v131, -v48, v129 row_newbcast:7 row_mask:0xf bank_mask:0xf
    v_fmac_f32_dpp v124, -v49, v123 row_newbcast:6 row_mask:0xf bank_mask:0xf
    v_fmac_f32_dpp v130, -v49, v129 row_newbcast:7 row_mask:0xf bank_mask:0xf
    v_fmac_f32_dpp v125, -v49, v122 row_newbcast:6 row_mask:0xf bank_mask:0xf
    v_fmac_f32_dpp v131, -v49, v128 row_newbcast:7 row_mask:0xf bank_mask:0xf
    v_cvt_pk_bf16_f32 v74, v124, v125
    v_cvt_pk_bf16_f32 v75, v130, v131
    s_nop 1
    v_mfma_f32_16x16x32_bf16 v[76:79], v[52:55], v[60:63], v[76:79]
    v_mfma_f32_16x16x32_bf16 v[84:87], v[52:55], v[64:67], v[84:87]
    v_mfma_f32_16x16x32_bf16 v[80:83], v[56:59], v[68:71], v[80:83]
    v_mfma_f32_16x16x32_bf16 v[88:91], v[56:59], v[72:75], v[88:91]
L_k3_skip_m:
    s_nop 7
    s_and_b32 s44, s3, 3
    s_mul_i32 s44, s44, 3072
    s_add_u32 s44, s44, 147456
    v_lshl_add_u32 v1, v0, 4, s44
    s_mov_b64 exec, 1
    v_add_f32 v76, s97, v76
    s_mov_b64 exec, -1
    v_mov_b32 v85, v86
    v_mov_b32 v86, v88
    v_mov_b32 v87, v90
    ds_write_b128 v1, v[76:79] offset:0
    ds_write_b128 v1, v[80:83] offset:1024
    ds_write_b128 v1, v[84:87] offset:2048
    s_lshl_b32 s44, s4, 4
    s_lshl_b32 s45, s3, 2
    s_add_u32 s44, s44, s45
    s_mul_i32 s44, s44, 55296
    s_add_u32 s44, s44, 0x800000
    v_mul_u32_u24 v1, 55296, v0
    s_mov_b64 exec, 0xf
    buffer_load_dword v252, v1, s[28:31], s44 offen
    s_mov_b64 exec, 0xff
    v_lshlrev_b32 v1, 21, v0
    buffer_load_dword v254, v1, s[28:31], 0 offen
    s_mov_b64 exec, -1
    s_waitcnt lgkmcnt(0)
    s_barrier
    ds_read_b128 v[208:211], v6 offset:0
    ds_read_b128 v[212:215], v6 offset:2048
    ds_read_b128 v[216:219], v6 offset:4096
    ds_read_b128 v[220:223], v6 offset:6144
    ds_read_b64_tr_b16 v[144:145], v2 offset:0
    ds_read_b64_tr_b16 v[146:147], v2 offset:512
    ds_read_b64_tr_b16 v[148:149], v3 offset:0
    ds_read_b64_tr_b16 v[150:151], v3 offset:512
    ds_read_b64_tr_b16 v[152:153], v4 offset:0
    ds_read_b64_tr_b16 v[154:155], v4 offset:512
    ds_read_b64_tr_b16 v[156:157], v5 offset:0
    ds_read_b64_tr_b16 v[158:159], v5 offset:512
    ds_read_b64_tr_b16 v[160:161], v2 offset:8192
    ds_read_b64_tr_b16 v[162:163], v2 offset:8704
    ds_read_b64_tr_b16 v[164:165], v3 offset:8192
    ds_read_b64_tr_b16 v[166:167], v3 offset:8704
    ds_read_b64_tr_b16 v[168:169], v4 offset:8192
    ds_read_b64_tr_b16 v[170:171], v4 offset:8704
    ds_read_b64_tr_b16 v[172:173], v5 offset:8192
    ds_read_b64_tr_b16 v[174:175], v5 offset:8704
    s_waitcnt lgkmcnt(0)
    v_mfma_f32_16x16x32_bf16 v[16:19], v[144:147], v[208:211], 0
    ds_read_b128 v[224:227], v7 offset:0
    v_mfma_f32_16x16x32_bf16 v[20:23], v[144:147], v[212:215], 0
    ds_read_b128 v[228:231], v7 offset:2048
    v_mfma_f32_16x16x32_bf16 v[24:27], v[144:147], v[216:219], 0
    ds_read_b128 v[232:235], v7 offset:4096
    v_mfma_f32_16x16x32_bf16 v[28:31], v[144:147], v[220:223], 0
    ds_read_b128 v[236:239], v7 offset:6144
    v_mfma_f32_16x16x32_bf16 v[44:47], v[148:151], v[220:223], 0
    ds_read_b64_tr_b16 v[176:177], v2 offset:4096
    v_mfma_f32_16x16x32_bf16 v[40:43], v[148:151], v[216:219], 0
    ds_read_b64_tr_b16 v[178:179], v2 offset:4608
    v_mfma_f32_16x16x32_bf16 v[36:39], v[148:151], v[212:215], 0
    ds_read_b64_tr_b16 v[180:181], v3 offset:4096
    v_mfma_f32_16x16x32_bf16 v[32:35], v[148:151], v[208:211], 0
    ds_read_b64_tr_b16 v[182:183], v3 offset:4608
    v_mfma_f32_16x16x32_bf16 v[48:51], v[152:155], v[208:211], 0
    ds_read_b64_tr_b16 v[184:185], v4 offset:4096
    v_mfma_f32_16x16x32_bf16 v[52:55], v[152:155], v[212:215], 0
    ds_read_b64_tr_b16 v[186:187], v4 offset:4608
    v_mfma_f32_16x16x32_bf16 v[56:59], v[152:155], v[216:219], 0
    ds_read_b64_tr_b16 v[188:189], v5 offset:4096
    v_mfma_f32_16x16x32_bf16 v[60:63], v[152:155], v[220:223], 0
    ds_read_b64_tr_b16 v[190:191], v5 offset:4608
    v_mfma_f32_16x16x32_bf16 v[76:79], v[156:159], v[220:223], 0
    ds_read_b64_tr_b16 v[192:193], v2 offset:12288
    v_mfma_f32_16x16x32_bf16 v[72:75], v[156:159], v[216:219], 0
    ds_read_b64_tr_b16 v[194:195], v2 offset:12800
    v_mfma_f32_16x16x32_bf16 v[68:71], v[156:159], v[212:215], 0
    ds_read_b64_tr_b16 v[196:197], v3 offset:12288
    v_mfma_f32_16x16x32_bf16 v[64:67], v[156:159], v[208:211], 0
    ds_read_b64_tr_b16 v[198:199], v3 offset:12800
    v_mfma_f32_16x16x32_bf16 v[80:83], v[160:163], v[208:211], 0
    ds_read_b64_tr_b16 v[200:201], v4 offset:12288
    v_mfma_f32_16x16x32_bf16 v[84:87], v[160:163], v[212:215], 0
    ds_read_b64_tr_b16 v[202:203], v4 offset:12800
    v_mfma_f32_16x16x32_bf16 v[88:91], v[160:163], v[216:219], 0
    ds_read_b64_tr_b16 v[204:205], v5 offset:12288
    v_mfma_f32_16x16x32_bf16 v[92:95], v[160:163], v[220:223], 0
    ds_read_b64_tr_b16 v[206:207], v5 offset:12800
    v_mfma_f32_16x16x32_bf16 v[108:111], v[164:167], v[220:223], 0
    v_mfma_f32_16x16x32_bf16 v[104:107], v[164:167], v[216:219], 0
    v_mfma_f32_16x16x32_bf16 v[100:103], v[164:167], v[212:215], 0
    v_mfma_f32_16x16x32_bf16 v[96:99], v[164:167], v[208:211], 0
    v_mfma_f32_16x16x32_bf16 v[112:115], v[168:171], v[208:211], 0
    v_mfma_f32_16x16x32_bf16 v[116:119], v[168:171], v[212:215], 0
    v_mfma_f32_16x16x32_bf16 v[120:123], v[168:171], v[216:219], 0
    v_mfma_f32_16x16x32_bf16 v[124:127], v[168:171], v[220:223], 0
    v_mfma_f32_16x16x32_bf16 v[140:143], v[172:175], v[220:223], 0
    v_mfma_f32_16x16x32_bf16 v[136:139], v[172:175], v[216:219], 0
    v_mfma_f32_16x16x32_bf16 v[132:135], v[172:175], v[212:215], 0
    v_mfma_f32_16x16x32_bf16 v[128:131], v[172:175], v[208:211], 0
    s_waitcnt lgkmcnt(0)
    s_barrier
    v_mfma_f32_16x16x32_bf16 v[16:19], v[176:179], v[224:227], v[16:19]
    ds_read_b128 v[208:211], v6 offset:32768
    v_mfma_f32_16x16x32_bf16 v[20:23], v[176:179], v[228:231], v[20:23]
    ds_read_b128 v[212:215], v6 offset:34816
    v_mfma_f32_16x16x32_bf16 v[24:27], v[176:179], v[232:235], v[24:27]
    ds_read_b128 v[216:219], v6 offset:36864
    v_mfma_f32_16x16x32_bf16 v[28:31], v[176:179], v[236:239], v[28:31]
    ds_read_b128 v[220:223], v6 offset:38912
    v_mfma_f32_16x16x32_bf16 v[44:47], v[180:183], v[236:239], v[44:47]
    ds_read_b64_tr_b16 v[144:145], v2 offset:16384
    v_mfma_f32_16x16x32_bf16 v[40:43], v[180:183], v[232:235], v[40:43]
    ds_read_b64_tr_b16 v[146:147], v2 offset:16896
    v_mfma_f32_16x16x32_bf16 v[36:39], v[180:183], v[228:231], v[36:39]
    ds_read_b64_tr_b16 v[148:149], v3 offset:16384
    v_mfma_f32_16x16x32_bf16 v[32:35], v[180:183], v[224:227], v[32:35]
    ds_read_b64_tr_b16 v[150:151], v3 offset:16896
    v_mfma_f32_16x16x32_bf16 v[48:51], v[184:187], v[224:227], v[48:51]
    ds_read_b64_tr_b16 v[152:153], v4 offset:16384
    v_mfma_f32_16x16x32_bf16 v[52:55], v[184:187], v[228:231], v[52:55]
    ds_read_b64_tr_b16 v[154:155], v4 offset:16896
    v_mfma_f32_16x16x32_bf16 v[56:59], v[184:187], v[232:235], v[56:59]
    ds_read_b64_tr_b16 v[156:157], v5 offset:16384
    v_mfma_f32_16x16x32_bf16 v[60:63], v[184:187], v[236:239], v[60:63]
    ds_read_b64_tr_b16 v[158:159], v5 offset:16896
    v_mfma_f32_16x16x32_bf16 v[76:79], v[188:191], v[236:239], v[76:79]
    ds_read_b64_tr_b16 v[160:161], v2 offset:24576
    v_mfma_f32_16x16x32_bf16 v[72:75], v[188:191], v[232:235], v[72:75]
    ds_read_b64_tr_b16 v[162:163], v2 offset:25088
    v_mfma_f32_16x16x32_bf16 v[68:71], v[188:191], v[228:231], v[68:71]
    ds_read_b64_tr_b16 v[164:165], v3 offset:24576
    v_mfma_f32_16x16x32_bf16 v[64:67], v[188:191], v[224:227], v[64:67]
    ds_read_b64_tr_b16 v[166:167], v3 offset:25088
    v_mfma_f32_16x16x32_bf16 v[80:83], v[192:195], v[224:227], v[80:83]
    ds_read_b64_tr_b16 v[168:169], v4 offset:24576
    v_mfma_f32_16x16x32_bf16 v[84:87], v[192:195], v[228:231], v[84:87]
    ds_read_b64_tr_b16 v[170:171], v4 offset:25088
    v_mfma_f32_16x16x32_bf16 v[88:91], v[192:195], v[232:235], v[88:91]
    ds_read_b64_tr_b16 v[172:173], v5 offset:24576
    v_mfma_f32_16x16x32_bf16 v[92:95], v[192:195], v[236:239], v[92:95]
    ds_read_b64_tr_b16 v[174:175], v5 offset:25088
    v_mfma_f32_16x16x32_bf16 v[108:111], v[196:199], v[236:239], v[108:111]
    v_mfma_f32_16x16x32_bf16 v[104:107], v[196:199], v[232:235], v[104:107]
    v_mfma_f32_16x16x32_bf16 v[100:103], v[196:199], v[228:231], v[100:103]
    v_mfma_f32_16x16x32_bf16 v[96:99], v[196:199], v[224:227], v[96:99]
    v_mfma_f32_16x16x32_bf16 v[112:115], v[200:203], v[224:227], v[112:115]
    v_mfma_f32_16x16x32_bf16 v[116:119], v[200:203], v[228:231], v[116:119]
    v_mfma_f32_16x16x32_bf16 v[120:123], v[200:203], v[232:235], v[120:123]
    v_mfma_f32_16x16x32_bf16 v[124:127], v[200:203], v[236:239], v[124:127]
    v_mfma_f32_16x16x32_bf16 v[140:143], v[204:207], v[236:239], v[140:143]
    v_mfma_f32_16x16x32_bf16 v[136:139], v[204:207], v[232:235], v[136:139]
    v_mfma_f32_16x16x32_bf16 v[132:135], v[204:207], v[228:231], v[132:135]
    v_mfma_f32_16x16x32_bf16 v[128:131], v[204:207], v[224:227], v[128:131]
    s_waitcnt lgkmcnt(0)
    v_mfma_f32_16x16x32_bf16 v[16:19], v[144:147], v[208:211], v[16:19]
    ds_read_b128 v[224:227], v7 offset:32768
    v_mfma_f32_16x16x32_bf16 v[20:23], v[144:147], v[212:215], v[20:23]
    ds_read_b128 v[228:231], v7 offset:34816
    v_mfma_f32_16x16x32_bf16 v[24:27], v[144:147], v[216:219], v[24:27]
    ds_read_b128 v[232:235], v7 offset:36864
    v_mfma_f32_16x16x32_bf16 v[28:31], v[144:147], v[220:223], v[28:31]
    ds_read_b128 v[236:239], v7 offset:38912
    v_mfma_f32_16x16x32_bf16 v[44:47], v[148:151], v[220:223], v[44:47]
    ds_read_b64_tr_b16 v[176:177], v2 offset:20480
    v_mfma_f32_16x16x32_bf16 v[40:43], v[148:151], v[216:219], v[40:43]
    ds_read_b64_tr_b16 v[178:179], v2 offset:20992
    v_mfma_f32_16x16x32_bf16 v[36:39], v[148:151], v[212:215], v[36:39]
    ds_read_b64_tr_b16 v[180:181], v3 offset:20480
    v_mfma_f32_16x16x32_bf16 v[32:35], v[148:151], v[208:211], v[32:35]
    ds_read_b64_tr_b16 v[182:183], v3 offset:20992
    v_mfma_f32_16x16x32_bf16 v[48:51], v[152:155], v[208:211], v[48:51]
    ds_read_b64_tr_b16 v[184:185], v4 offset:20480
    v_mfma_f32_16x16x32_bf16 v[52:55], v[152:155], v[212:215], v[52:55]
    ds_read_b64_tr_b16 v[186:187], v4 offset:20992
    v_mfma_f32_16x16x32_bf16 v[56:59], v[152:155], v[216:219], v[56:59]
    ds_read_b64_tr_b16 v[188:189], v5 offset:20480
    v_mfma_f32_16x16x32_bf16 v[60:63], v[152:155], v[220:223], v[60:63]
    ds_read_b64_tr_b16 v[190:191], v5 offset:20992
    v_mfma_f32_16x16x32_bf16 v[76:79], v[156:159], v[220:223], v[76:79]
    ds_read_b64_tr_b16 v[192:193], v2 offset:28672
    v_mfma_f32_16x16x32_bf16 v[72:75], v[156:159], v[216:219], v[72:75]
    ds_read_b64_tr_b16 v[194:195], v2 offset:29184
    v_mfma_f32_16x16x32_bf16 v[68:71], v[156:159], v[212:215], v[68:71]
    ds_read_b64_tr_b16 v[196:197], v3 offset:28672
    v_mfma_f32_16x16x32_bf16 v[64:67], v[156:159], v[208:211], v[64:67]
    ds_read_b64_tr_b16 v[198:199], v3 offset:29184
    v_mfma_f32_16x16x32_bf16 v[80:83], v[160:163], v[208:211], v[80:83]
    ds_read_b64_tr_b16 v[200:201], v4 offset:28672
    v_mfma_f32_16x16x32_bf16 v[84:87], v[160:163], v[212:215], v[84:87]
    ds_read_b64_tr_b16 v[202:203], v4 offset:29184
    v_mfma_f32_16x16x32_bf16 v[88:91], v[160:163], v[216:219], v[88:91]
    ds_read_b64_tr_b16 v[204:205], v5 offset:28672
    v_mfma_f32_16x16x32_bf16 v[92:95], v[160:163], v[220:223], v[92:95]
    ds_read_b64_tr_b16 v[206:207], v5 offset:29184
    v_mfma_f32_16x16x32_bf16 v[108:111], v[164:167], v[220:223], v[108:111]
    v_mfma_f32_16x16x32_bf16 v[104:107], v[164:167], v[216:219], v[104:107]
    v_mfma_f32_16x16x32_bf16 v[100:103], v[164:167], v[212:215], v[100:103]
    v_mfma_f32_16x16x32_bf16 v[96:99], v[164:167], v[208:211], v[96:99]
    v_mfma_f32_16x16x32_bf16 v[112:115], v[168:171], v[208:211], v[112:115]
    v_mfma_f32_16x16x32_bf16 v[116:119], v[168:171], v[212:215], v[116:119]
    v_mfma_f32_16x16x32_bf16 v[120:123], v[168:171], v[216:219], v[120:123]
    v_mfma_f32_16x16x32_bf16 v[124:127], v[168:171], v[220:223], v[124:127]
    v_mfma_f32_16x16x32_bf16 v[140:143], v[172:175], v[220:223], v[140:143]
    v_mfma_f32_16x16x32_bf16 v[136:139], v[172:175], v[216:219], v[136:139]
    v_mfma_f32_16x16x32_bf16 v[132:135], v[172:175], v[212:215], v[132:135]
    v_mfma_f32_16x16x32_bf16 v[128:131], v[172:175], v[208:211], v[128:131]
    s_waitcnt lgkmcnt(0)
    s_barrier
    v_mfma_f32_16x16x32_bf16 v[16:19], v[176:179], v[224:227], v[16:19]
    ds_read_b128 v[208:211], v8 offset:0
    v_mfma_f32_16x16x32_bf16 v[20:23], v[176:179], v[228:231], v[20:23]
    ds_read_b128 v[212:215], v8 offset:2048
    v_mfma_f32_16x16x32_bf16 v[24:27], v[176:179], v[232:235], v[24:27]
    ds_read_b128 v[216:219], v8 offset:4096
    v_mfma_f32_16x16x32_bf16 v[28:31], v[176:179], v[236:239], v[28:31]
    ds_read_b128 v[220:223], v8 offset:6144
    v_mfma_f32_16x16x32_bf16 v[44:47], v[180:183], v[236:239], v[44:47]
    ds_read_b64_tr_b16 v[144:145], v2 offset:32768
    v_mfma_f32_16x16x32_bf16 v[40:43], v[180:183], v[232:235], v[40:43]
    ds_read_b64_tr_b16 v[146:147], v2 offset:33280
    v_mfma_f32_16x16x32_bf16 v[36:39], v[180:183], v[228:231], v[36:39]
    ds_read_b64_tr_b16 v[148:149], v3 offset:32768
    v_mfma_f32_16x16x32_bf16 v[32:35], v[180:183], v[224:227], v[32:35]
    ds_read_b64_tr_b16 v[150:151], v3 offset:33280
    v_mfma_f32_16x16x32_bf16 v[48:51], v[184:187], v[224:227], v[48:51]
    ds_read_b64_tr_b16 v[152:153], v4 offset:32768
    v_mfma_f32_16x16x32_bf16 v[52:55], v[184:187], v[228:231], v[52:55]
    ds_read_b64_tr_b16 v[154:155], v4 offset:33280
    v_mfma_f32_16x16x32_bf16 v[56:59], v[184:187], v[232:235], v[56:59]
    ds_read_b64_tr_b16 v[156:157], v5 offset:32768
    v_mfma_f32_16x16x32_bf16 v[60:63], v[184:187], v[236:239], v[60:63]
    ds_read_b64_tr_b16 v[158:159], v5 offset:33280
    v_mfma_f32_16x16x32_bf16 v[76:79], v[188:191], v[236:239], v[76:79]
    ds_read_b64_tr_b16 v[160:161], v2 offset:40960
    v_mfma_f32_16x16x32_bf16 v[72:75], v[188:191], v[232:235], v[72:75]
    ds_read_b64_tr_b16 v[162:163], v2 offset:41472
    v_mfma_f32_16x16x32_bf16 v[68:71], v[188:191], v[228:231], v[68:71]
    ds_read_b64_tr_b16 v[164:165], v3 offset:40960
    v_mfma_f32_16x16x32_bf16 v[64:67], v[188:191], v[224:227], v[64:67]
    ds_read_b64_tr_b16 v[166:167], v3 offset:41472
    v_mfma_f32_16x16x32_bf16 v[80:83], v[192:195], v[224:227], v[80:83]
    ds_read_b64_tr_b16 v[168:169], v4 offset:40960
    v_mfma_f32_16x16x32_bf16 v[84:87], v[192:195], v[228:231], v[84:87]
    ds_read_b64_tr_b16 v[170:171], v4 offset:41472
    v_mfma_f32_16x16x32_bf16 v[88:91], v[192:195], v[232:235], v[88:91]
    ds_read_b64_tr_b16 v[172:173], v5 offset:40960
    v_mfma_f32_16x16x32_bf16 v[92:95], v[192:195], v[236:239], v[92:95]
    ds_read_b64_tr_b16 v[174:175], v5 offset:41472
    v_mfma_f32_16x16x32_bf16 v[108:111], v[196:199], v[236:239], v[108:111]
    v_mfma_f32_16x16x32_bf16 v[104:107], v[196:199], v[232:235], v[104:107]
    v_mfma_f32_16x16x32_bf16 v[100:103], v[196:199], v[228:231], v[100:103]
    v_mfma_f32_16x16x32_bf16 v[96:99], v[196:199], v[224:227], v[96:99]
    v_mfma_f32_16x16x32_bf16 v[112:115], v[200:203], v[224:227], v[112:115]
    v_mfma_f32_16x16x32_bf16 v[116:119], v[200:203], v[228:231], v[116:119]
    v_mfma_f32_16x16x32_bf16 v[120:123], v[200:203], v[232:235], v[120:123]
    v_mfma_f32_16x16x32_bf16 v[124:127], v[200:203], v[236:239], v[124:127]
    v_mfma_f32_16x16x32_bf16 v[140:143], v[204:207], v[236:239], v[140:143]
    v_mfma_f32_16x16x32_bf16 v[136:139], v[204:207], v[232:235], v[136:139]
    v_mfma_f32_16x16x32_bf16 v[132:135], v[204:207], v[228:231], v[132:135]
    v_mfma_f32_16x16x32_bf16 v[128:131], v[204:207], v[224:227], v[128:131]
    s_waitcnt lgkmcnt(0)
    v_mfma_f32_16x16x32_bf16 v[16:19], v[144:147], v[208:211], v[16:19]
    ds_read_b128 v[224:227], v9 offset:0
    v_mfma_f32_16x16x32_bf16 v[20:23], v[144:147], v[212:215], v[20:23]
    ds_read_b128 v[228:231], v9 offset:2048
    v_mfma_f32_16x16x32_bf16 v[24:27], v[144:147], v[216:219], v[24:27]
    ds_read_b128 v[232:235], v9 offset:4096
    v_mfma_f32_16x16x32_bf16 v[28:31], v[144:147], v[220:223], v[28:31]
    ds_read_b128 v[236:239], v9 offset:6144
    v_mfma_f32_16x16x32_bf16 v[44:47], v[148:151], v[220:223], v[44:47]
    ds_read_b64_tr_b16 v[176:177], v2 offset:36864
    v_mfma_f32_16x16x32_bf16 v[40:43], v[148:151], v[216:219], v[40:43]
    ds_read_b64_tr_b16 v[178:179], v2 offset:37376
    v_mfma_f32_16x16x32_bf16 v[36:39], v[148:151], v[212:215], v[36:39]
    ds_read_b64_tr_b16 v[180:181], v3 offset:36864
    v_mfma_f32_16x16x32_bf16 v[32:35], v[148:151], v[208:211], v[32:35]
    ds_read_b64_tr_b16 v[182:183], v3 offset:37376
    v_mfma_f32_16x16x32_bf16 v[48:51], v[152:155], v[208:211], v[48:51]
    ds_read_b64_tr_b16 v[184:185], v4 offset:36864
    v_mfma_f32_16x16x32_bf16 v[52:55], v[152:155], v[212:215], v[52:55]
    ds_read_b64_tr_b16 v[186:187], v4 offset:37376
    v_mfma_f32_16x16x32_bf16 v[56:59], v[152:155], v[216:219], v[56:59]
    ds_read_b64_tr_b16 v[188:189], v5 offset:36864
    v_mfma_f32_16x16x32_bf16 v[60:63], v[152:155], v[220:223], v[60:63]
    ds_read_b64_tr_b16 v[190:191], v5 offset:37376
    v_mfma_f32_16x16x32_bf16 v[76:79], v[156:159], v[220:223], v[76:79]
    ds_read_b64_tr_b16 v[192:193], v2 offset:45056
    v_mfma_f32_16x16x32_bf16 v[72:75], v[156:159], v[216:219], v[72:75]
    ds_read_b64_tr_b16 v[194:195], v2 offset:45568
    v_mfma_f32_16x16x32_bf16 v[68:71], v[156:159], v[212:215], v[68:71]
    ds_read_b64_tr_b16 v[196:197], v3 offset:45056
    v_mfma_f32_16x16x32_bf16 v[64:67], v[156:159], v[208:211], v[64:67]
    ds_read_b64_tr_b16 v[198:199], v3 offset:45568
    v_mfma_f32_16x16x32_bf16 v[80:83], v[160:163], v[208:211], v[80:83]
    ds_read_b64_tr_b16 v[200:201], v4 offset:45056
    v_mfma_f32_16x16x32_bf16 v[84:87], v[160:163], v[212:215], v[84:87]
    ds_read_b64_tr_b16 v[202:203], v4 offset:45568
    v_mfma_f32_16x16x32_bf16 v[88:91], v[160:163], v[216:219], v[88:91]
    ds_read_b64_tr_b16 v[204:205], v5 offset:45056
    v_mfma_f32_16x16x32_bf16 v[92:95], v[160:163], v[220:223], v[92:95]
    ds_read_b64_tr_b16 v[206:207], v5 offset:45568
    v_mfma_f32_16x16x32_bf16 v[108:111], v[164:167], v[220:223], v[108:111]
    v_mfma_f32_16x16x32_bf16 v[104:107], v[164:167], v[216:219], v[104:107]
    v_mfma_f32_16x16x32_bf16 v[100:103], v[164:167], v[212:215], v[100:103]
    v_mfma_f32_16x16x32_bf16 v[96:99], v[164:167], v[208:211], v[96:99]
    v_mfma_f32_16x16x32_bf16 v[112:115], v[168:171], v[208:211], v[112:115]
    v_mfma_f32_16x16x32_bf16 v[116:119], v[168:171], v[212:215], v[116:119]
    v_mfma_f32_16x16x32_bf16 v[120:123], v[168:171], v[216:219], v[120:123]
    v_mfma_f32_16x16x32_bf16 v[124:127], v[168:171], v[220:223], v[124:127]
    v_mfma_f32_16x16x32_bf16 v[140:143], v[172:175], v[220:223], v[140:143]
    v_mfma_f32_16x16x32_bf16 v[136:139], v[172:175], v[216:219], v[136:139]
    v_mfma_f32_16x16x32_bf16 v[132:135], v[172:175], v[212:215], v[132:135]
    v_mfma_f32_16x16x32_bf16 v[128:131], v[172:175], v[208:211], v[128:131]
    s_waitcnt lgkmcnt(0)
    s_barrier
    v_mfma_f32_16x16x32_bf16 v[16:19], v[176:179], v[224:227], v[16:19]
    ds_read_b128 v[208:211], v6 offset:0
    v_mfma_f32_16x16x32_bf16 v[20:23], v[176:179], v[228:231], v[20:23]
    ds_read_b128 v[212:215], v6 offset:2048
    v_mfma_f32_16x16x32_bf16 v[24:27], v[176:179], v[232:235], v[24:27]
    ds_read_b128 v[216:219], v6 offset:4096
    v_mfma_f32_16x16x32_bf16 v[28:31], v[176:179], v[236:239], v[28:31]
    ds_read_b128 v[220:223], v6 offset:6144
    v_mfma_f32_16x16x32_bf16 v[44:47], v[180:183], v[236:239], v[44:47]
    ds_read_b64_tr_b16 v[144:145], v2 offset:0
    v_mfma_f32_16x16x32_bf16 v[40:43], v[180:183], v[232:235], v[40:43]
    ds_read_b64_tr_b16 v[146:147], v2 offset:512
    v_mfma_f32_16x16x32_bf16 v[36:39], v[180:183], v[228:231], v[36:39]
    ds_read_b64_tr_b16 v[148:149], v3 offset:0
    v_mfma_f32_16x16x32_bf16 v[32:35], v[180:183], v[224:227], v[32:35]
    ds_read_b64_tr_b16 v[150:151], v3 offset:512
    v_mfma_f32_16x16x32_bf16 v[48:51], v[184:187], v[224:227], v[48:51]
    ds_read_b64_tr_b16 v[152:153], v4 offset:0
    v_mfma_f32_16x16x32_bf16 v[52:55], v[184:187], v[228:231], v[52:55]
    ds_read_b64_tr_b16 v[154:155], v4 offset:512
    v_mfma_f32_16x16x32_bf16 v[56:59], v[184:187], v[232:235], v[56:59]
    ds_read_b64_tr_b16 v[156:157], v5 offset:0
    v_mfma_f32_16x16x32_bf16 v[60:63], v[184:187], v[236:239], v[60:63]
    ds_read_b64_tr_b16 v[158:159], v5 offset:512
    v_mfma_f32_16x16x32_bf16 v[76:79], v[188:191], v[236:239], v[76:79]
    ds_read_b64_tr_b16 v[160:161], v2 offset:8192
    v_mfma_f32_16x16x32_bf16 v[72:75], v[188:191], v[232:235], v[72:75]
    ds_read_b64_tr_b16 v[162:163], v2 offset:8704
    v_mfma_f32_16x16x32_bf16 v[68:71], v[188:191], v[228:231], v[68:71]
    ds_read_b64_tr_b16 v[164:165], v3 offset:8192
    v_mfma_f32_16x16x32_bf16 v[64:67], v[188:191], v[224:227], v[64:67]
    ds_read_b64_tr_b16 v[166:167], v3 offset:8704
    v_mfma_f32_16x16x32_bf16 v[80:83], v[192:195], v[224:227], v[80:83]
    ds_read_b64_tr_b16 v[168:169], v4 offset:8192
    v_mfma_f32_16x16x32_bf16 v[84:87], v[192:195], v[228:231], v[84:87]
    ds_read_b64_tr_b16 v[170:171], v4 offset:8704
    v_mfma_f32_16x16x32_bf16 v[88:91], v[192:195], v[232:235], v[88:91]
    ds_read_b64_tr_b16 v[172:173], v5 offset:8192
    v_mfma_f32_16x16x32_bf16 v[92:95], v[192:195], v[236:239], v[92:95]
    ds_read_b64_tr_b16 v[174:175], v5 offset:8704
    v_mfma_f32_16x16x32_bf16 v[108:111], v[196:199], v[236:239], v[108:111]
    v_mfma_f32_16x16x32_bf16 v[104:107], v[196:199], v[232:235], v[104:107]
    v_mfma_f32_16x16x32_bf16 v[100:103], v[196:199], v[228:231], v[100:103]
    v_mfma_f32_16x16x32_bf16 v[96:99], v[196:199], v[224:227], v[96:99]
    v_mfma_f32_16x16x32_bf16 v[112:115], v[200:203], v[224:227], v[112:115]
    v_mfma_f32_16x16x32_bf16 v[116:119], v[200:203], v[228:231], v[116:119]
    v_mfma_f32_16x16x32_bf16 v[120:123], v[200:203], v[232:235], v[120:123]
    v_mfma_f32_16x16x32_bf16 v[124:127], v[200:203], v[236:239], v[124:127]
    v_mfma_f32_16x16x32_bf16 v[140:143], v[204:207], v[236:239], v[140:143]
    v_mfma_f32_16x16x32_bf16 v[136:139], v[204:207], v[232:235], v[136:139]
    v_mfma_f32_16x16x32_bf16 v[132:135], v[204:207], v[228:231], v[132:135]
    v_mfma_f32_16x16x32_bf16 v[128:131], v[204:207], v[224:227], v[128:131]
    s_waitcnt lgkmcnt(0)
    v_mfma_f32_16x16x32_bf16 v[16:19], v[144:147], v[208:211], v[16:19]
    ds_read_b128 v[224:227], v7 offset:0
    v_mfma_f32_16x16x32_bf16 v[20:23], v[144:147], v[212:215], v[20:23]
    ds_read_b128 v[228:231], v7 offset:2048
    v_mfma_f32_16x16x32_bf16 v[24:27], v[144:147], v[216:219], v[24:27]
    ds_read_b128 v[232:235], v7 offset:4096
    v_mfma_f32_16x16x32_bf16 v[28:31], v[144:147], v[220:223], v[28:31]
    ds_read_b128 v[236:239], v7 offset:6144
    v_mfma_f32_16x16x32_bf16 v[44:47], v[148:151], v[220:223], v[44:47]
    ds_read_b64_tr_b16 v[176:177], v2 offset:4096
    v_mfma_f32_16x16x32_bf16 v[40:43], v[148:151], v[216:219], v[40:43]
    ds_read_b64_tr_b16 v[178:179], v2 offset:4608
    v_mfma_f32_16x16x32_bf16 v[36:39], v[148:151], v[212:215], v[36:39]
    ds_read_b64_tr_b16 v[180:181], v3 offset:4096
    v_mfma_f32_16x16x32_bf16 v[32:35], v[148:151], v[208:211], v[32:35]
    ds_read_b64_tr_b16 v[182:183], v3 offset:4608
    v_mfma_f32_16x16x32_bf16 v[48:51], v[152:155], v[208:211], v[48:51]
    ds_read_b64_tr_b16 v[184:185], v4 offset:4096
    v_mfma_f32_16x16x32_bf16 v[52:55], v[152:155], v[212:215], v[52:55]
    ds_read_b64_tr_b16 v[186:187], v4 offset:4608
    v_mfma_f32_16x16x32_bf16 v[56:59], v[152:155], v[216:219], v[56:59]
    ds_read_b64_tr_b16 v[188:189], v5 offset:4096
    v_mfma_f32_16x16x32_bf16 v[60:63], v[152:155], v[220:223], v[60:63]
    ds_read_b64_tr_b16 v[190:191], v5 offset:4608
    v_mfma_f32_16x16x32_bf16 v[76:79], v[156:159], v[220:223], v[76:79]
    ds_read_b64_tr_b16 v[192:193], v2 offset:12288
    v_mfma_f32_16x16x32_bf16 v[72:75], v[156:159], v[216:219], v[72:75]
    ds_read_b64_tr_b16 v[194:195], v2 offset:12800
    v_mfma_f32_16x16x32_bf16 v[68:71], v[156:159], v[212:215], v[68:71]
    ds_read_b64_tr_b16 v[196:197], v3 offset:12288
    v_mfma_f32_16x16x32_bf16 v[64:67], v[156:159], v[208:211], v[64:67]
    ds_read_b64_tr_b16 v[198:199], v3 offset:12800
    v_mfma_f32_16x16x32_bf16 v[80:83], v[160:163], v[208:211], v[80:83]
    ds_read_b64_tr_b16 v[200:201], v4 offset:12288
    v_mfma_f32_16x16x32_bf16 v[84:87], v[160:163], v[212:215], v[84:87]
    ds_read_b64_tr_b16 v[202:203], v4 offset:12800
    v_mfma_f32_16x16x32_bf16 v[88:91], v[160:163], v[216:219], v[88:91]
    ds_read_b64_tr_b16 v[204:205], v5 offset:12288
    v_mfma_f32_16x16x32_bf16 v[92:95], v[160:163], v[220:223], v[92:95]
    ds_read_b64_tr_b16 v[206:207], v5 offset:12800
    v_mfma_f32_16x16x32_bf16 v[108:111], v[164:167], v[220:223], v[108:111]
    v_mfma_f32_16x16x32_bf16 v[104:107], v[164:167], v[216:219], v[104:107]
    v_mfma_f32_16x16x32_bf16 v[100:103], v[164:167], v[212:215], v[100:103]
    v_mfma_f32_16x16x32_bf16 v[96:99], v[164:167], v[208:211], v[96:99]
    v_mfma_f32_16x16x32_bf16 v[112:115], v[168:171], v[208:211], v[112:115]
    v_mfma_f32_16x16x32_bf16 v[116:119], v[168:171], v[212:215], v[116:119]
    v_mfma_f32_16x16x32_bf16 v[120:123], v[168:171], v[216:219], v[120:123]
    v_mfma_f32_16x16x32_bf16 v[124:127], v[168:171], v[220:223], v[124:127]
    v_mfma_f32_16x16x32_bf16 v[140:143], v[172:175], v[220:223], v[140:143]
    v_mfma_f32_16x16x32_bf16 v[136:139], v[172:175], v[216:219], v[136:139]
    v_mfma_f32_16x16x32_bf16 v[132:135], v[172:175], v[212:215], v[132:135]
    v_mfma_f32_16x16x32_bf16 v[128:131], v[172:175], v[208:211], v[128:131]
    s_waitcnt lgkmcnt(0)
    s_barrier
    v_mfma_f32_16x16x32_bf16 v[16:19], v[176:179], v[224:227], v[16:19]
    ds_read_b128 v[208:211], v6 offset:32768
    v_mfma_f32_16x16x32_bf16 v[20:23], v[176:179], v[228:231], v[20:23]
    ds_read_b128 v[212:215], v6 offset:34816
    v_mfma_f32_16x16x32_bf16 v[24:27], v[176:179], v[232:235], v[24:27]
    ds_read_b128 v[216:219], v6 offset:36864
    v_mfma_f32_16x16x32_bf16 v[28:31], v[176:179], v[236:239], v[28:31]
    ds_read_b128 v[220:223], v6 offset:38912
    v_mfma_f32_16x16x32_bf16 v[44:47], v[180:183], v[236:239], v[44:47]
    ds_read_b64_tr_b16 v[144:145], v2 offset:16384
    v_mfma_f32_16x16x32_bf16 v[40:43], v[180:183], v[232:235], v[40:43]
    ds_read_b64_tr_b16 v[146:147], v2 offset:16896
    v_mfma_f32_16x16x32_bf16 v[36:39], v[180:183], v[228:231], v[36:39]
    ds_read_b64_tr_b16 v[148:149], v3 offset:16384
    v_mfma_f32_16x16x32_bf16 v[32:35], v[180:183], v[224:227], v[32:35]
    ds_read_b64_tr_b16 v[150:151], v3 offset:16896
    v_mfma_f32_16x16x32_bf16 v[48:51], v[184:187], v[224:227], v[48:51]
    ds_read_b64_tr_b16 v[152:153], v4 offset:16384
    v_mfma_f32_16x16x32_bf16 v[52:55], v[184:187], v[228:231], v[52:55]
    ds_read_b64_tr_b16 v[154:155], v4 offset:16896
    v_mfma_f32_16x16x32_bf16 v[56:59], v[184:187], v[232:235], v[56:59]
    ds_read_b64_tr_b16 v[156:157], v5 offset:16384
    v_mfma_f32_16x16x32_bf16 v[60:63], v[184:187], v[236:239], v[60:63]
    ds_read_b64_tr_b16 v[158:159], v5 offset:16896
    v_mfma_f32_16x16x32_bf16 v[76:79], v[188:191], v[236:239], v[76:79]
    ds_read_b64_tr_b16 v[160:161], v2 offset:24576
    v_mfma_f32_16x16x32_bf16 v[72:75], v[188:191], v[232:235], v[72:75]
    ds_read_b64_tr_b16 v[162:163], v2 offset:25088
    v_mfma_f32_16x16x32_bf16 v[68:71], v[188:191], v[228:231], v[68:71]
    ds_read_b64_tr_b16 v[164:165], v3 offset:24576
    v_mfma_f32_16x16x32_bf16 v[64:67], v[188:191], v[224:227], v[64:67]
    ds_read_b64_tr_b16 v[166:167], v3 offset:25088
    v_mfma_f32_16x16x32_bf16 v[80:83], v[192:195], v[224:227], v[80:83]
    ds_read_b64_tr_b16 v[168:169], v4 offset:24576
    v_mfma_f32_16x16x32_bf16 v[84:87], v[192:195], v[228:231], v[84:87]
    ds_read_b64_tr_b16 v[170:171], v4 offset:25088
    v_mfma_f32_16x16x32_bf16 v[88:91], v[192:195], v[232:235], v[88:91]
    ds_read_b64_tr_b16 v[172:173], v5 offset:24576
    v_mfma_f32_16x16x32_bf16 v[92:95], v[192:195], v[236:239], v[92:95]
    ds_read_b64_tr_b16 v[174:175], v5 offset:25088
    v_mfma_f32_16x16x32_bf16 v[108:111], v[196:199], v[236:239], v[108:111]
    v_mfma_f32_16x16x32_bf16 v[104:107], v[196:199], v[232:235], v[104:107]
    v_mfma_f32_16x16x32_bf16 v[100:103], v[196:199], v[228:231], v[100:103]
    v_mfma_f32_16x16x32_bf16 v[96:99], v[196:199], v[224:227], v[96:99]
    v_mfma_f32_16x16x32_bf16 v[112:115], v[200:203], v[224:227], v[112:115]
    v_mfma_f32_16x16x32_bf16 v[116:119], v[200:203], v[228:231], v[116:119]
    v_mfma_f32_16x16x32_bf16 v[120:123], v[200:203], v[232:235], v[120:123]
    v_mfma_f32_16x16x32_bf16 v[124:127], v[200:203], v[236:239], v[124:127]
    v_mfma_f32_16x16x32_bf16 v[140:143], v[204:207], v[236:239], v[140:143]
    v_mfma_f32_16x16x32_bf16 v[136:139], v[204:207], v[232:235], v[136:139]
    v_mfma_f32_16x16x32_bf16 v[132:135], v[204:207], v[228:231], v[132:135]
    v_mfma_f32_16x16x32_bf16 v[128:131], v[204:207], v[224:227], v[128:131]
    s_waitcnt lgkmcnt(0)
    v_mfma_f32_16x16x32_bf16 v[16:19], v[144:147], v[208:211], v[16:19]
    ds_read_b128 v[224:227], v7 offset:32768
    v_mfma_f32_16x16x32_bf16 v[20:23], v[144:147], v[212:215], v[20:23]
    ds_read_b128 v[228:231], v7 offset:34816
    v_mfma_f32_16x16x32_bf16 v[24:27], v[144:147], v[216:219], v[24:27]
    ds_read_b128 v[232:235], v7 offset:36864
    v_mfma_f32_16x16x32_bf16 v[28:31], v[144:147], v[220:223], v[28:31]
    ds_read_b128 v[236:239], v7 offset:38912
    v_mfma_f32_16x16x32_bf16 v[44:47], v[148:151], v[220:223], v[44:47]
    ds_read_b64_tr_b16 v[176:177], v2 offset:20480
    v_mfma_f32_16x16x32_bf16 v[40:43], v[148:151], v[216:219], v[40:43]
    ds_read_b64_tr_b16 v[178:179], v2 offset:20992
    v_mfma_f32_16x16x32_bf16 v[36:39], v[148:151], v[212:215], v[36:39]
    ds_read_b64_tr_b16 v[180:181], v3 offset:20480
    v_mfma_f32_16x16x32_bf16 v[32:35], v[148:151], v[208:211], v[32:35]
    ds_read_b64_tr_b16 v[182:183], v3 offset:20992
    v_mfma_f32_16x16x32_bf16 v[48:51], v[152:155], v[208:211], v[48:51]
    ds_read_b64_tr_b16 v[184:185], v4 offset:20480
    v_mfma_f32_16x16x32_bf16 v[52:55], v[152:155], v[212:215], v[52:55]
    ds_read_b64_tr_b16 v[186:187], v4 offset:20992
    v_mfma_f32_16x16x32_bf16 v[56:59], v[152:155], v[216:219], v[56:59]
    ds_read_b64_tr_b16 v[188:189], v5 offset:20480
    v_mfma_f32_16x16x32_bf16 v[60:63], v[152:155], v[220:223], v[60:63]
    ds_read_b64_tr_b16 v[190:191], v5 offset:20992
    v_mfma_f32_16x16x32_bf16 v[76:79], v[156:159], v[220:223], v[76:79]
    ds_read_b64_tr_b16 v[192:193], v2 offset:28672
    v_mfma_f32_16x16x32_bf16 v[72:75], v[156:159], v[216:219], v[72:75]
    ds_read_b64_tr_b16 v[194:195], v2 offset:29184
    v_mfma_f32_16x16x32_bf16 v[68:71], v[156:159], v[212:215], v[68:71]
    ds_read_b64_tr_b16 v[196:197], v3 offset:28672
    v_mfma_f32_16x16x32_bf16 v[64:67], v[156:159], v[208:211], v[64:67]
    ds_read_b64_tr_b16 v[198:199], v3 offset:29184
    v_mfma_f32_16x16x32_bf16 v[80:83], v[160:163], v[208:211], v[80:83]
    ds_read_b64_tr_b16 v[200:201], v4 offset:28672
    v_mfma_f32_16x16x32_bf16 v[84:87], v[160:163], v[212:215], v[84:87]
    ds_read_b64_tr_b16 v[202:203], v4 offset:29184
    v_mfma_f32_16x16x32_bf16 v[88:91], v[160:163], v[216:219], v[88:91]
    ds_read_b64_tr_b16 v[204:205], v5 offset:28672
    v_mfma_f32_16x16x32_bf16 v[92:95], v[160:163], v[220:223], v[92:95]
    ds_read_b64_tr_b16 v[206:207], v5 offset:29184
    v_mfma_f32_16x16x32_bf16 v[108:111], v[164:167], v[220:223], v[108:111]
    v_mfma_f32_16x16x32_bf16 v[104:107], v[164:167], v[216:219], v[104:107]
    v_mfma_f32_16x16x32_bf16 v[100:103], v[164:167], v[212:215], v[100:103]
    v_mfma_f32_16x16x32_bf16 v[96:99], v[164:167], v[208:211], v[96:99]
    v_mfma_f32_16x16x32_bf16 v[112:115], v[168:171], v[208:211], v[112:115]
    v_mfma_f32_16x16x32_bf16 v[116:119], v[168:171], v[212:215], v[116:119]
    v_mfma_f32_16x16x32_bf16 v[120:123], v[168:171], v[216:219], v[120:123]
    v_mfma_f32_16x16x32_bf16 v[124:127], v[168:171], v[220:223], v[124:127]
    v_mfma_f32_16x16x32_bf16 v[140:143], v[172:175], v[220:223], v[140:143]
    v_mfma_f32_16x16x32_bf16 v[136:139], v[172:175], v[216:219], v[136:139]
    v_mfma_f32_16x16x32_bf16 v[132:135], v[172:175], v[212:215], v[132:135]
    v_mfma_f32_16x16x32_bf16 v[128:131], v[172:175], v[208:211], v[128:131]
    s_waitcnt lgkmcnt(0)
    s_barrier
    v_mfma_f32_16x16x32_bf16 v[16:19], v[176:179], v[224:227], v[16:19]
    ds_read_b128 v[208:211], v8 offset:0
    v_mfma_f32_16x16x32_bf16 v[20:23], v[176:179], v[228:231], v[20:23]
    ds_read_b128 v[212:215], v8 offset:2048
    v_mfma_f32_16x16x32_bf16 v[24:27], v[176:179], v[232:235], v[24:27]
    ds_read_b128 v[216:219], v8 offset:4096
    v_mfma_f32_16x16x32_bf16 v[28:31], v[176:179], v[236:239], v[28:31]
    ds_read_b128 v[220:223], v8 offset:6144
    v_mfma_f32_16x16x32_bf16 v[44:47], v[180:183], v[236:239], v[44:47]
    ds_read_b64_tr_b16 v[144:145], v2 offset:32768
    v_mfma_f32_16x16x32_bf16 v[40:43], v[180:183], v[232:235], v[40:43]
    ds_read_b64_tr_b16 v[146:147], v2 offset:33280
    v_mfma_f32_16x16x32_bf16 v[36:39], v[180:183], v[228:231], v[36:39]
    ds_read_b64_tr_b16 v[148:149], v3 offset:32768
    v_mfma_f32_16x16x32_bf16 v[32:35], v[180:183], v[224:227], v[32:35]
    ds_read_b64_tr_b16 v[150:151], v3 offset:33280
    v_mfma_f32_16x16x32_bf16 v[48:51], v[184:187], v[224:227], v[48:51]
    ds_read_b64_tr_b16 v[152:153], v4 offset:32768
    v_mfma_f32_16x16x32_bf16 v[52:55], v[184:187], v[228:231], v[52:55]
    ds_read_b64_tr_b16 v[154:155], v4 offset:33280
    v_mfma_f32_16x16x32_bf16 v[56:59], v[184:187], v[232:235], v[56:59]
    ds_read_b64_tr_b16 v[156:157], v5 offset:32768
    v_mfma_f32_16x16x32_bf16 v[60:63], v[184:187], v[236:239], v[60:63]
    ds_read_b64_tr_b16 v[158:159], v5 offset:33280
    v_mfma_f32_16x16x32_bf16 v[76:79], v[188:191], v[236:239], v[76:79]
    ds_read_b64_tr_b16 v[160:161], v2 offset:40960
    v_mfma_f32_16x16x32_bf16 v[72:75], v[188:191], v[232:235], v[72:75]
    ds_read_b64_tr_b16 v[162:163], v2 offset:41472
    v_mfma_f32_16x16x32_bf16 v[68:71], v[188:191], v[228:231], v[68:71]
    ds_read_b64_tr_b16 v[164:165], v3 offset:40960
    v_mfma_f32_16x16x32_bf16 v[64:67], v[188:191], v[224:227], v[64:67]
    ds_read_b64_tr_b16 v[166:167], v3 offset:41472
    v_mfma_f32_16x16x32_bf16 v[80:83], v[192:195], v[224:227], v[80:83]
    ds_read_b64_tr_b16 v[168:169], v4 offset:40960
    v_mfma_f32_16x16x32_bf16 v[84:87], v[192:195], v[228:231], v[84:87]
    ds_read_b64_tr_b16 v[170:171], v4 offset:41472
    v_mfma_f32_16x16x32_bf16 v[88:91], v[192:195], v[232:235], v[88:91]
    ds_read_b64_tr_b16 v[172:173], v5 offset:40960
    v_mfma_f32_16x16x32_bf16 v[92:95], v[192:195], v[236:239], v[92:95]
    ds_read_b64_tr_b16 v[174:175], v5 offset:41472
    v_mfma_f32_16x16x32_bf16 v[108:111], v[196:199], v[236:239], v[108:111]
    v_mfma_f32_16x16x32_bf16 v[104:107], v[196:199], v[232:235], v[104:107]
    v_mfma_f32_16x16x32_bf16 v[100:103], v[196:199], v[228:231], v[100:103]
    v_mfma_f32_16x16x32_bf16 v[96:99], v[196:199], v[224:227], v[96:99]
    v_mfma_f32_16x16x32_bf16 v[112:115], v[200:203], v[224:227], v[112:115]
    v_mfma_f32_16x16x32_bf16 v[116:119], v[200:203], v[228:231], v[116:119]
    v_mfma_f32_16x16x32_bf16 v[120:123], v[200:203], v[232:235], v[120:123]
    v_mfma_f32_16x16x32_bf16 v[124:127], v[200:203], v[236:239], v[124:127]
    v_mfma_f32_16x16x32_bf16 v[140:143], v[204:207], v[236:239], v[140:143]
    v_mfma_f32_16x16x32_bf16 v[136:139], v[204:207], v[232:235], v[136:139]
    v_mfma_f32_16x16x32_bf16 v[132:135], v[204:207], v[228:231], v[132:135]
    v_mfma_f32_16x16x32_bf16 v[128:131], v[204:207], v[224:227], v[128:131]
    s_waitcnt lgkmcnt(0)
    v_mfma_f32_16x16x32_bf16 v[16:19], v[144:147], v[208:211], v[16:19]
    ds_read_b128 v[224:227], v9 offset:0
    v_mfma_f32_16x16x32_bf16 v[20:23], v[144:147], v[212:215], v[20:23]
    ds_read_b128 v[228:231], v9 offset:2048
    v_mfma_f32_16x16x32_bf16 v[24:27], v[144:147], v[216:219], v[24:27]
    ds_read_b128 v[232:235], v9 offset:4096
    v_mfma_f32_16x16x32_bf16 v[28:31], v[144:147], v[220:223], v[28:31]
    ds_read_b128 v[236:239], v9 offset:6144
    v_mfma_f32_16x16x32_bf16 v[44:47], v[148:151], v[220:223], v[44:47]
    ds_read_b64_tr_b16 v[176:177], v2 offset:36864
    v_mfma_f32_16x16x32_bf16 v[40:43], v[148:151], v[216:219], v[40:43]
    ds_read_b64_tr_b16 v[178:179], v2 offset:37376
    v_mfma_f32_16x16x32_bf16 v[36:39], v[148:151], v[212:215], v[36:39]
    ds_read_b64_tr_b16 v[180:181], v3 offset:36864
    v_mfma_f32_16x16x32_bf16 v[32:35], v[148:151], v[208:211], v[32:35]
    ds_read_b64_tr_b16 v[182:183], v3 offset:37376
    v_mfma_f32_16x16x32_bf16 v[48:51], v[152:155], v[208:211], v[48:51]
    ds_read_b64_tr_b16 v[184:185], v4 offset:36864
    v_mfma_f32_16x16x32_bf16 v[52:55], v[152:155], v[212:215], v[52:55]
    ds_read_b64_tr_b16 v[186:187], v4 offset:37376
    v_mfma_f32_16x16x32_bf16 v[56:59], v[152:155], v[216:219], v[56:59]
    ds_read_b64_tr_b16 v[188:189], v5 offset:36864
    v_mfma_f32_16x16x32_bf16 v[60:63], v[152:155], v[220:223], v[60:63]
    ds_read_b64_tr_b16 v[190:191], v5 offset:37376
    v_mfma_f32_16x16x32_bf16 v[76:79], v[156:159], v[220:223], v[76:79]
    ds_read_b64_tr_b16 v[192:193], v2 offset:45056
    v_mfma_f32_16x16x32_bf16 v[72:75], v[156:159], v[216:219], v[72:75]
    ds_read_b64_tr_b16 v[194:195], v2 offset:45568
    v_mfma_f32_16x16x32_bf16 v[68:71], v[156:159], v[212:215], v[68:71]
    ds_read_b64_tr_b16 v[196:197], v3 offset:45056
    v_mfma_f32_16x16x32_bf16 v[64:67], v[156:159], v[208:211], v[64:67]
    ds_read_b64_tr_b16 v[198:199], v3 offset:45568
    v_mfma_f32_16x16x32_bf16 v[80:83], v[160:163], v[208:211], v[80:83]
    ds_read_b64_tr_b16 v[200:201], v4 offset:45056
    v_mfma_f32_16x16x32_bf16 v[84:87], v[160:163], v[212:215], v[84:87]
    ds_read_b64_tr_b16 v[202:203], v4 offset:45568
    v_mfma_f32_16x16x32_bf16 v[88:91], v[160:163], v[216:219], v[88:91]
    ds_read_b64_tr_b16 v[204:205], v5 offset:45056
    v_mfma_f32_16x16x32_bf16 v[92:95], v[160:163], v[220:223], v[92:95]
    ds_read_b64_tr_b16 v[206:207], v5 offset:45568
    v_mfma_f32_16x16x32_bf16 v[108:111], v[164:167], v[220:223], v[108:111]
    v_mfma_f32_16x16x32_bf16 v[104:107], v[164:167], v[216:219], v[104:107]
    v_mfma_f32_16x16x32_bf16 v[100:103], v[164:167], v[212:215], v[100:103]
    v_mfma_f32_16x16x32_bf16 v[96:99], v[164:167], v[208:211], v[96:99]
    v_mfma_f32_16x16x32_bf16 v[112:115], v[168:171], v[208:211], v[112:115]
    v_mfma_f32_16x16x32_bf16 v[116:119], v[168:171], v[212:215], v[116:119]
    v_mfma_f32_16x16x32_bf16 v[120:123], v[168:171], v[216:219], v[120:123]
    v_mfma_f32_16x16x32_bf16 v[124:127], v[168:171], v[220:223], v[124:127]
    v_mfma_f32_16x16x32_bf16 v[140:143], v[172:175], v[220:223], v[140:143]
    v_mfma_f32_16x16x32_bf16 v[136:139], v[172:175], v[216:219], v[136:139]
    v_mfma_f32_16x16x32_bf16 v[132:135], v[172:175], v[212:215], v[132:135]
    v_mfma_f32_16x16x32_bf16 v[128:131], v[172:175], v[208:211], v[128:131]
    s_waitcnt lgkmcnt(0)
    s_barrier
    v_mfma_f32_16x16x32_bf16 v[16:19], v[176:179], v[224:227], v[16:19]
    ds_read_b128 v[208:211], v6 offset:0
    v_mfma_f32_16x16x32_bf16 v[20:23], v[176:179], v[228:231], v[20:23]
    ds_read_b128 v[212:215], v6 offset:2048
    v_mfma_f32_16x16x32_bf16 v[24:27], v[176:179], v[232:235], v[24:27]
    ds_read_b128 v[216:219], v6 offset:4096
    v_mfma_f32_16x16x32_bf16 v[28:31], v[176:179], v[236:239], v[28:31]
    ds_read_b128 v[220:223], v6 offset:6144
    v_mfma_f32_16x16x32_bf16 v[44:47], v[180:183], v[236:239], v[44:47]
    ds_read_b64_tr_b16 v[144:145], v2 offset:0
    v_mfma_f32_16x16x32_bf16 v[40:43], v[180:183], v[232:235], v[40:43]
    ds_read_b64_tr_b16 v[146:147], v2 offset:512
    v_mfma_f32_16x16x32_bf16 v[36:39], v[180:183], v[228:231], v[36:39]
    ds_read_b64_tr_b16 v[148:149], v3 offset:0
    v_mfma_f32_16x16x32_bf16 v[32:35], v[180:183], v[224:227], v[32:35]
    ds_read_b64_tr_b16 v[150:151], v3 offset:512
    v_mfma_f32_16x16x32_bf16 v[48:51], v[184:187], v[224:227], v[48:51]
    ds_read_b64_tr_b16 v[152:153], v4 offset:0
    v_mfma_f32_16x16x32_bf16 v[52:55], v[184:187], v[228:231], v[52:55]
    ds_read_b64_tr_b16 v[154:155], v4 offset:512
    v_mfma_f32_16x16x32_bf16 v[56:59], v[184:187], v[232:235], v[56:59]
    ds_read_b64_tr_b16 v[156:157], v5 offset:0
    v_mfma_f32_16x16x32_bf16 v[60:63], v[184:187], v[236:239], v[60:63]
    ds_read_b64_tr_b16 v[158:159], v5 offset:512
    v_mfma_f32_16x16x32_bf16 v[76:79], v[188:191], v[236:239], v[76:79]
    ds_read_b64_tr_b16 v[160:161], v2 offset:8192
    v_mfma_f32_16x16x32_bf16 v[72:75], v[188:191], v[232:235], v[72:75]
    ds_read_b64_tr_b16 v[162:163], v2 offset:8704
    v_mfma_f32_16x16x32_bf16 v[68:71], v[188:191], v[228:231], v[68:71]
    ds_read_b64_tr_b16 v[164:165], v3 offset:8192
    v_mfma_f32_16x16x32_bf16 v[64:67], v[188:191], v[224:227], v[64:67]
    ds_read_b64_tr_b16 v[166:167], v3 offset:8704
    v_mfma_f32_16x16x32_bf16 v[80:83], v[192:195], v[224:227], v[80:83]
    ds_read_b64_tr_b16 v[168:169], v4 offset:8192
    v_mfma_f32_16x16x32_bf16 v[84:87], v[192:195], v[228:231], v[84:87]
    ds_read_b64_tr_b16 v[170:171], v4 offset:8704
    v_mfma_f32_16x16x32_bf16 v[88:91], v[192:195], v[232:235], v[88:91]
    ds_read_b64_tr_b16 v[172:173], v5 offset:8192
    v_mfma_f32_16x16x32_bf16 v[92:95], v[192:195], v[236:239], v[92:95]
    ds_read_b64_tr_b16 v[174:175], v5 offset:8704
    v_mfma_f32_16x16x32_bf16 v[108:111], v[196:199], v[236:239], v[108:111]
    v_mfma_f32_16x16x32_bf16 v[104:107], v[196:199], v[232:235], v[104:107]
    v_mfma_f32_16x16x32_bf16 v[100:103], v[196:199], v[228:231], v[100:103]
    v_mfma_f32_16x16x32_bf16 v[96:99], v[196:199], v[224:227], v[96:99]
    v_mfma_f32_16x16x32_bf16 v[112:115], v[200:203], v[224:227], v[112:115]
    v_mfma_f32_16x16x32_bf16 v[116:119], v[200:203], v[228:231], v[116:119]
    v_mfma_f32_16x16x32_bf16 v[120:123], v[200:203], v[232:235], v[120:123]
    v_mfma_f32_16x16x32_bf16 v[124:127], v[200:203], v[236:239], v[124:127]
    v_mfma_f32_16x16x32_bf16 v[140:143], v[204:207], v[236:239], v[140:143]
    v_mfma_f32_16x16x32_bf16 v[136:139], v[204:207], v[232:235], v[136:139]
    v_mfma_f32_16x16x32_bf16 v[132:135], v[204:207], v[228:231], v[132:135]
    v_mfma_f32_16x16x32_bf16 v[128:131], v[204:207], v[224:227], v[128:131]
    s_waitcnt lgkmcnt(0)
    v_mov_b32 v240, 0
    buffer_load_dword v240, v240, s[36:39], 0 offen sc1
    v_mfma_f32_16x16x32_bf16 v[16:19], v[144:147], v[208:211], v[16:19]
    ds_read_b128 v[224:227], v7 offset:0
    v_mfma_f32_16x16x32_bf16 v[20:23], v[144:147], v[212:215], v[20:23]
    ds_read_b128 v[228:231], v7 offset:2048
    v_mfma_f32_16x16x32_bf16 v[24:27], v[144:147], v[216:219], v[24:27]
    ds_read_b128 v[232:235], v7 offset:4096
    v_mfma_f32_16x16x32_bf16 v[28:31], v[144:147], v[220:223], v[28:31]
    ds_read_b128 v[236:239], v7 offset:6144
    v_mfma_f32_16x16x32_bf16 v[44:47], v[148:151], v[220:223], v[44:47]
    ds_read_b64_tr_b16 v[176:177], v2 offset:4096
    v_mfma_f32_16x16x32_bf16 v[40:43], v[148:151], v[216:219], v[40:43]
    ds_read_b64_tr_b16 v[178:179], v2 offset:4608
    v_mfma_f32_16x16x32_bf16 v[36:39], v[148:151], v[212:215], v[36:39]
    ds_read_b64_tr_b16 v[180:181], v3 offset:4096
    v_mfma_f32_16x16x32_bf16 v[32:35], v[148:151], v[208:211], v[32:35]
    ds_read_b64_tr_b16 v[182:183], v3 offset:4608
    v_mfma_f32_16x16x32_bf16 v[48:51], v[152:155], v[208:211], v[48:51]
    ds_read_b64_tr_b16 v[184:185], v4 offset:4096
    v_mfma_f32_16x16x32_bf16 v[52:55], v[152:155], v[212:215], v[52:55]
    ds_read_b64_tr_b16 v[186:187], v4 offset:4608
    v_mfma_f32_16x16x32_bf16 v[56:59], v[152:155], v[216:219], v[56:59]
    ds_read_b64_tr_b16 v[188:189], v5 offset:4096
    v_mfma_f32_16x16x32_bf16 v[60:63], v[152:155], v[220:223], v[60:63]
    ds_read_b64_tr_b16 v[190:191], v5 offset:4608
    v_mfma_f32_16x16x32_bf16 v[76:79], v[156:159], v[220:223], v[76:79]
    ds_read_b64_tr_b16 v[192:193], v2 offset:12288
    v_mfma_f32_16x16x32_bf16 v[72:75], v[156:159], v[216:219], v[72:75]
    ds_read_b64_tr_b16 v[194:195], v2 offset:12800
    v_mfma_f32_16x16x32_bf16 v[68:71], v[156:159], v[212:215], v[68:71]
    ds_read_b64_tr_b16 v[196:197], v3 offset:12288
    v_mfma_f32_16x16x32_bf16 v[64:67], v[156:159], v[208:211], v[64:67]
    ds_read_b64_tr_b16 v[198:199], v3 offset:12800
    v_mfma_f32_16x16x32_bf16 v[80:83], v[160:163], v[208:211], v[80:83]
    ds_read_b64_tr_b16 v[200:201], v4 offset:12288
    v_mfma_f32_16x16x32_bf16 v[84:87], v[160:163], v[212:215], v[84:87]
    ds_read_b64_tr_b16 v[202:203], v4 offset:12800
    v_mfma_f32_16x16x32_bf16 v[88:91], v[160:163], v[216:219], v[88:91]
    ds_read_b64_tr_b16 v[204:205], v5 offset:12288
    v_mfma_f32_16x16x32_bf16 v[92:95], v[160:163], v[220:223], v[92:95]
    ds_read_b64_tr_b16 v[206:207], v5 offset:12800
    v_mfma_f32_16x16x32_bf16 v[108:111], v[164:167], v[220:223], v[108:111]
    v_mfma_f32_16x16x32_bf16 v[104:107], v[164:167], v[216:219], v[104:107]
    v_mfma_f32_16x16x32_bf16 v[100:103], v[164:167], v[212:215], v[100:103]
    v_mfma_f32_16x16x32_bf16 v[96:99], v[164:167], v[208:211], v[96:99]
    v_mfma_f32_16x16x32_bf16 v[112:115], v[168:171], v[208:211], v[112:115]
    v_mfma_f32_16x16x32_bf16 v[116:119], v[168:171], v[212:215], v[116:119]
    v_mfma_f32_16x16x32_bf16 v[120:123], v[168:171], v[216:219], v[120:123]
    v_mfma_f32_16x16x32_bf16 v[124:127], v[168:171], v[220:223], v[124:127]
    v_mfma_f32_16x16x32_bf16 v[140:143], v[172:175], v[220:223], v[140:143]
    v_mfma_f32_16x16x32_bf16 v[136:139], v[172:175], v[216:219], v[136:139]
    v_mfma_f32_16x16x32_bf16 v[132:135], v[172:175], v[212:215], v[132:135]
    v_mfma_f32_16x16x32_bf16 v[128:131], v[172:175], v[208:211], v[128:131]
    s_waitcnt lgkmcnt(0)
    s_barrier
    v_mfma_f32_16x16x32_bf16 v[16:19], v[176:179], v[224:227], v[16:19]
    ds_read_b128 v[208:211], v6 offset:32768
    v_mfma_f32_16x16x32_bf16 v[20:23], v[176:179], v[228:231], v[20:23]
    ds_read_b128 v[212:215], v6 offset:34816
    v_mfma_f32_16x16x32_bf16 v[24:27], v[176:179], v[232:235], v[24:27]
    ds_read_b128 v[216:219], v6 offset:36864
    v_mfma_f32_16x16x32_bf16 v[28:31], v[176:179], v[236:239], v[28:31]
    ds_read_b128 v[220:223], v6 offset:38912
    v_mfma_f32_16x16x32_bf16 v[44:47], v[180:183], v[236:239], v[44:47]
    ds_read_b64_tr_b16 v[144:145], v2 offset:16384
    v_mfma_f32_16x16x32_bf16 v[40:43], v[180:183], v[232:235], v[40:43]
    ds_read_b64_tr_b16 v[146:147], v2 offset:16896
    v_mfma_f32_16x16x32_bf16 v[36:39], v[180:183], v[228:231], v[36:39]
    ds_read_b64_tr_b16 v[148:149], v3 offset:16384
    v_mfma_f32_16x16x32_bf16 v[32:35], v[180:183], v[224:227], v[32:35]
    ds_read_b64_tr_b16 v[150:151], v3 offset:16896
    v_mfma_f32_16x16x32_bf16 v[48:51], v[184:187], v[224:227], v[48:51]
    ds_read_b64_tr_b16 v[152:153], v4 offset:16384
    v_mfma_f32_16x16x32_bf16 v[52:55], v[184:187], v[228:231], v[52:55]
    ds_read_b64_tr_b16 v[154:155], v4 offset:16896
    v_mfma_f32_16x16x32_bf16 v[56:59], v[184:187], v[232:235], v[56:59]
    ds_read_b64_tr_b16 v[156:157], v5 offset:16384
    v_mfma_f32_16x16x32_bf16 v[60:63], v[184:187], v[236:239], v[60:63]
    ds_read_b64_tr_b16 v[158:159], v5 offset:16896
    v_mfma_f32_16x16x32_bf16 v[76:79], v[188:191], v[236:239], v[76:79]
    ds_read_b64_tr_b16 v[160:161], v2 offset:24576
    v_mfma_f32_16x16x32_bf16 v[72:75], v[188:191], v[232:235], v[72:75]
    ds_read_b64_tr_b16 v[162:163], v2 offset:25088
    v_mfma_f32_16x16x32_bf16 v[68:71], v[188:191], v[228:231], v[68:71]
    ds_read_b64_tr_b16 v[164:165], v3 offset:24576
    v_mfma_f32_16x16x32_bf16 v[64:67], v[188:191], v[224:227], v[64:67]
    ds_read_b64_tr_b16 v[166:167], v3 offset:25088
    v_mfma_f32_16x16x32_bf16 v[80:83], v[192:195], v[224:227], v[80:83]
    ds_read_b64_tr_b16 v[168:169], v4 offset:24576
    v_mfma_f32_16x16x32_bf16 v[84:87], v[192:195], v[228:231], v[84:87]
    ds_read_b64_tr_b16 v[170:171], v4 offset:25088
    v_mfma_f32_16x16x32_bf16 v[88:91], v[192:195], v[232:235], v[88:91]
    ds_read_b64_tr_b16 v[172:173], v5 offset:24576
    v_mfma_f32_16x16x32_bf16 v[92:95], v[192:195], v[236:239], v[92:95]
    ds_read_b64_tr_b16 v[174:175], v5 offset:25088
    v_mfma_f32_16x16x32_bf16 v[108:111], v[196:199], v[236:239], v[108:111]
    v_mfma_f32_16x16x32_bf16 v[104:107], v[196:199], v[232:235], v[104:107]
    v_mfma_f32_16x16x32_bf16 v[100:103], v[196:199], v[228:231], v[100:103]
    v_mfma_f32_16x16x32_bf16 v[96:99], v[196:199], v[224:227], v[96:99]
    v_mfma_f32_16x16x32_bf16 v[112:115], v[200:203], v[224:227], v[112:115]
    v_mfma_f32_16x16x32_bf16 v[116:119], v[200:203], v[228:231], v[116:119]
    v_mfma_f32_16x16x32_bf16 v[120:123], v[200:203], v[232:235], v[120:123]
    v_mfma_f32_16x16x32_bf16 v[124:127], v[200:203], v[236:239], v[124:127]
    v_mfma_f32_16x16x32_bf16 v[140:143], v[204:207], v[236:239], v[140:143]
    v_mfma_f32_16x16x32_bf16 v[136:139], v[204:207], v[232:235], v[136:139]
    v_mfma_f32_16x16x32_bf16 v[132:135], v[204:207], v[228:231], v[132:135]
    v_mfma_f32_16x16x32_bf16 v[128:131], v[204:207], v[224:227], v[128:131]
    s_waitcnt lgkmcnt(0)
    v_mfma_f32_16x16x32_bf16 v[16:19], v[144:147], v[208:211], v[16:19]
    ds_read_b128 v[224:227], v7 offset:32768
    v_mfma_f32_16x16x32_bf16 v[20:23], v[144:147], v[212:215], v[20:23]
    ds_read_b128 v[228:231], v7 offset:34816
    v_mfma_f32_16x16x32_bf16 v[24:27], v[144:147], v[216:219], v[24:27]
    ds_read_b128 v[232:235], v7 offset:36864
    v_mfma_f32_16x16x32_bf16 v[28:31], v[144:147], v[220:223], v[28:31]
    ds_read_b128 v[236:239], v7 offset:38912
    v_mfma_f32_16x16x32_bf16 v[44:47], v[148:151], v[220:223], v[44:47]
    ds_read_b64_tr_b16 v[176:177], v2 offset:20480
    v_mfma_f32_16x16x32_bf16 v[40:43], v[148:151], v[216:219], v[40:43]
    ds_read_b64_tr_b16 v[178:179], v2 offset:20992
    v_mfma_f32_16x16x32_bf16 v[36:39], v[148:151], v[212:215], v[36:39]
    ds_read_b64_tr_b16 v[180:181], v3 offset:20480
    v_mfma_f32_16x16x32_bf16 v[32:35], v[148:151], v[208:211], v[32:35]
    ds_read_b64_tr_b16 v[182:183], v3 offset:20992
    v_mfma_f32_16x16x32_bf16 v[48:51], v[152:155], v[208:211], v[48:51]
    ds_read_b64_tr_b16 v[184:185], v4 offset:20480
    v_mfma_f32_16x16x32_bf16 v[52:55], v[152:155], v[212:215], v[52:55]
    ds_read_b64_tr_b16 v[186:187], v4 offset:20992
    v_mfma_f32_16x16x32_bf16 v[56:59], v[152:155], v[216:219], v[56:59]
    ds_read_b64_tr_b16 v[188:189], v5 offset:20480
    v_mfma_f32_16x16x32_bf16 v[60:63], v[152:155], v[220:223], v[60:63]
    ds_read_b64_tr_b16 v[190:191], v5 offset:20992
    v_mfma_f32_16x16x32_bf16 v[76:79], v[156:159], v[220:223], v[76:79]
    ds_read_b64_tr_b16 v[192:193], v2 offset:28672
    v_mfma_f32_16x16x32_bf16 v[72:75], v[156:159], v[216:219], v[72:75]
    ds_read_b64_tr_b16 v[194:195], v2 offset:29184
    v_mfma_f32_16x16x32_bf16 v[68:71], v[156:159], v[212:215], v[68:71]
    ds_read_b64_tr_b16 v[196:197], v3 offset:28672
    v_mfma_f32_16x16x32_bf16 v[64:67], v[156:159], v[208:211], v[64:67]
    ds_read_b64_tr_b16 v[198:199], v3 offset:29184
    v_mfma_f32_16x16x32_bf16 v[80:83], v[160:163], v[208:211], v[80:83]
    ds_read_b64_tr_b16 v[200:201], v4 offset:28672
    v_mfma_f32_16x16x32_bf16 v[84:87], v[160:163], v[212:215], v[84:87]
    ds_read_b64_tr_b16 v[202:203], v4 offset:29184
    v_mfma_f32_16x16x32_bf16 v[88:91], v[160:163], v[216:219], v[88:91]
    ds_read_b64_tr_b16 v[204:205], v5 offset:28672
    v_mfma_f32_16x16x32_bf16 v[92:95], v[160:163], v[220:223], v[92:95]
    ds_read_b64_tr_b16 v[206:207], v5 offset:29184
    v_mfma_f32_16x16x32_bf16 v[108:111], v[164:167], v[220:223], v[108:111]
    v_mfma_f32_16x16x32_bf16 v[104:107], v[164:167], v[216:219], v[104:107]
    v_mfma_f32_16x16x32_bf16 v[100:103], v[164:167], v[212:215], v[100:103]
    v_mfma_f32_16x16x32_bf16 v[96:99], v[164:167], v[208:211], v[96:99]
    v_mfma_f32_16x16x32_bf16 v[112:115], v[168:171], v[208:211], v[112:115]
    v_mfma_f32_16x16x32_bf16 v[116:119], v[168:171], v[212:215], v[116:119]
    v_mfma_f32_16x16x32_bf16 v[120:123], v[168:171], v[216:219], v[120:123]
    v_mfma_f32_16x16x32_bf16 v[124:127], v[168:171], v[220:223], v[124:127]
    v_mfma_f32_16x16x32_bf16 v[140:143], v[172:175], v[220:223], v[140:143]
    v_mfma_f32_16x16x32_bf16 v[136:139], v[172:175], v[216:219], v[136:139]
    v_mfma_f32_16x16x32_bf16 v[132:135], v[172:175], v[212:215], v[132:135]
    v_mfma_f32_16x16x32_bf16 v[128:131], v[172:175], v[208:211], v[128:131]
    s_waitcnt lgkmcnt(0)
    s_barrier
    v_mfma_f32_16x16x32_bf16 v[16:19], v[176:179], v[224:227], v[16:19]
    ds_read_b128 v[208:211], v8 offset:0
    v_mfma_f32_16x16x32_bf16 v[20:23], v[176:179], v[228:231], v[20:23]
    ds_read_b128 v[212:215], v8 offset:2048
    v_mfma_f32_16x16x32_bf16 v[24:27], v[176:179], v[232:235], v[24:27]
    ds_read_b128 v[216:219], v8 offset:4096
    v_mfma_f32_16x16x32_bf16 v[28:31], v[176:179], v[236:239], v[28:31]
    ds_read_b128 v[220:223], v8 offset:6144
    v_mfma_f32_16x16x32_bf16 v[44:47], v[180:183], v[236:239], v[44:47]
    ds_read_b64_tr_b16 v[144:145], v2 offset:32768
    v_mfma_f32_16x16x32_bf16 v[40:43], v[180:183], v[232:235], v[40:43]
    ds_read_b64_tr_b16 v[146:147], v2 offset:33280
    v_mfma_f32_16x16x32_bf16 v[36:39], v[180:183], v[228:231], v[36:39]
    ds_read_b64_tr_b16 v[148:149], v3 offset:32768
    v_mfma_f32_16x16x32_bf16 v[32:35], v[180:183], v[224:227], v[32:35]
    ds_read_b64_tr_b16 v[150:151], v3 offset:33280
    v_mfma_f32_16x16x32_bf16 v[48:51], v[184:187], v[224:227], v[48:51]
    ds_read_b64_tr_b16 v[152:153], v4 offset:32768
    v_mfma_f32_16x16x32_bf16 v[52:55], v[184:187], v[228:231], v[52:55]
    ds_read_b64_tr_b16 v[154:155], v4 offset:33280
    v_mfma_f32_16x16x32_bf16 v[56:59], v[184:187], v[232:235], v[56:59]
    ds_read_b64_tr_b16 v[156:157], v5 offset:32768
    v_mfma_f32_16x16x32_bf16 v[60:63], v[184:187], v[236:239], v[60:63]
    ds_read_b64_tr_b16 v[158:159], v5 offset:33280
    v_mfma_f32_16x16x32_bf16 v[76:79], v[188:191], v[236:239], v[76:79]
    ds_read_b64_tr_b16 v[160:161], v2 offset:40960
    v_mfma_f32_16x16x32_bf16 v[72:75], v[188:191], v[232:235], v[72:75]
    ds_read_b64_tr_b16 v[162:163], v2 offset:41472
    v_mfma_f32_16x16x32_bf16 v[68:71], v[188:191], v[228:231], v[68:71]
    ds_read_b64_tr_b16 v[164:165], v3 offset:40960
    v_mfma_f32_16x16x32_bf16 v[64:67], v[188:191], v[224:227], v[64:67]
    ds_read_b64_tr_b16 v[166:167], v3 offset:41472
    v_mfma_f32_16x16x32_bf16 v[80:83], v[192:195], v[224:227], v[80:83]
    ds_read_b64_tr_b16 v[168:169], v4 offset:40960
    v_mfma_f32_16x16x32_bf16 v[84:87], v[192:195], v[228:231], v[84:87]
    ds_read_b64_tr_b16 v[170:171], v4 offset:41472
    v_mfma_f32_16x16x32_bf16 v[88:91], v[192:195], v[232:235], v[88:91]
    ds_read_b64_tr_b16 v[172:173], v5 offset:40960
    v_mfma_f32_16x16x32_bf16 v[92:95], v[192:195], v[236:239], v[92:95]
    ds_read_b64_tr_b16 v[174:175], v5 offset:41472
    v_mfma_f32_16x16x32_bf16 v[108:111], v[196:199], v[236:239], v[108:111]
    v_mfma_f32_16x16x32_bf16 v[104:107], v[196:199], v[232:235], v[104:107]
    v_mfma_f32_16x16x32_bf16 v[100:103], v[196:199], v[228:231], v[100:103]
    v_mfma_f32_16x16x32_bf16 v[96:99], v[196:199], v[224:227], v[96:99]
    v_mfma_f32_16x16x32_bf16 v[112:115], v[200:203], v[224:227], v[112:115]
    v_mfma_f32_16x16x32_bf16 v[116:119], v[200:203], v[228:231], v[116:119]
    v_mfma_f32_16x16x32_bf16 v[120:123], v[200:203], v[232:235], v[120:123]
    v_mfma_f32_16x16x32_bf16 v[124:127], v[200:203], v[236:239], v[124:127]
    v_mfma_f32_16x16x32_bf16 v[140:143], v[204:207], v[236:239], v[140:143]
    v_mfma_f32_16x16x32_bf16 v[136:139], v[204:207], v[232:235], v[136:139]
    v_mfma_f32_16x16x32_bf16 v[132:135], v[204:207], v[228:231], v[132:135]
    v_mfma_f32_16x16x32_bf16 v[128:131], v[204:207], v[224:227], v[128:131]
    s_waitcnt lgkmcnt(0)
    v_mfma_f32_16x16x32_bf16 v[16:19], v[144:147], v[208:211], v[16:19]
    ds_read_b128 v[224:227], v9 offset:0
    v_mfma_f32_16x16x32_bf16 v[20:23], v[144:147], v[212:215], v[20:23]
    ds_read_b128 v[228:231], v9 offset:2048
    v_mfma_f32_16x16x32_bf16 v[24:27], v[144:147], v[216:219], v[24:27]
    ds_read_b128 v[232:235], v9 offset:4096
    v_mfma_f32_16x16x32_bf16 v[28:31], v[144:147], v[220:223], v[28:31]
    ds_read_b128 v[236:239], v9 offset:6144
    v_mfma_f32_16x16x32_bf16 v[44:47], v[148:151], v[220:223], v[44:47]
    ds_read_b64_tr_b16 v[176:177], v2 offset:36864
    v_mfma_f32_16x16x32_bf16 v[40:43], v[148:151], v[216:219], v[40:43]
    ds_read_b64_tr_b16 v[178:179], v2 offset:37376
    v_mfma_f32_16x16x32_bf16 v[36:39], v[148:151], v[212:215], v[36:39]
    ds_read_b64_tr_b16 v[180:181], v3 offset:36864
    v_mfma_f32_16x16x32_bf16 v[32:35], v[148:151], v[208:211], v[32:35]
    ds_read_b64_tr_b16 v[182:183], v3 offset:37376
    v_mfma_f32_16x16x32_bf16 v[48:51], v[152:155], v[208:211], v[48:51]
    ds_read_b64_tr_b16 v[184:185], v4 offset:36864
    v_mfma_f32_16x16x32_bf16 v[52:55], v[152:155], v[212:215], v[52:55]
    ds_read_b64_tr_b16 v[186:187], v4 offset:37376
    v_mfma_f32_16x16x32_bf16 v[56:59], v[152:155], v[216:219], v[56:59]
    ds_read_b64_tr_b16 v[188:189], v5 offset:36864
    v_mfma_f32_16x16x32_bf16 v[60:63], v[152:155], v[220:223], v[60:63]
    ds_read_b64_tr_b16 v[190:191], v5 offset:37376
    v_mfma_f32_16x16x32_bf16 v[76:79], v[156:159], v[220:223], v[76:79]
    ds_read_b64_tr_b16 v[192:193], v2 offset:45056
    v_mfma_f32_16x16x32_bf16 v[72:75], v[156:159], v[216:219], v[72:75]
    ds_read_b64_tr_b16 v[194:195], v2 offset:45568
    v_mfma_f32_16x16x32_bf16 v[68:71], v[156:159], v[212:215], v[68:71]
    ds_read_b64_tr_b16 v[196:197], v3 offset:45056
    v_mfma_f32_16x16x32_bf16 v[64:67], v[156:159], v[208:211], v[64:67]
    ds_read_b64_tr_b16 v[198:199], v3 offset:45568
    v_mfma_f32_16x16x32_bf16 v[80:83], v[160:163], v[208:211], v[80:83]
    ds_read_b64_tr_b16 v[200:201], v4 offset:45056
    v_mfma_f32_16x16x32_bf16 v[84:87], v[160:163], v[212:215], v[84:87]
    ds_read_b64_tr_b16 v[202:203], v4 offset:45568
    v_mfma_f32_16x16x32_bf16 v[88:91], v[160:163], v[216:219], v[88:91]
    ds_read_b64_tr_b16 v[204:205], v5 offset:45056
    v_mfma_f32_16x16x32_bf16 v[92:95], v[160:163], v[220:223], v[92:95]
    ds_read_b64_tr_b16 v[206:207], v5 offset:45568
    v_mfma_f32_16x16x32_bf16 v[108:111], v[164:167], v[220:223], v[108:111]
    v_mfma_f32_16x16x32_bf16 v[104:107], v[164:167], v[216:219], v[104:107]
    v_mfma_f32_16x16x32_bf16 v[100:103], v[164:167], v[212:215], v[100:103]
    v_mfma_f32_16x16x32_bf16 v[96:99], v[164:167], v[208:211], v[96:99]
    v_mfma_f32_16x16x32_bf16 v[112:115], v[168:171], v[208:211], v[112:115]
    v_mfma_f32_16x16x32_bf16 v[116:119], v[168:171], v[212:215], v[116:119]
    v_mfma_f32_16x16x32_bf16 v[120:123], v[168:171], v[216:219], v[120:123]
    v_mfma_f32_16x16x32_bf16 v[124:127], v[168:171], v[220:223], v[124:127]
    v_mfma_f32_16x16x32_bf16 v[140:143], v[172:175], v[220:223], v[140:143]
    v_mfma_f32_16x16x32_bf16 v[136:139], v[172:175], v[216:219], v[136:139]
    v_mfma_f32_16x16x32_bf16 v[132:135], v[172:175], v[212:215], v[132:135]
    v_mfma_f32_16x16x32_bf16 v[128:131], v[172:175], v[208:211], v[128:131]
    s_waitcnt lgkmcnt(0)
    s_barrier
    v_mfma_f32_16x16x32_bf16 v[16:19], v[176:179], v[224:227], v[16:19]
    ds_read_b128 v[208:211], v6 offset:0
    v_mfma_f32_16x16x32_bf16 v[20:23], v[176:179], v[228:231], v[20:23]
    ds_read_b128 v[212:215], v6 offset:2048
    v_mfma_f32_16x16x32_bf16 v[24:27], v[176:179], v[232:235], v[24:27]
    ds_read_b128 v[216:219], v6 offset:4096
    v_mfma_f32_16x16x32_bf16 v[28:31], v[176:179], v[236:239], v[28:31]
    ds_read_b128 v[220:223], v6 offset:6144
    v_mfma_f32_16x16x32_bf16 v[44:47], v[180:183], v[236:239], v[44:47]
    ds_read_b64_tr_b16 v[144:145], v2 offset:0
    v_mfma_f32_16x16x32_bf16 v[40:43], v[180:183], v[232:235], v[40:43]
    ds_read_b64_tr_b16 v[146:147], v2 offset:512
    v_mfma_f32_16x16x32_bf16 v[36:39], v[180:183], v[228:231], v[36:39]
    ds_read_b64_tr_b16 v[148:149], v3 offset:0
    v_mfma_f32_16x16x32_bf16 v[32:35], v[180:183], v[224:227], v[32:35]
    ds_read_b64_tr_b16 v[150:151], v3 offset:512
    v_mfma_f32_16x16x32_bf16 v[48:51], v[184:187], v[224:227], v[48:51]
    ds_read_b64_tr_b16 v[152:153], v4 offset:0
    v_mfma_f32_16x16x32_bf16 v[52:55], v[184:187], v[228:231], v[52:55]
    ds_read_b64_tr_b16 v[154:155], v4 offset:512
    v_mfma_f32_16x16x32_bf16 v[56:59], v[184:187], v[232:235], v[56:59]
    ds_read_b64_tr_b16 v[156:157], v5 offset:0
    v_mfma_f32_16x16x32_bf16 v[60:63], v[184:187], v[236:239], v[60:63]
    ds_read_b64_tr_b16 v[158:159], v5 offset:512
    v_mfma_f32_16x16x32_bf16 v[76:79], v[188:191], v[236:239], v[76:79]
    ds_read_b64_tr_b16 v[160:161], v2 offset:8192
    v_mfma_f32_16x16x32_bf16 v[72:75], v[188:191], v[232:235], v[72:75]
    ds_read_b64_tr_b16 v[162:163], v2 offset:8704
    v_mfma_f32_16x16x32_bf16 v[68:71], v[188:191], v[228:231], v[68:71]
    ds_read_b64_tr_b16 v[164:165], v3 offset:8192
    v_mfma_f32_16x16x32_bf16 v[64:67], v[188:191], v[224:227], v[64:67]
    ds_read_b64_tr_b16 v[166:167], v3 offset:8704
    v_mfma_f32_16x16x32_bf16 v[80:83], v[192:195], v[224:227], v[80:83]
    ds_read_b64_tr_b16 v[168:169], v4 offset:8192
    v_mfma_f32_16x16x32_bf16 v[84:87], v[192:195], v[228:231], v[84:87]
    ds_read_b64_tr_b16 v[170:171], v4 offset:8704
    v_mfma_f32_16x16x32_bf16 v[88:91], v[192:195], v[232:235], v[88:91]
    ds_read_b64_tr_b16 v[172:173], v5 offset:8192
    v_mfma_f32_16x16x32_bf16 v[92:95], v[192:195], v[236:239], v[92:95]
    ds_read_b64_tr_b16 v[174:175], v5 offset:8704
    v_mfma_f32_16x16x32_bf16 v[108:111], v[196:199], v[236:239], v[108:111]
    v_mfma_f32_16x16x32_bf16 v[104:107], v[196:199], v[232:235], v[104:107]
    v_mfma_f32_16x16x32_bf16 v[100:103], v[196:199], v[228:231], v[100:103]
    v_mfma_f32_16x16x32_bf16 v[96:99], v[196:199], v[224:227], v[96:99]
    v_mfma_f32_16x16x32_bf16 v[112:115], v[200:203], v[224:227], v[112:115]
    v_mfma_f32_16x16x32_bf16 v[116:119], v[200:203], v[228:231], v[116:119]
    v_mfma_f32_16x16x32_bf16 v[120:123], v[200:203], v[232:235], v[120:123]
    v_mfma_f32_16x16x32_bf16 v[124:127], v[200:203], v[236:239], v[124:127]
    v_mfma_f32_16x16x32_bf16 v[140:143], v[204:207], v[236:239], v[140:143]
    v_mfma_f32_16x16x32_bf16 v[136:139], v[204:207], v[232:235], v[136:139]
    v_mfma_f32_16x16x32_bf16 v[132:135], v[204:207], v[228:231], v[132:135]
    v_mfma_f32_16x16x32_bf16 v[128:131], v[204:207], v[224:227], v[128:131]
    s_waitcnt lgkmcnt(0)
    v_mfma_f32_16x16x32_bf16 v[16:19], v[144:147], v[208:211], v[16:19]
    ds_read_b128 v[224:227], v7 offset:0
    v_mfma_f32_16x16x32_bf16 v[20:23], v[144:147], v[212:215], v[20:23]
    ds_read_b128 v[228:231], v7 offset:2048
    v_mfma_f32_16x16x32_bf16 v[24:27], v[144:147], v[216:219], v[24:27]
    ds_read_b128 v[232:235], v7 offset:4096
    v_mfma_f32_16x16x32_bf16 v[28:31], v[144:147], v[220:223], v[28:31]
    ds_read_b128 v[236:239], v7 offset:6144
    v_mfma_f32_16x16x32_bf16 v[44:47], v[148:151], v[220:223], v[44:47]
    ds_read_b64_tr_b16 v[176:177], v2 offset:4096
    v_mfma_f32_16x16x32_bf16 v[40:43], v[148:151], v[216:219], v[40:43]
    ds_read_b64_tr_b16 v[178:179], v2 offset:4608
    v_mfma_f32_16x16x32_bf16 v[36:39], v[148:151], v[212:215], v[36:39]
    ds_read_b64_tr_b16 v[180:181], v3 offset:4096
    v_mfma_f32_16x16x32_bf16 v[32:35], v[148:151], v[208:211], v[32:35]
    ds_read_b64_tr_b16 v[182:183], v3 offset:4608
    v_mfma_f32_16x16x32_bf16 v[48:51], v[152:155], v[208:211], v[48:51]
    ds_read_b64_tr_b16 v[184:185], v4 offset:4096
    v_mfma_f32_16x16x32_bf16 v[52:55], v[152:155], v[212:215], v[52:55]
    ds_read_b64_tr_b16 v[186:187], v4 offset:4608
    v_mfma_f32_16x16x32_bf16 v[56:59], v[152:155], v[216:219], v[56:59]
    ds_read_b64_tr_b16 v[188:189], v5 offset:4096
    v_mfma_f32_16x16x32_bf16 v[60:63], v[152:155], v[220:223], v[60:63]
    ds_read_b64_tr_b16 v[190:191], v5 offset:4608
    v_mfma_f32_16x16x32_bf16 v[76:79], v[156:159], v[220:223], v[76:79]
    ds_read_b64_tr_b16 v[192:193], v2 offset:12288
    v_mfma_f32_16x16x32_bf16 v[72:75], v[156:159], v[216:219], v[72:75]
    ds_read_b64_tr_b16 v[194:195], v2 offset:12800
    v_mfma_f32_16x16x32_bf16 v[68:71], v[156:159], v[212:215], v[68:71]
    ds_read_b64_tr_b16 v[196:197], v3 offset:12288
    v_mfma_f32_16x16x32_bf16 v[64:67], v[156:159], v[208:211], v[64:67]
    ds_read_b64_tr_b16 v[198:199], v3 offset:12800
    v_mfma_f32_16x16x32_bf16 v[80:83], v[160:163], v[208:211], v[80:83]
    ds_read_b64_tr_b16 v[200:201], v4 offset:12288
    v_mfma_f32_16x16x32_bf16 v[84:87], v[160:163], v[212:215], v[84:87]
    ds_read_b64_tr_b16 v[202:203], v4 offset:12800
    v_mfma_f32_16x16x32_bf16 v[88:91], v[160:163], v[216:219], v[88:91]
    ds_read_b64_tr_b16 v[204:205], v5 offset:12288
    v_mfma_f32_16x16x32_bf16 v[92:95], v[160:163], v[220:223], v[92:95]
    ds_read_b64_tr_b16 v[206:207], v5 offset:12800
    v_mfma_f32_16x16x32_bf16 v[108:111], v[164:167], v[220:223], v[108:111]
    v_mfma_f32_16x16x32_bf16 v[104:107], v[164:167], v[216:219], v[104:107]
    v_mfma_f32_16x16x32_bf16 v[100:103], v[164:167], v[212:215], v[100:103]
    v_mfma_f32_16x16x32_bf16 v[96:99], v[164:167], v[208:211], v[96:99]
    v_mfma_f32_16x16x32_bf16 v[112:115], v[168:171], v[208:211], v[112:115]
    v_mfma_f32_16x16x32_bf16 v[116:119], v[168:171], v[212:215], v[116:119]
    v_mfma_f32_16x16x32_bf16 v[120:123], v[168:171], v[216:219], v[120:123]
    v_mfma_f32_16x16x32_bf16 v[124:127], v[168:171], v[220:223], v[124:127]
    v_mfma_f32_16x16x32_bf16 v[140:143], v[172:175], v[220:223], v[140:143]
    v_mfma_f32_16x16x32_bf16 v[136:139], v[172:175], v[216:219], v[136:139]
    v_mfma_f32_16x16x32_bf16 v[132:135], v[172:175], v[212:215], v[132:135]
    v_mfma_f32_16x16x32_bf16 v[128:131], v[172:175], v[208:211], v[128:131]
    s_waitcnt lgkmcnt(0)
    s_barrier
    v_mfma_f32_16x16x32_bf16 v[16:19], v[176:179], v[224:227], v[16:19]
    v_lshrrev_b32 v10, 4, v0
    v_mfma_f32_16x16x32_bf16 v[32:35], v[180:183], v[224:227], v[32:35]
    v_lshlrev_b32 v10, 4, v10
    v_mfma_f32_16x16x32_bf16 v[48:51], v[184:187], v[224:227], v[48:51]
    v_add_u32 v10, 161792, v10
    v_mfma_f32_16x16x32_bf16 v[64:67], v[188:191], v[224:227], v[64:67]
    v_and_b32 v15, 15, v0
    v_mfma_f32_16x16x32_bf16 v[80:83], v[192:195], v[224:227], v[80:83]
    s_lshl_b32 s44, s3, 9
    v_mfma_f32_16x16x32_bf16 v[96:99], v[196:199], v[224:227], v[96:99]
    s_add_u32 s44, s44, 159744
    v_mfma_f32_16x16x32_bf16 v[112:115], v[200:203], v[224:227], v[112:115]
    v_lshl_add_u32 v15, v15, 3, s44
    v_mfma_f32_16x16x32_bf16 v[128:131], v[204:207], v[224:227], v[128:131]
    v_mfma_f32_16x16x32_bf16 v[20:23], v[176:179], v[228:231], v[20:23]
    v_mfma_f32_16x16x32_bf16 v[36:39], v[180:183], v[228:231], v[36:39]
    v_mfma_f32_16x16x32_bf16 v[52:55], v[184:187], v[228:231], v[52:55]
    v_mfma_f32_16x16x32_bf16 v[68:71], v[188:191], v[228:231], v[68:71]
    v_mfma_f32_16x16x32_bf16 v[84:87], v[192:195], v[228:231], v[84:87]
    v_mfma_f32_16x16x32_bf16 v[100:103], v[196:199], v[228:231], v[100:103]
    v_mfma_f32_16x16x32_bf16 v[116:119], v[200:203], v[228:231], v[116:119]
    v_mfma_f32_16x16x32_bf16 v[132:135], v[204:207], v[228:231], v[132:135]
    v_mfma_f32_16x16x32_bf16 v[24:27], v[176:179], v[232:235], v[24:27]
    v_mfma_f32_16x16x32_bf16 v[40:43], v[180:183], v[232:235], v[40:43]
    v_mfma_f32_16x16x32_bf16 v[56:59], v[184:187], v[232:235], v[56:59]
    v_mfma_f32_16x16x32_bf16 v[72:75], v[188:191], v[232:235], v[72:75]
    v_mfma_f32_16x16x32_bf16 v[88:91], v[192:195], v[232:235], v[88:91]
    v_mfma_f32_16x16x32_bf16 v[104:107], v[196:199], v[232:235], v[104:107]
    v_mfma_f32_16x16x32_bf16 v[120:123], v[200:203], v[232:235], v[120:123]
    v_mfma_f32_16x16x32_bf16 v[136:139], v[204:207], v[232:235], v[136:139]
    v_mfma_f32_16x16x32_bf16 v[28:31], v[176:179], v[236:239], v[28:31]
    v_mfma_f32_16x16x32_bf16 v[44:47], v[180:183], v[236:239], v[44:47]
    v_mfma_f32_16x16x32_bf16 v[60:63], v[184:187], v[236:239], v[60:63]
    v_mfma_f32_16x16x32_bf16 v[76:79], v[188:191], v[236:239], v[76:79]
    v_mfma_f32_16x16x32_bf16 v[92:95], v[192:195], v[236:239], v[92:95]
    v_mfma_f32_16x16x32_bf16 v[108:111], v[196:199], v[236:239], v[108:111]
    v_mfma_f32_16x16x32_bf16 v[124:127], v[200:203], v[236:239], v[124:127]
    v_mfma_f32_16x16x32_bf16 v[140:143], v[204:207], v[236:239], v[140:143]
    s_waitcnt lgkmcnt(0)
    v_bfe_u32 v12, v0, 4, 1
    v_lshlrev_b32 v12, 1, v12
    v_lshrrev_b32 v13, 5, v0
    v_add_u32 v12, v12, v13
    s_lshl_b32 s46, s5, 3
    v_add_lshl_u32 v12, v12, s46, 8
    v_and_b32 v11, 15, v0
    v_lshl_add_u32 v14, v11, 4, v12
    s_lshl_b32 s46, s4, 4
    s_lshl_b32 s47, s3, 2
    s_add_u32 s46, s46, s47
    s_mul_i32 s46, s46, 55296
    s_add_u32 s57, s46, 0x800000
    s_waitcnt vmcnt(0)
    v_readfirstlane_b32 s11, v240
    s_cmp_eq_u32 s11, 0
    s_cbranch_scc1 L_slow_m_1
L_back_m_1:
    s_barrier
    ds_read_b32 v208, v15 offset:0
    ds_read_b32 v210, v15 offset:128
    ds_read_b32 v212, v15 offset:256
    ds_read_b32 v214, v15 offset:384
    ds_read_b128 v[144:147], v10 offset:0
    ds_read_b128 v[148:151], v10 offset:64
    ds_read_b128 v[152:155], v10 offset:128
    ds_read_b128 v[156:159], v10 offset:192
    ds_read_b128 v[160:163], v10 offset:256
    ds_read_b128 v[164:167], v10 offset:320
    ds_read_b128 v[168:171], v10 offset:384
    ds_read_b128 v[172:175], v10 offset:448
    s_waitcnt lgkmcnt(0)
    v_pk_fma_f32 v[16:17], v[208:209], v[144:145], v[16:17] op_sel_hi:[0,1,1] neg_lo:[1,0,0] neg_hi:[1,0,0]
    v_pk_fma_f32 v[18:19], v[208:209], v[146:147], v[18:19] op_sel_hi:[0,1,1] neg_lo:[1,0,0] neg_hi:[1,0,0]
    v_pk_fma_f32 v[32:33], v[208:209], v[148:149], v[32:33] op_sel_hi:[0,1,1] neg_lo:[1,0,0] neg_hi:[1,0,0]
    v_pk_fma_f32 v[34:35], v[208:209], v[150:151], v[34:35] op_sel_hi:[0,1,1] neg_lo:[1,0,0] neg_hi:[1,0,0]
    v_pk_fma_f32 v[48:49], v[208:209], v[152:153], v[48:49] op_sel_hi:[0,1,1] neg_lo:[1,0,0] neg_hi:[1,0,0]
    v_pk_fma_f32 v[50:51], v[208:209], v[154:155], v[50:51] op_sel_hi:[0,1,1] neg_lo:[1,0,0] neg_hi:[1,0,0]
    v_pk_fma_f32 v[64:65], v[208:209], v[156:157], v[64:65] op_sel_hi:[0,1,1] neg_lo:[1,0,0] neg_hi:[1,0,0]
    v_pk_fma_f32 v[66:67], v[208:209], v[158:159], v[66:67] op_sel_hi:[0,1,1] neg_lo:[1,0,0] neg_hi:[1,0,0]
    v_pk_fma_f32 v[80:81], v[208:209], v[160:161], v[80:81] op_sel_hi:[0,1,1] neg_lo:[1,0,0] neg_hi:[1,0,0]
    v_pk_fma_f32 v[82:83], v[208:209], v[162:163], v[82:83] op_sel_hi:[0,1,1] neg_lo:[1,0,0] neg_hi:[1,0,0]
    v_pk_fma_f32 v[96:97], v[208:209], v[164:165], v[96:97] op_sel_hi:[0,1,1] neg_lo:[1,0,0] neg_hi:[1,0,0]
    v_pk_fma_f32 v[98:99], v[208:209], v[166:167], v[98:99] op_sel_hi:[0,1,1] neg_lo:[1,0,0] neg_hi:[1,0,0]
    v_pk_fma_f32 v[112:113], v[208:209], v[168:169], v[112:113] op_sel_hi:[0,1,1] neg_lo:[1,0,0] neg_hi:[1,0,0]
    v_pk_fma_f32 v[114:115], v[208:209], v[170:171], v[114:115] op_sel_hi:[0,1,1] neg_lo:[1,0,0] neg_hi:[1,0,0]
    v_pk_fma_f32 v[128:129], v[208:209], v[172:173], v[128:129] op_sel_hi:[0,1,1] neg_lo:[1,0,0] neg_hi:[1,0,0]
    v_pk_fma_f32 v[130:131], v[208:209], v[174:175], v[130:131] op_sel_hi:[0,1,1] neg_lo:[1,0,0] neg_hi:[1,0,0]
    v_max_f32 v16, 0, v16
    v_max_f32 v17, 0, v17
    v_max_f32 v18, 0, v18
    v_max_f32 v19, 0, v19
    v_max_f32 v32, 0, v32
    v_max_f32 v33, 0, v33
    v_max_f32 v34, 0, v34
    v_max_f32 v35, 0, v35
    v_max_f32 v48, 0, v48
    v_max_f32 v49, 0, v49
    v_max_f32 v50, 0, v50
    v_max_f32 v51, 0, v51
    v_max_f32 v64, 0, v64
    v_max_f32 v65, 0, v65
    v_max_f32 v66, 0, v66
    v_max_f32 v67, 0, v67
    v_pk_mul_f32 v[16:17], v[16:17], v[80:81]
    v_pk_mul_f32 v[18:19], v[18:19], v[82:83]
    v_pk_mul_f32 v[32:33], v[32:33], v[96:97]
    v_pk_mul_f32 v[34:35], v[34:35], v[98:99]
    v_pk_mul_f32 v[48:49], v[48:49], v[112:113]
    v_pk_mul_f32 v[50:51], v[50:51], v[114:115]
    v_pk_mul_f32 v[64:65], v[64:65], v[128:129]
    v_pk_mul_f32 v[66:67], v[66:67], v[130:131]
    v_cvt_pk_bf16_f32 v176, v16, v17
    v_cvt_pk_bf16_f32 v177, v18, v19
    v_cvt_pk_bf16_f32 v178, v32, v33
    v_cvt_pk_bf16_f32 v179, v34, v35
    v_cvt_pk_bf16_f32 v180, v48, v49
    v_cvt_pk_bf16_f32 v181, v50, v51
    v_cvt_pk_bf16_f32 v182, v64, v65
    v_cvt_pk_bf16_f32 v183, v66, v67
    s_nop 0
    v_permlane16_swap_b32 v176, v178
    v_permlane16_swap_b32 v177, v179
    v_permlane16_swap_b32 v180, v182
    v_permlane16_swap_b32 v181, v183
    buffer_store_dwordx4 v[176:179], v14, s[28:31], s57 offen sc1
    buffer_store_dwordx4 v[180:183], v14, s[28:31], s57 offen offset:1024 sc1
    s_add_u32 s57, s57, 55296
    v_pk_fma_f32 v[20:21], v[210:211], v[144:145], v[20:21] op_sel_hi:[0,1,1] neg_lo:[1,0,0] neg_hi:[1,0,0]
    v_pk_fma_f32 v[22:23], v[210:211], v[146:147], v[22:23] op_sel_hi:[0,1,1] neg_lo:[1,0,0] neg_hi:[1,0,0]
    v_pk_fma_f32 v[36:37], v[210:211], v[148:149], v[36:37] op_sel_hi:[0,1,1] neg_lo:[1,0,0] neg_hi:[1,0,0]
    v_pk_fma_f32 v[38:39], v[210:211], v[150:151], v[38:39] op_sel_hi:[0,1,1] neg_lo:[1,0,0] neg_hi:[1,0,0]
    v_pk_fma_f32 v[52:53], v[210:211], v[152:153], v[52:53] op_sel_hi:[0,1,1] neg_lo:[1,0,0] neg_hi:[1,0,0]
    v_pk_fma_f32 v[54:55], v[210:211], v[154:155], v[54:55] op_sel_hi:[0,1,1] neg_lo:[1,0,0] neg_hi:[1,0,0]
    v_pk_fma_f32 v[68:69], v[210:211], v[156:157], v[68:69] op_sel_hi:[0,1,1] neg_lo:[1,0,0] neg_hi:[1,0,0]
    v_pk_fma_f32 v[70:71], v[210:211], v[158:159], v[70:71] op_sel_hi:[0,1,1] neg_lo:[1,0,0] neg_hi:[1,0,0]
    v_pk_fma_f32 v[84:85], v[210:211], v[160:161], v[84:85] op_sel_hi:[0,1,1] neg_lo:[1,0,0] neg_hi:[1,0,0]
    v_pk_fma_f32 v[86:87], v[210:211], v[162:163], v[86:87] op_sel_hi:[0,1,1] neg_lo:[1,0,0] neg_hi:[1,0,0]
    v_pk_fma_f32 v[100:101], v[210:211], v[164:165], v[100:101] op_sel_hi:[0,1,1] neg_lo:[1,0,0] neg_hi:[1,0,0]
    v_pk_fma_f32 v[102:103], v[210:211], v[166:167], v[102:103] op_sel_hi:[0,1,1] neg_lo:[1,0,0] neg_hi:[1,0,0]
    v_pk_fma_f32 v[116:117], v[210:211], v[168:169], v[116:117] op_sel_hi:[0,1,1] neg_lo:[1,0,0] neg_hi:[1,0,0]
    v_pk_fma_f32 v[118:119], v[210:211], v[170:171], v[118:119] op_sel_hi:[0,1,1] neg_lo:[1,0,0] neg_hi:[1,0,0]
    v_pk_fma_f32 v[132:133], v[210:211], v[172:173], v[132:133] op_sel_hi:[0,1,1] neg_lo:[1,0,0] neg_hi:[1,0,0]
    v_pk_fma_f32 v[134:135], v[210:211], v[174:175], v[134:135] op_sel_hi:[0,1,1] neg_lo:[1,0,0] neg_hi:[1,0,0]
    v_max_f32 v20, 0, v20
    v_max_f32 v21, 0, v21
    v_max_f32 v22, 0, v22
    v_max_f32 v23, 0, v23
    v_max_f32 v36, 0, v36
    v_max_f32 v37, 0, v37
    v_max_f32 v38, 0, v38
    v_max_f32 v39, 0, v39
    v_max_f32 v52, 0, v52
    v_max_f32 v53, 0, v53
    v_max_f32 v54, 0, v54
    v_max_f32 v55, 0, v55
    v_max_f32 v68, 0, v68
    v_max_f32 v69, 0, v69
    v_max_f32 v70, 0, v70
    v_max_f32 v71, 0, v71
    v_pk_mul_f32 v[20:21], v[20:21], v[84:85]
    v_pk_mul_f32 v[22:23], v[22:23], v[86:87]
    v_pk_mul_f32 v[36:37], v[36:37], v[100:101]
    v_pk_mul_f32 v[38:39], v[38:39], v[102:103]
    v_pk_mul_f32 v[52:53], v[52:53], v[116:117]
    v_pk_mul_f32 v[54:55], v[54:55], v[118:119]
    v_pk_mul_f32 v[68:69], v[68:69], v[132:133]
    v_pk_mul_f32 v[70:71], v[70:71], v[134:135]
    v_cvt_pk_bf16_f32 v184, v20, v21
    v_cvt_pk_bf16_f32 v185, v22, v23
    v_cvt_pk_bf16_f32 v186, v36, v37
    v_cvt_pk_bf16_f32 v187, v38, v39
    v_cvt_pk_bf16_f32 v188, v52, v53
    v_cvt_pk_bf16_f32 v189, v54, v55
    v_cvt_pk_bf16_f32 v190, v68, v69
    v_cvt_pk_bf16_f32 v191, v70, v71
    s_nop 0
    v_permlane16_swap_b32 v184, v186
    v_permlane16_swap_b32 v185, v187
    v_permlane16_swap_b32 v188, v190
    v_permlane16_swap_b32 v189, v191
    buffer_store_dwordx4 v[184:187], v14, s[28:31], s57 offen sc1
    buffer_store_dwordx4 v[188:191], v14, s[28:31], s57 offen offset:1024 sc1
    s_add_u32 s57, s57, 55296
    v_pk_fma_f32 v[24:25], v[212:213], v[144:145], v[24:25] op_sel_hi:[0,1,1] neg_lo:[1,0,0] neg_hi:[1,0,0]
    v_pk_fma_f32 v[26:27], v[212:213], v[146:147], v[26:27] op_sel_hi:[0,1,1] neg_lo:[1,0,0] neg_hi:[1,0,0]
    v_pk_fma_f32 v[40:41], v[212:213], v[148:149], v[40:41] op_sel_hi:[0,1,1] neg_lo:[1,0,0] neg_hi:[1,0,0]
    v_pk_fma_f32 v[42:43], v[212:213], v[150:151], v[42:43] op_sel_hi:[0,1,1] neg_lo:[1,0,0] neg_hi:[1,0,0]
    v_pk_fma_f32 v[56:57], v[212:213], v[152:153], v[56:57] op_sel_hi:[0,1,1] neg_lo:[1,0,0] neg_hi:[1,0,0]
    v_pk_fma_f32 v[58:59], v[212:213], v[154:155], v[58:59] op_sel_hi:[0,1,1] neg_lo:[1,0,0] neg_hi:[1,0,0]
    v_pk_fma_f32 v[72:73], v[212:213], v[156:157], v[72:73] op_sel_hi:[0,1,1] neg_lo:[1,0,0] neg_hi:[1,0,0]
    v_pk_fma_f32 v[74:75], v[212:213], v[158:159], v[74:75] op_sel_hi:[0,1,1] neg_lo:[1,0,0] neg_hi:[1,0,0]
    v_pk_fma_f32 v[88:89], v[212:213], v[160:161], v[88:89] op_sel_hi:[0,1,1] neg_lo:[1,0,0] neg_hi:[1,0,0]
    v_pk_fma_f32 v[90:91], v[212:213], v[162:163], v[90:91] op_sel_hi:[0,1,1] neg_lo:[1,0,0] neg_hi:[1,0,0]
    v_pk_fma_f32 v[104:105], v[212:213], v[164:165], v[104:105] op_sel_hi:[0,1,1] neg_lo:[1,0,0] neg_hi:[1,0,0]
    v_pk_fma_f32 v[106:107], v[212:213], v[166:167], v[106:107] op_sel_hi:[0,1,1] neg_lo:[1,0,0] neg_hi:[1,0,0]
    v_pk_fma_f32 v[120:121], v[212:213], v[168:169], v[120:121] op_sel_hi:[0,1,1] neg_lo:[1,0,0] neg_hi:[1,0,0]
    v_pk_fma_f32 v[122:123], v[212:213], v[170:171], v[122:123] op_sel_hi:[0,1,1] neg_lo:[1,0,0] neg_hi:[1,0,0]
    v_pk_fma_f32 v[136:137], v[212:213], v[172:173], v[136:137] op_sel_hi:[0,1,1] neg_lo:[1,0,0] neg_hi:[1,0,0]
    v_pk_fma_f32 v[138:139], v[212:213], v[174:175], v[138:139] op_sel_hi:[0,1,1] neg_lo:[1,0,0] neg_hi:[1,0,0]
    v_max_f32 v24, 0, v24
    v_max_f32 v25, 0, v25
    v_max_f32 v26, 0, v26
    v_max_f32 v27, 0, v27
    v_max_f32 v40, 0, v40
    v_max_f32 v41, 0, v41
    v_max_f32 v42, 0, v42
    v_max_f32 v43, 0, v43
    v_max_f32 v56, 0, v56
    v_max_f32 v57, 0, v57
    v_max_f32 v58, 0, v58
    v_max_f32 v59, 0, v59
    v_max_f32 v72, 0, v72
    v_max_f32 v73, 0, v73
    v_max_f32 v74, 0, v74
    v_max_f32 v75, 0, v75
    v_pk_mul_f32 v[24:25], v[24:25], v[88:89]
    v_pk_mul_f32 v[26:27], v[26:27], v[90:91]
    v_pk_mul_f32 v[40:41], v[40:41], v[104:105]
    v_pk_mul_f32 v[42:43], v[42:43], v[106:107]
    v_pk_mul_f32 v[56:57], v[56:57], v[120:121]
    v_pk_mul_f32 v[58:59], v[58:59], v[122:123]
    v_pk_mul_f32 v[72:73], v[72:73], v[136:137]
    v_pk_mul_f32 v[74:75], v[74:75], v[138:139]
    v_cvt_pk_bf16_f32 v192, v24, v25
    v_cvt_pk_bf16_f32 v193, v26, v27
    v_cvt_pk_bf16_f32 v194, v40, v41
    v_cvt_pk_bf16_f32 v195, v42, v43
    v_cvt_pk_bf16_f32 v196, v56, v57
    v_cvt_pk_bf16_f32 v197, v58, v59
    v_cvt_pk_bf16_f32 v198, v72, v73
    v_cvt_pk_bf16_f32 v199, v74, v75
    s_nop 0
    v_permlane16_swap_b32 v192, v194
    v_permlane16_swap_b32 v193, v195
    v_permlane16_swap_b32 v196, v198
    v_permlane16_swap_b32 v197, v199
    buffer_store_dwordx4 v[192:195], v14, s[28:31], s57 offen sc1
    buffer_store_dwordx4 v[196:199], v14, s[28:31], s57 offen offset:1024 sc1
    s_add_u32 s57, s57, 55296
    v_pk_fma_f32 v[28:29], v[214:215], v[144:145], v[28:29] op_sel_hi:[0,1,1] neg_lo:[1,0,0] neg_hi:[1,0,0]
    v_pk_fma_f32 v[30:31], v[214:215], v[146:147], v[30:31] op_sel_hi:[0,1,1] neg_lo:[1,0,0] neg_hi:[1,0,0]
    v_pk_fma_f32 v[44:45], v[214:215], v[148:149], v[44:45] op_sel_hi:[0,1,1] neg_lo:[1,0,0] neg_hi:[1,0,0]
    v_pk_fma_f32 v[46:47], v[214:215], v[150:151], v[46:47] op_sel_hi:[0,1,1] neg_lo:[1,0,0] neg_hi:[1,0,0]
    v_pk_fma_f32 v[60:61], v[214:215], v[152:153], v[60:61] op_sel_hi:[0,1,1] neg_lo:[1,0,0] neg_hi:[1,0,0]
    v_pk_fma_f32 v[62:63], v[214:215], v[154:155], v[62:63] op_sel_hi:[0,1,1] neg_lo:[1,0,0] neg_hi:[1,0,0]
    v_pk_fma_f32 v[76:77], v[214:215], v[156:157], v[76:77] op_sel_hi:[0,1,1] neg_lo:[1,0,0] neg_hi:[1,0,0]
    v_pk_fma_f32 v[78:79], v[214:215], v[158:159], v[78:79] op_sel_hi:[0,1,1] neg_lo:[1,0,0] neg_hi:[1,0,0]
    v_pk_fma_f32 v[92:93], v[214:215], v[160:161], v[92:93] op_sel_hi:[0,1,1] neg_lo:[1,0,0] neg_hi:[1,0,0]
    v_pk_fma_f32 v[94:95], v[214:215], v[162:163], v[94:95] op_sel_hi:[0,1,1] neg_lo:[1,0,0] neg_hi:[1,0,0]
    v_pk_fma_f32 v[108:109], v[214:215], v[164:165], v[108:109] op_sel_hi:[0,1,1] neg_lo:[1,0,0] neg_hi:[1,0,0]
    v_pk_fma_f32 v[110:111], v[214:215], v[166:167], v[110:111] op_sel_hi:[0,1,1] neg_lo:[1,0,0] neg_hi:[1,0,0]
    v_pk_fma_f32 v[124:125], v[214:215], v[168:169], v[124:125] op_sel_hi:[0,1,1] neg_lo:[1,0,0] neg_hi:[1,0,0]
    v_pk_fma_f32 v[126:127], v[214:215], v[170:171], v[126:127] op_sel_hi:[0,1,1] neg_lo:[1,0,0] neg_hi:[1,0,0]
    v_pk_fma_f32 v[140:141], v[214:215], v[172:173], v[140:141] op_sel_hi:[0,1,1] neg_lo:[1,0,0] neg_hi:[1,0,0]
    v_pk_fma_f32 v[142:143], v[214:215], v[174:175], v[142:143] op_sel_hi:[0,1,1] neg_lo:[1,0,0] neg_hi:[1,0,0]
    v_max_f32 v28, 0, v28
    v_max_f32 v29, 0, v29
    v_max_f32 v30, 0, v30
    v_max_f32 v31, 0, v31
    v_max_f32 v44, 0, v44
    v_max_f32 v45, 0, v45
    v_max_f32 v46, 0, v46
    v_max_f32 v47, 0, v47
    v_max_f32 v60, 0, v60
    v_max_f32 v61, 0, v61
    v_max_f32 v62, 0, v62
    v_max_f32 v63, 0, v63
    v_max_f32 v76, 0, v76
    v_max_f32 v77, 0, v77
    v_max_f32 v78, 0, v78
    v_max_f32 v79, 0, v79
    v_pk_mul_f32 v[28:29], v[28:29], v[92:93]
    v_pk_mul_f32 v[30:31], v[30:31], v[94:95]
    v_pk_mul_f32 v[44:45], v[44:45], v[108:109]
    v_pk_mul_f32 v[46:47], v[46:47], v[110:111]
    v_pk_mul_f32 v[60:61], v[60:61], v[124:125]
    v_pk_mul_f32 v[62:63], v[62:63], v[126:127]
    v_pk_mul_f32 v[76:77], v[76:77], v[140:141]
    v_pk_mul_f32 v[78:79], v[78:79], v[142:143]
    v_cvt_pk_bf16_f32 v200, v28, v29
    v_cvt_pk_bf16_f32 v201, v30, v31
    v_cvt_pk_bf16_f32 v202, v44, v45
    v_cvt_pk_bf16_f32 v203, v46, v47
    v_cvt_pk_bf16_f32 v204, v60, v61
    v_cvt_pk_bf16_f32 v205, v62, v63
    v_cvt_pk_bf16_f32 v206, v76, v77
    v_cvt_pk_bf16_f32 v207, v78, v79
    s_nop 0
    v_permlane16_swap_b32 v200, v202
    v_permlane16_swap_b32 v201, v203
    v_permlane16_swap_b32 v204, v206
    v_permlane16_swap_b32 v205, v207
    buffer_store_dwordx4 v[200:203], v14, s[28:31], s57 offen sc1
    buffer_store_dwordx4 v[204:207], v14, s[28:31], s57 offen offset:1024 sc1
L_m_post:
    v_and_b32 v10, 15, v0
    v_lshrrev_b32 v11, 4, v0
    v_and_b32 v1, 3, v10
    v_sub_u32 v1, 3, v1
    v_mul_u32_u24 v1, 4160, v1
    v_lshl_add_u32 v1, v11, 4, v1
    v_lshrrev_b32 v12, 2, v10
    v_lshlrev_b32 v12, 3, v12
    v_sub_u32 v1, v1, v12
    v_add_u32 v6, 24, v1
    v_lshl_add_u32 v1, v10, 1, v11
    v_mul_u32_u24 v1, 48, v1
    v_add_u32 v7, 49920, v1
    v_lshlrev_b32 v8, 5, v10
    v_lshrrev_b32 v1, 1, v11
    v_lshl_add_u32 v8, v1, 4, v8
    v_and_b32 v1, 1, v11
    v_lshl_add_u32 v8, v1, 9, v8
    s_add_u32 s44, s9, 0
    s_and_b32 s45, s44, 63
    s_lshl_b32 s45, s45, 1
    s_bfe_u32 s46, s44, 0x10006
    s_add_u32 s45, s45, s46
    s_and_b32 s44, s44, 0x380
    s_add_u32 s44, s44, s45
    s_lshl_b32 s44, s44, 12
    s_add_u32 s49, s44, 0x400000
    s_add_u32 s44, s9, 1
    s_and_b32 s45, s44, 63
    s_lshl_b32 s45, s45, 1
    s_bfe_u32 s46, s44, 0x10006
    s_add_u32 s45, s45, s46
    s_and_b32 s44, s44, 0x380
    s_add_u32 s44, s44, s45
    s_lshl_b32 s44, s44, 12
    s_add_u32 s50, s44, 0x400000
    s_add_u32 s44, s9, 2
    s_and_b32 s45, s44, 63
    s_lshl_b32 s45, s45, 1
    s_bfe_u32 s46, s44, 0x10006
    s_add_u32 s45, s45, s46
    s_and_b32 s44, s44, 0x380
    s_add_u32 s44, s44, s45
    s_lshl_b32 s44, s44, 12
    s_add_u32 s51, s44, 0x400000
    s_barrier
    v_mov_b32 v2, v6
    v_mov_b32 v3, v7
    v_mov_b32 v4, v8
    s_mov_b32 s48, s49
    s_mov_b32 s49, s50
    s_mov_b32 s50, s51
    s_cmp_eq_u32 s3, 3
    s_cbranch_scc1 L_conv_b
    s_cmp_ge_u32 s3, s10
    s_cbranch_scc1 L_conv_idle
    s_mul_i32 s44, s3, 16640
    v_add_u32 v2, s44, v2
    s_lshl_b32 s44, s3, 4
    v_add_u32 v3, s44, v3
    s_cmp_eq_u32 s3, 1
    s_cselect_b32 s48, s49, s48
    s_cmp_eq_u32 s3, 2
    s_cselect_b32 s48, s50, s48
    ds_read_b64 v[40:41], v2 offset:4032
    ds_read_b64 v[42:43], v2 offset:4040
    ds_read_b128 v[72:75], v3 offset:1344
    ds_read_b64 v[44:45], v2 offset:3520
    ds_read_b64 v[46:47], v2 offset:3528
    ds_read_b128 v[76:79], v3 offset:2880
    ds_read_b64 v[48:49], v2 offset:3008
    ds_read_b64 v[50:51], v2 offset:3016
    ds_read_b128 v[80:83], v3 offset:4416
    ds_read_b64 v[52:53], v2 offset:2496
    ds_read_b64 v[54:55], v2 offset:2504
    ds_read_b128 v[84:87], v3 offset:5952
    ds_read_b64 v[56:57], v2 offset:1984
    ds_read_b64 v[58:59], v2 offset:1992
    ds_read_b128 v[88:91], v3 offset:7488
    ds_read_b64 v[60:61], v2 offset:1472
    ds_read_b64 v[62:63], v2 offset:1480
    ds_read_b128 v[92:95], v3 offset:9024
    ds_read_b64 v[64:65], v2 offset:960
    ds_read_b64 v[66:67], v2 offset:968
    ds_read_b128 v[96:99], v3 offset:10560
    ds_read_b64 v[68:69], v2 offset:448
    ds_read_b64 v[70:71], v2 offset:456
    ds_read_b128 v[100:103], v3 offset:12096
    s_waitcnt lgkmcnt(0)
    v_mfma_f32_16x16x32_bf16 v[20:23], v[52:55], v[84:87], 0
    ds_read_b64 v[104:105], v2 offset:3968
    v_mfma_f32_16x16x32_bf16 v[16:19], v[52:55], v[88:91], 0
    ds_read_b64 v[106:107], v2 offset:3976
    v_mfma_f32_16x16x32_bf16 v[24:27], v[52:55], v[80:83], 0
    ds_read_b128 v[136:139], v3 offset:1152
    v_mfma_f32_16x16x32_bf16 v[20:23], v[56:59], v[80:83], v[20:23]
    ds_read_b64 v[108:109], v2 offset:3456
    v_mfma_f32_16x16x32_bf16 v[16:19], v[56:59], v[84:87], v[16:19]
    ds_read_b64 v[110:111], v2 offset:3464
    v_mfma_f32_16x16x32_bf16 v[24:27], v[48:51], v[84:87], v[24:27]
    ds_read_b128 v[140:143], v3 offset:2688
    v_mfma_f32_16x16x32_bf16 v[28:31], v[48:51], v[80:83], 0
    ds_read_b64 v[112:113], v2 offset:2944
    v_mfma_f32_16x16x32_bf16 v[16:19], v[48:51], v[92:95], v[16:19]
    ds_read_b64 v[114:115], v2 offset:2952
    v_mfma_f32_16x16x32_bf16 v[20:23], v[48:51], v[88:91], v[20:23]
    ds_read_b128 v[144:147], v3 offset:4224
    v_mfma_f32_16x16x32_bf16 v[24:27], v[44:47], v[88:91], v[24:27]
    ds_read_b64 v[116:117], v2 offset:2432
    v_mfma_f32_16x16x32_bf16 v[16:19], v[44:47], v[96:99], v[16:19]
    ds_read_b64 v[118:119], v2 offset:2440
    v_mfma_f32_16x16x32_bf16 v[28:31], v[44:47], v[84:87], v[28:31]
    ds_read_b128 v[148:151], v3 offset:5760
    v_mfma_f32_16x16x32_bf16 v[20:23], v[44:47], v[92:95], v[20:23]
    ds_read_b64 v[120:121], v2 offset:1920
    v_mfma_f32_16x16x32_bf16 v[24:27], v[40:43], v[92:95], v[24:27]
    ds_read_b64 v[122:123], v2 offset:1928
    v_mfma_f32_16x16x32_bf16 v[16:19], v[40:43], v[100:103], v[16:19]
    ds_read_b128 v[152:155], v3 offset:7296
    v_mfma_f32_16x16x32_bf16 v[28:31], v[40:43], v[88:91], v[28:31]
    ds_read_b64 v[124:125], v2 offset:1408
    v_mfma_f32_16x16x32_bf16 v[20:23], v[40:43], v[96:99], v[20:23]
    ds_read_b64 v[126:127], v2 offset:1416
    v_mfma_f32_16x16x32_bf16 v[32:35], v[40:43], v[76:79], 0
    ds_read_b128 v[156:159], v3 offset:8832
    v_mfma_f32_16x16x32_bf16 v[16:19], v[64:67], v[76:79], v[16:19]
    ds_read_b64 v[128:129], v2 offset:896
    v_mfma_f32_16x16x32_bf16 v[28:31], v[52:55], v[76:79], v[28:31]
    ds_read_b64 v[130:131], v2 offset:904
    v_mfma_f32_16x16x32_bf16 v[24:27], v[56:59], v[76:79], v[24:27]
    ds_read_b128 v[160:163], v3 offset:10368
    v_mfma_f32_16x16x32_bf16 v[20:23], v[60:63], v[76:79], v[20:23]
    ds_read_b64 v[132:133], v2 offset:384
    v_mfma_f32_16x16x32_bf16 v[16:19], v[60:63], v[80:83], v[16:19]
    ds_read_b64 v[134:135], v2 offset:392
    v_mfma_f32_16x16x32_bf16 v[24:27], v[60:63], v[72:75], v[24:27]
    ds_read_b128 v[164:167], v3 offset:11904
    v_mfma_f32_16x16x32_bf16 v[36:39], v[40:43], v[72:75], 0
    v_mfma_f32_16x16x32_bf16 v[32:35], v[44:47], v[72:75], v[32:35]
    v_mfma_f32_16x16x32_bf16 v[28:31], v[56:59], v[72:75], v[28:31]
    v_mfma_f32_16x16x32_bf16 v[20:23], v[64:67], v[72:75], v[20:23]
    v_mfma_f32_16x16x32_bf16 v[16:19], v[68:71], v[72:75], v[16:19]
    s_waitcnt lgkmcnt(0)
    s_cmp_ge_u32 s8, 27
    s_cbranch_scc1 L_no_s2_a
    s_waitcnt vmcnt(0)
    s_lshl_b32 s44, s4, 5
    s_add_u32 s44, s44, s5
    s_lshl_b32 s44, s44, 2
    s_add_u32 s44, s44, 0x1000
    s_mov_b64 exec, 1
    v_mov_b32 v252, 162308
    v_mov_b32 v253, 1
    ds_add_rtn_u32 v253, v252, v253
    s_mov_b64 exec, 0x3ff
    v_mov_b32 v252, s11
    v_mul_u32_u24 v254, 1024, v0
    s_waitcnt lgkmcnt(0)
    v_readfirstlane_b32 s45, v253
    s_cmp_lg_u32 s45, 3
    s_cbranch_scc1 L_noflag_s2a
    buffer_store_dword v252, v254, s[28:31], s44 offen sc1
L_noflag_s2a:
    s_mov_b64 exec, -1
L_no_s2_a:
    v_mfma_f32_16x16x32_bf16 v[20:23], v[116:119], v[148:151], v[20:23]
    ds_read_b64 v[40:41], v2 offset:3904
    v_mfma_f32_16x16x32_bf16 v[16:19], v[116:119], v[152:155], v[16:19]
    ds_read_b64 v[42:43], v2 offset:3912
    v_mfma_f32_16x16x32_bf16 v[24:27], v[116:119], v[144:147], v[24:27]
    ds_read_b128 v[72:75], v3 offset:960
    v_mfma_f32_16x16x32_bf16 v[20:23], v[120:123], v[144:147], v[20:23]
    ds_read_b64 v[44:45], v2 offset:3392
    v_mfma_f32_16x16x32_bf16 v[16:19], v[120:123], v[148:151], v[16:19]
    ds_read_b64 v[46:47], v2 offset:3400
    v_mfma_f32_16x16x32_bf16 v[24:27], v[112:115], v[148:151], v[24:27]
    ds_read_b128 v[76:79], v3 offset:2496
    v_mfma_f32_16x16x32_bf16 v[28:31], v[112:115], v[144:147], v[28:31]
    ds_read_b64 v[48:49], v2 offset:2880
    v_mfma_f32_16x16x32_bf16 v[16:19], v[112:115], v[156:159], v[16:19]
    ds_read_b64 v[50:51], v2 offset:2888
    v_mfma_f32_16x16x32_bf16 v[20:23], v[112:115], v[152:155], v[20:23]
    ds_read_b128 v[80:83], v3 offset:4032
    v_mfma_f32_16x16x32_bf16 v[24:27], v[108:111], v[152:155], v[24:27]
    ds_read_b64 v[52:53], v2 offset:2368
    v_mfma_f32_16x16x32_bf16 v[16:19], v[108:111], v[160:163], v[16:19]
    ds_read_b64 v[54:55], v2 offset:2376
    v_mfma_f32_16x16x32_bf16 v[28:31], v[108:111], v[148:151], v[28:31]
    ds_read_b128 v[84:87], v3 offset:5568
    v_mfma_f32_16x16x32_bf16 v[20:23], v[108:111], v[156:159], v[20:23]
    ds_read_b64 v[56:57], v2 offset:1856
    v_mfma_f32_16x16x32_bf16 v[24:27], v[104:107], v[156:159], v[24:27]
    ds_read_b64 v[58:59], v2 offset:1864
    v_mfma_f32_16x16x32_bf16 v[16:19], v[104:107], v[164:167], v[16:19]
    ds_read_b128 v[88:91], v3 offset:7104
    v_mfma_f32_16x16x32_bf16 v[28:31], v[104:107], v[152:155], v[28:31]
    ds_read_b64 v[60:61], v2 offset:1344
    v_mfma_f32_16x16x32_bf16 v[20:23], v[104:107], v[160:163], v[20:23]
    ds_read_b64 v[62:63], v2 offset:1352
    v_mfma_f32_16x16x32_bf16 v[32:35], v[104:107], v[140:143], v[32:35]
    ds_read_b128 v[92:95], v3 offset:8640
    v_mfma_f32_16x16x32_bf16 v[16:19], v[128:131], v[140:143], v[16:19]
    ds_read_b64 v[64:65], v2 offset:832
    v_mfma_f32_16x16x32_bf16 v[28:31], v[116:119], v[140:143], v[28:31]
    ds_read_b64 v[66:67], v2 offset:840
    v_mfma_f32_16x16x32_bf16 v[24:27], v[120:123], v[140:143], v[24:27]
    ds_read_b128 v[96:99], v3 offset:10176
    v_mfma_f32_16x16x32_bf16 v[20:23], v[124:127], v[140:143], v[20:23]
    ds_read_b64 v[68:69], v2 offset:320
    v_mfma_f32_16x16x32_bf16 v[16:19], v[124:127], v[144:147], v[16:19]
    ds_read_b64 v[70:71], v2 offset:328
    v_mfma_f32_16x16x32_bf16 v[24:27], v[124:127], v[136:139], v[24:27]
    ds_read_b128 v[100:103], v3 offset:11712
    v_mfma_f32_16x16x32_bf16 v[36:39], v[104:107], v[136:139], v[36:39]
    v_mfma_f32_16x16x32_bf16 v[32:35], v[108:111], v[136:139], v[32:35]
    v_mfma_f32_16x16x32_bf16 v[28:31], v[120:123], v[136:139], v[28:31]
    v_mfma_f32_16x16x32_bf16 v[20:23], v[128:131], v[136:139], v[20:23]
    v_mfma_f32_16x16x32_bf16 v[16:19], v[132:135], v[136:139], v[16:19]
    s_waitcnt lgkmcnt(0)
    v_mfma_f32_16x16x32_bf16 v[20:23], v[52:55], v[84:87], v[20:23]
    ds_read_b64 v[104:105], v2 offset:3840
    v_mfma_f32_16x16x32_bf16 v[16:19], v[52:55], v[88:91], v[16:19]
    ds_read_b64 v[106:107], v2 offset:3848
    v_mfma_f32_16x16x32_bf16 v[24:27], v[52:55], v[80:83], v[24:27]
    ds_read_b128 v[136:139], v3 offset:768
    v_mfma_f32_16x16x32_bf16 v[20:23], v[56:59], v[80:83], v[20:23]
    ds_read_b64 v[108:109], v2 offset:3328
    v_mfma_f32_16x16x32_bf16 v[16:19], v[56:59], v[84:87], v[16:19]
    ds_read_b64 v[110:111], v2 offset:3336
    v_mfma_f32_16x16x32_bf16 v[24:27], v[48:51], v[84:87], v[24:27]
    ds_read_b128 v[140:143], v3 offset:2304
    v_mfma_f32_16x16x32_bf16 v[28:31], v[48:51], v[80:83], v[28:31]
    ds_read_b64 v[112:113], v2 offset:2816
    v_mfma_f32_16x16x32_bf16 v[16:19], v[48:51], v[92:95], v[16:19]
    ds_read_b64 v[114:115], v2 offset:2824
    v_mfma_f32_16x16x32_bf16 v[20:23], v[48:51], v[88:91], v[20:23]
    ds_read_b128 v[144:147], v3 offset:3840
    v_mfma_f32_16x16x32_bf16 v[24:27], v[44:47], v[88:91], v[24:27]
    ds_read_b64 v[116:117], v2 offset:2304
    v_mfma_f32_16x16x32_bf16 v[16:19], v[44:47], v[96:99], v[16:19]
    ds_read_b64 v[118:119], v2 offset:2312
    v_mfma_f32_16x16x32_bf16 v[28:31], v[44:47], v[84:87], v[28:31]
    ds_read_b128 v[148:151], v3 offset:5376
    v_mfma_f32_16x16x32_bf16 v[20:23], v[44:47], v[92:95], v[20:23]
    ds_read_b64 v[120:121], v2 offset:1792
    v_mfma_f32_16x16x32_bf16 v[24:27], v[40:43], v[92:95], v[24:27]
    ds_read_b64 v[122:123], v2 offset:1800
    v_mfma_f32_16x16x32_bf16 v[16:19], v[40:43], v[100:103], v[16:19]
    ds_read_b128 v[152:155], v3 offset:6912
    v_mfma_f32_16x16x32_bf16 v[28:31], v[40:43], v[88:91], v[28:31]
    ds_read_b64 v[124:125], v2 offset:1280
    v_mfma_f32_16x16x32_bf16 v[20:23], v[40:43], v[96:99], v[20:23]
    ds_read_b64 v[126:127], v2 offset:1288
    v_mfma_f32_16x16x32_bf16 v[32:35], v[40:43], v[76:79], v[32:35]
    ds_read_b128 v[156:159], v3 offset:8448
    v_mfma_f32_16x16x32_bf16 v[16:19], v[64:67], v[76:79], v[16:19]
    ds_read_b64 v[128:129], v2 offset:768
    v_mfma_f32_16x16x32_bf16 v[28:31], v[52:55], v[76:79], v[28:31]
    ds_read_b64 v[130:131], v2 offset:776
    v_mfma_f32_16x16x32_bf16 v[24:27], v[56:59], v[76:79], v[24:27]
    ds_read_b128 v[160:163], v3 offset:9984
    v_mfma_f32_16x16x32_bf16 v[20:23], v[60:63], v[76:79], v[20:23]
    ds_read_b64 v[132:133], v2 offset:256
    v_mfma_f32_16x16x32_bf16 v[16:19], v[60:63], v[80:83], v[16:19]
    ds_read_b64 v[134:135], v2 offset:264
    v_mfma_f32_16x16x32_bf16 v[24:27], v[60:63], v[72:75], v[24:27]
    ds_read_b128 v[164:167], v3 offset:11520
    v_mfma_f32_16x16x32_bf16 v[36:39], v[40:43], v[72:75], v[36:39]
    v_mfma_f32_16x16x32_bf16 v[32:35], v[44:47], v[72:75], v[32:35]
    v_mfma_f32_16x16x32_bf16 v[28:31], v[56:59], v[72:75], v[28:31]
    v_mfma_f32_16x16x32_bf16 v[20:23], v[64:67], v[72:75], v[20:23]
    v_mfma_f32_16x16x32_bf16 v[16:19], v[68:71], v[72:75], v[16:19]
    s_waitcnt lgkmcnt(0)
    v_mfma_f32_16x16x32_bf16 v[20:23], v[116:119], v[148:151], v[20:23]
    ds_read_b64 v[40:41], v2 offset:3776
    v_mfma_f32_16x16x32_bf16 v[16:19], v[116:119], v[152:155], v[16:19]
    ds_read_b64 v[42:43], v2 offset:3784
    v_mfma_f32_16x16x32_bf16 v[24:27], v[116:119], v[144:147], v[24:27]
    ds_read_b128 v[72:75], v3 offset:576
    v_mfma_f32_16x16x32_bf16 v[20:23], v[120:123], v[144:147], v[20:23]
    ds_read_b64 v[44:45], v2 offset:3264
    v_mfma_f32_16x16x32_bf16 v[16:19], v[120:123], v[148:151], v[16:19]
    ds_read_b64 v[46:47], v2 offset:3272
    v_mfma_f32_16x16x32_bf16 v[24:27], v[112:115], v[148:151], v[24:27]
    ds_read_b128 v[76:79], v3 offset:2112
    v_mfma_f32_16x16x32_bf16 v[28:31], v[112:115], v[144:147], v[28:31]
    ds_read_b64 v[48:49], v2 offset:2752
    v_mfma_f32_16x16x32_bf16 v[16:19], v[112:115], v[156:159], v[16:19]
    ds_read_b64 v[50:51], v2 offset:2760
    v_mfma_f32_16x16x32_bf16 v[20:23], v[112:115], v[152:155], v[20:23]
    ds_read_b128 v[80:83], v3 offset:3648
    v_mfma_f32_16x16x32_bf16 v[24:27], v[108:111], v[152:155], v[24:27]
    ds_read_b64 v[52:53], v2 offset:2240
    v_mfma_f32_16x16x32_bf16 v[16:19], v[108:111], v[160:163], v[16:19]
    ds_read_b64 v[54:55], v2 offset:2248
    v_mfma_f32_16x16x32_bf16 v[28:31], v[108:111], v[148:151], v[28:31]
    ds_read_b128 v[84:87], v3 offset:5184
    v_mfma_f32_16x16x32_bf16 v[20:23], v[108:111], v[156:159], v[20:23]
    ds_read_b64 v[56:57], v2 offset:1728
    v_mfma_f32_16x16x32_bf16 v[24:27], v[104:107], v[156:159], v[24:27]
    ds_read_b64 v[58:59], v2 offset:1736
    v_mfma_f32_16x16x32_bf16 v[16:19], v[104:107], v[164:167], v[16:19]
    ds_read_b128 v[88:91], v3 offset:6720
    v_mfma_f32_16x16x32_bf16 v[28:31], v[104:107], v[152:155], v[28:31]
    ds_read_b64 v[60:61], v2 offset:1216
    v_mfma_f32_16x16x32_bf16 v[20:23], v[104:107], v[160:163], v[20:23]
    ds_read_b64 v[62:63], v2 offset:1224
    v_mfma_f32_16x16x32_bf16 v[32:35], v[104:107], v[140:143], v[32:35]
    ds_read_b128 v[92:95], v3 offset:8256
    v_mfma_f32_16x16x32_bf16 v[16:19], v[128:131], v[140:143], v[16:19]
    ds_read_b64 v[64:65], v2 offset:704
    v_mfma_f32_16x16x32_bf16 v[28:31], v[116:119], v[140:143], v[28:31]
    ds_read_b64 v[66:67], v2 offset:712
    v_mfma_f32_16x16x32_bf16 v[24:27], v[120:123], v[140:143], v[24:27]
    ds_read_b128 v[96:99], v3 offset:9792
    v_mfma_f32_16x16x32_bf16 v[20:23], v[124:127], v[140:143], v[20:23]
    ds_read_b64 v[68:69], v2 offset:192
    v_mfma_f32_16x16x32_bf16 v[16:19], v[124:127], v[144:147], v[16:19]
    ds_read_b64 v[70:71], v2 offset:200
    v_mfma_f32_16x16x32_bf16 v[24:27], v[124:127], v[136:139], v[24:27]
    ds_read_b128 v[100:103], v3 offset:11328
    v_mfma_f32_16x16x32_bf16 v[36:39], v[104:107], v[136:139], v[36:39]
    v_mfma_f32_16x16x32_bf16 v[32:35], v[108:111], v[136:139], v[32:35]
    v_mfma_f32_16x16x32_bf16 v[28:31], v[120:123], v[136:139], v[28:31]
    v_mfma_f32_16x16x32_bf16 v[20:23], v[128:131], v[136:139], v[20:23]
    v_mfma_f32_16x16x32_bf16 v[16:19], v[132:135], v[136:139], v[16:19]
    s_waitcnt lgkmcnt(0)
    v_mfma_f32_16x16x32_bf16 v[20:23], v[52:55], v[84:87], v[20:23]
    ds_read_b64 v[104:105], v2 offset:3712
    v_mfma_f32_16x16x32_bf16 v[16:19], v[52:55], v[88:91], v[16:19]
    ds_read_b64 v[106:107], v2 offset:3720
    v_mfma_f32_16x16x32_bf16 v[24:27], v[52:55], v[80:83], v[24:27]
    ds_read_b128 v[136:139], v3 offset:384
    v_mfma_f32_16x16x32_bf16 v[20:23], v[56:59], v[80:83], v[20:23]
    ds_read_b64 v[108:109], v2 offset:3200
    v_mfma_f32_16x16x32_bf16 v[16:19], v[56:59], v[84:87], v[16:19]
    ds_read_b64 v[110:111], v2 offset:3208
    v_mfma_f32_16x16x32_bf16 v[24:27], v[48:51], v[84:87], v[24:27]
    ds_read_b128 v[140:143], v3 offset:1920
    v_mfma_f32_16x16x32_bf16 v[28:31], v[48:51], v[80:83], v[28:31]
    ds_read_b64 v[112:113], v2 offset:2688
    v_mfma_f32_16x16x32_bf16 v[16:19], v[48:51], v[92:95], v[16:19]
    ds_read_b64 v[114:115], v2 offset:2696
    v_mfma_f32_16x16x32_bf16 v[20:23], v[48:51], v[88:91], v[20:23]
    ds_read_b128 v[144:147], v3 offset:3456
    v_mfma_f32_16x16x32_bf16 v[24:27], v[44:47], v[88:91], v[24:27]
    ds_read_b64 v[116:117], v2 offset:2176
    v_mfma_f32_16x16x32_bf16 v[16:19], v[44:47], v[96:99], v[16:19]
    ds_read_b64 v[118:119], v2 offset:2184
    v_mfma_f32_16x16x32_bf16 v[28:31], v[44:47], v[84:87], v[28:31]
    ds_read_b128 v[148:151], v3 offset:4992
    v_mfma_f32_16x16x32_bf16 v[20:23], v[44:47], v[92:95], v[20:23]
    ds_read_b64 v[120:121], v2 offset:1664
    v_mfma_f32_16x16x32_bf16 v[24:27], v[40:43], v[92:95], v[24:27]
    ds_read_b64 v[122:123], v2 offset:1672
    v_mfma_f32_16x16x32_bf16 v[16:19], v[40:43], v[100:103], v[16:19]
    ds_read_b128 v[152:155], v3 offset:6528
    v_mfma_f32_16x16x32_bf16 v[28:31], v[40:43], v[88:91], v[28:31]
    ds_read_b64 v[124:125], v2 offset:1152
    v_mfma_f32_16x16x32_bf16 v[20:23], v[40:43], v[96:99], v[20:23]
    ds_read_b64 v[126:127], v2 offset:1160
    v_mfma_f32_16x16x32_bf16 v[32:35], v[40:43], v[76:79], v[32:35]
    ds_read_b128 v[156:159], v3 offset:8064
    v_mfma_f32_16x16x32_bf16 v[16:19], v[64:67], v[76:79], v[16:19]
    ds_read_b64 v[128:129], v2 offset:640
    v_mfma_f32_16x16x32_bf16 v[28:31], v[52:55], v[76:79], v[28:31]
    ds_read_b64 v[130:131], v2 offset:648
    v_mfma_f32_16x16x32_bf16 v[24:27], v[56:59], v[76:79], v[24:27]
    ds_read_b128 v[160:163], v3 offset:9600
    v_mfma_f32_16x16x32_bf16 v[20:23], v[60:63], v[76:79], v[20:23]
    ds_read_b64 v[132:133], v2 offset:128
    v_mfma_f32_16x16x32_bf16 v[16:19], v[60:63], v[80:83], v[16:19]
    ds_read_b64 v[134:135], v2 offset:136
    v_mfma_f32_16x16x32_bf16 v[24:27], v[60:63], v[72:75], v[24:27]
    ds_read_b128 v[164:167], v3 offset:11136
    v_mfma_f32_16x16x32_bf16 v[36:39], v[40:43], v[72:75], v[36:39]
    v_mfma_f32_16x16x32_bf16 v[32:35], v[44:47], v[72:75], v[32:35]
    v_mfma_f32_16x16x32_bf16 v[28:31], v[56:59], v[72:75], v[28:31]
    v_mfma_f32_16x16x32_bf16 v[20:23], v[64:67], v[72:75], v[20:23]
    v_mfma_f32_16x16x32_bf16 v[16:19], v[68:71], v[72:75], v[16:19]
    s_waitcnt lgkmcnt(0)
    v_mfma_f32_16x16x32_bf16 v[20:23], v[116:119], v[148:151], v[20:23]
    ds_read_b64 v[40:41], v2 offset:3648
    v_mfma_f32_16x16x32_bf16 v[16:19], v[116:119], v[152:155], v[16:19]
    ds_read_b64 v[42:43], v2 offset:3656
    v_mfma_f32_16x16x32_bf16 v[24:27], v[116:119], v[144:147], v[24:27]
    ds_read_b128 v[72:75], v3 offset:192
    v_mfma_f32_16x16x32_bf16 v[20:23], v[120:123], v[144:147], v[20:23]
    ds_read_b64 v[44:45], v2 offset:3136
    v_mfma_f32_16x16x32_bf16 v[16:19], v[120:123], v[148:151], v[16:19]
    ds_read_b64 v[46:47], v2 offset:3144
    v_mfma_f32_16x16x32_bf16 v[24:27], v[112:115], v[148:151], v[24:27]
    ds_read_b128 v[76:79], v3 offset:1728
    v_mfma_f32_16x16x32_bf16 v[28:31], v[112:115], v[144:147], v[28:31]
    ds_read_b64 v[48:49], v2 offset:2624
    v_mfma_f32_16x16x32_bf16 v[16:19], v[112:115], v[156:159], v[16:19]
    ds_read_b64 v[50:51], v2 offset:2632
    v_mfma_f32_16x16x32_bf16 v[20:23], v[112:115], v[152:155], v[20:23]
    ds_read_b128 v[80:83], v3 offset:3264
    v_mfma_f32_16x16x32_bf16 v[24:27], v[108:111], v[152:155], v[24:27]
    ds_read_b64 v[52:53], v2 offset:2112
    v_mfma_f32_16x16x32_bf16 v[16:19], v[108:111], v[160:163], v[16:19]
    ds_read_b64 v[54:55], v2 offset:2120
    v_mfma_f32_16x16x32_bf16 v[28:31], v[108:111], v[148:151], v[28:31]
    ds_read_b128 v[84:87], v3 offset:4800
    v_mfma_f32_16x16x32_bf16 v[20:23], v[108:111], v[156:159], v[20:23]
    ds_read_b64 v[56:57], v2 offset:1600
    v_mfma_f32_16x16x32_bf16 v[24:27], v[104:107], v[156:159], v[24:27]
    ds_read_b64 v[58:59], v2 offset:1608
    v_mfma_f32_16x16x32_bf16 v[16:19], v[104:107], v[164:167], v[16:19]
    ds_read_b128 v[88:91], v3 offset:6336
    v_mfma_f32_16x16x32_bf16 v[28:31], v[104:107], v[152:155], v[28:31]
    ds_read_b64 v[60:61], v2 offset:1088
    v_mfma_f32_16x16x32_bf16 v[20:23], v[104:107], v[160:163], v[20:23]
    ds_read_b64 v[62:63], v2 offset:1096
    v_mfma_f32_16x16x32_bf16 v[32:35], v[104:107], v[140:143], v[32:35]
    ds_read_b128 v[92:95], v3 offset:7872
    v_mfma_f32_16x16x32_bf16 v[16:19], v[128:131], v[140:143], v[16:19]
    ds_read_b64 v[64:65], v2 offset:576
    v_mfma_f32_16x16x32_bf16 v[28:31], v[116:119], v[140:143], v[28:31]
    ds_read_b64 v[66:67], v2 offset:584
    v_mfma_f32_16x16x32_bf16 v[24:27], v[120:123], v[140:143], v[24:27]
    ds_read_b128 v[96:99], v3 offset:9408
    v_mfma_f32_16x16x32_bf16 v[20:23], v[124:127], v[140:143], v[20:23]
    ds_read_b64 v[68:69], v2 offset:64
    v_mfma_f32_16x16x32_bf16 v[16:19], v[124:127], v[144:147], v[16:19]
    ds_read_b64 v[70:71], v2 offset:72
    v_mfma_f32_16x16x32_bf16 v[24:27], v[124:127], v[136:139], v[24:27]
    ds_read_b128 v[100:103], v3 offset:10944
    v_mfma_f32_16x16x32_bf16 v[36:39], v[104:107], v[136:139], v[36:39]
    v_mfma_f32_16x16x32_bf16 v[32:35], v[108:111], v[136:139], v[32:35]
    v_mfma_f32_16x16x32_bf16 v[28:31], v[120:123], v[136:139], v[28:31]
    v_mfma_f32_16x16x32_bf16 v[20:23], v[128:131], v[136:139], v[20:23]
    v_mfma_f32_16x16x32_bf16 v[16:19], v[132:135], v[136:139], v[16:19]
    s_waitcnt lgkmcnt(0)
    v_mfma_f32_16x16x32_bf16 v[20:23], v[52:55], v[84:87], v[20:23]
    ds_read_b64 v[104:105], v2 offset:3584
    v_mfma_f32_16x16x32_bf16 v[16:19], v[52:55], v[88:91], v[16:19]
    ds_read_b64 v[106:107], v2 offset:3592
    v_mfma_f32_16x16x32_bf16 v[24:27], v[52:55], v[80:83], v[24:27]
    ds_read_b128 v[136:139], v3 offset:0
    v_mfma_f32_16x16x32_bf16 v[20:23], v[56:59], v[80:83], v[20:23]
    ds_read_b64 v[108:109], v2 offset:3072
    v_mfma_f32_16x16x32_bf16 v[16:19], v[56:59], v[84:87], v[16:19]
    ds_read_b64 v[110:111], v2 offset:3080
    v_mfma_f32_16x16x32_bf16 v[24:27], v[48:51], v[84:87], v[24:27]
    ds_read_b128 v[140:143], v3 offset:1536
    v_mfma_f32_16x16x32_bf16 v[28:31], v[48:51], v[80:83], v[28:31]
    ds_read_b64 v[112:113], v2 offset:2560
    v_mfma_f32_16x16x32_bf16 v[16:19], v[48:51], v[92:95], v[16:19]
    ds_read_b64 v[114:115], v2 offset:2568
    v_mfma_f32_16x16x32_bf16 v[20:23], v[48:51], v[88:91], v[20:23]
    ds_read_b128 v[144:147], v3 offset:3072
    v_mfma_f32_16x16x32_bf16 v[24:27], v[44:47], v[88:91], v[24:27]
    ds_read_b64 v[116:117], v2 offset:2048
    v_mfma_f32_16x16x32_bf16 v[16:19], v[44:47], v[96:99], v[16:19]
    ds_read_b64 v[118:119], v2 offset:2056
    v_mfma_f32_16x16x32_bf16 v[28:31], v[44:47], v[84:87], v[28:31]
    ds_read_b128 v[148:151], v3 offset:4608
    v_mfma_f32_16x16x32_bf16 v[20:23], v[44:47], v[92:95], v[20:23]
    ds_read_b64 v[120:121], v2 offset:1536
    v_mfma_f32_16x16x32_bf16 v[24:27], v[40:43], v[92:95], v[24:27]
    ds_read_b64 v[122:123], v2 offset:1544
    v_mfma_f32_16x16x32_bf16 v[16:19], v[40:43], v[100:103], v[16:19]
    ds_read_b128 v[152:155], v3 offset:6144
    v_mfma_f32_16x16x32_bf16 v[28:31], v[40:43], v[88:91], v[28:31]
    ds_read_b64 v[124:125], v2 offset:1024
    v_mfma_f32_16x16x32_bf16 v[20:23], v[40:43], v[96:99], v[20:23]
    ds_read_b64 v[126:127], v2 offset:1032
    v_mfma_f32_16x16x32_bf16 v[32:35], v[40:43], v[76:79], v[32:35]
    ds_read_b128 v[156:159], v3 offset:7680
    v_mfma_f32_16x16x32_bf16 v[16:19], v[64:67], v[76:79], v[16:19]
    ds_read_b64 v[128:129], v2 offset:512
    v_mfma_f32_16x16x32_bf16 v[28:31], v[52:55], v[76:79], v[28:31]
    ds_read_b64 v[130:131], v2 offset:520
    v_mfma_f32_16x16x32_bf16 v[24:27], v[56:59], v[76:79], v[24:27]
    ds_read_b128 v[160:163], v3 offset:9216
    v_mfma_f32_16x16x32_bf16 v[20:23], v[60:63], v[76:79], v[20:23]
    ds_read_b64 v[132:133], v2 offset:0
    v_mfma_f32_16x16x32_bf16 v[16:19], v[60:63], v[80:83], v[16:19]
    ds_read_b64 v[134:135], v2 offset:8
    v_mfma_f32_16x16x32_bf16 v[24:27], v[60:63], v[72:75], v[24:27]
    ds_read_b128 v[164:167], v3 offset:10752
    v_mfma_f32_16x16x32_bf16 v[36:39], v[40:43], v[72:75], v[36:39]
    v_mfma_f32_16x16x32_bf16 v[32:35], v[44:47], v[72:75], v[32:35]
    v_mfma_f32_16x16x32_bf16 v[28:31], v[56:59], v[72:75], v[28:31]
    v_mfma_f32_16x16x32_bf16 v[20:23], v[64:67], v[72:75], v[20:23]
    v_mfma_f32_16x16x32_bf16 v[16:19], v[68:71], v[72:75], v[16:19]
    s_waitcnt lgkmcnt(0)
    v_mfma_f32_16x16x32_bf16 v[20:23], v[116:119], v[148:151], v[20:23]
    v_mfma_f32_16x16x32_bf16 v[16:19], v[116:119], v[152:155], v[16:19]
    v_mfma_f32_16x16x32_bf16 v[24:27], v[116:119], v[144:147], v[24:27]
    v_mfma_f32_16x16x32_bf16 v[20:23], v[120:123], v[144:147], v[20:23]
    v_mfma_f32_16x16x32_bf16 v[16:19], v[120:123], v[148:151], v[16:19]
    v_mfma_f32_16x16x32_bf16 v[24:27], v[112:115], v[148:151], v[24:27]
    v_mfma_f32_16x16x32_bf16 v[28:31], v[112:115], v[144:147], v[28:31]
    v_mfma_f32_16x16x32_bf16 v[16:19], v[112:115], v[156:159], v[16:19]
    v_mfma_f32_16x16x32_bf16 v[20:23], v[112:115], v[152:155], v[20:23]
    v_mfma_f32_16x16x32_bf16 v[24:27], v[108:111], v[152:155], v[24:27]
    v_mfma_f32_16x16x32_bf16 v[16:19], v[108:111], v[160:163], v[16:19]
    v_mfma_f32_16x16x32_bf16 v[28:31], v[108:111], v[148:151], v[28:31]
    v_mfma_f32_16x16x32_bf16 v[20:23], v[108:111], v[156:159], v[20:23]
    v_mfma_f32_16x16x32_bf16 v[24:27], v[104:107], v[156:159], v[24:27]
    v_mfma_f32_16x16x32_bf16 v[16:19], v[104:107], v[164:167], v[16:19]
    v_mfma_f32_16x16x32_bf16 v[28:31], v[104:107], v[152:155], v[28:31]
    v_mfma_f32_16x16x32_bf16 v[20:23], v[104:107], v[160:163], v[20:23]
    v_mfma_f32_16x16x32_bf16 v[32:35], v[104:107], v[140:143], v[32:35]
    v_mfma_f32_16x16x32_bf16 v[16:19], v[128:131], v[140:143], v[16:19]
    v_mfma_f32_16x16x32_bf16 v[28:31], v[116:119], v[140:143], v[28:31]
    v_mfma_f32_16x16x32_bf16 v[24:27], v[120:123], v[140:143], v[24:27]
    v_mfma_f32_16x16x32_bf16 v[20:23], v[124:127], v[140:143], v[20:23]
    v_mfma_f32_16x16x32_bf16 v[16:19], v[124:127], v[144:147], v[16:19]
    v_mfma_f32_16x16x32_bf16 v[24:27], v[124:127], v[136:139], v[24:27]
    v_mfma_f32_16x16x32_bf16 v[36:39], v[104:107], v[136:139], v[36:39]
    v_mfma_f32_16x16x32_bf16 v[32:35], v[108:111], v[136:139], v[32:35]
    v_mfma_f32_16x16x32_bf16 v[28:31], v[120:123], v[136:139], v[28:31]
    v_mfma_f32_16x16x32_bf16 v[20:23], v[128:131], v[136:139], v[20:23]
    v_mfma_f32_16x16x32_bf16 v[16:19], v[132:135], v[136:139], v[16:19]
    s_waitcnt lgkmcnt(0)
    s_nop 7
    v_cvt_pk_bf16_f32 v20, v20, v21
    v_cvt_pk_bf16_f32 v21, v22, v23
    v_cvt_pk_bf16_f32 v22, v16, v17
    v_cvt_pk_bf16_f32 v23, v18, v19
    v_cvt_pk_bf16_f32 v28, v28, v29
    v_cvt_pk_bf16_f32 v29, v30, v31
    v_cvt_pk_bf16_f32 v30, v24, v25
    v_cvt_pk_bf16_f32 v31, v26, v27
    v_cvt_pk_bf16_f32 v36, v36, v37
    v_cvt_pk_bf16_f32 v37, v38, v39
    v_cvt_pk_bf16_f32 v38, v32, v33
    v_cvt_pk_bf16_f32 v39, v34, v35
    s_nop 1
    v_permlane16_swap_b32 v20, v22
    v_permlane16_swap_b32 v21, v23
    v_permlane16_swap_b32 v28, v30
    v_permlane16_swap_b32 v29, v31
    v_permlane16_swap_b32 v36, v38
    v_permlane16_swap_b32 v37, v39
    buffer_store_dwordx4 v[20:23], v4, s[28:31], s48 offen offset:3072 sc1
    buffer_store_dwordx4 v[28:31], v4, s[28:31], s48 offen offset:2048 sc1
    buffer_store_dwordx4 v[36:39], v4, s[28:31], s48 offen offset:0 sc1
    s_branch L_conv_done
L_conv_b:
    ds_read_b64 v[40:41], v2 offset:4032
    ds_read_b64 v[42:43], v2 offset:4040
    ds_read_b128 v[56:59], v3 offset:1344
    ds_read_b64 v[72:73], v2 offset:20672
    ds_read_b64 v[74:75], v2 offset:20680
    ds_read_b128 v[88:91], v3 offset:1360
    ds_read_b64 v[104:105], v2 offset:37312
    ds_read_b64 v[106:107], v2 offset:37320
    ds_read_b128 v[120:123], v3 offset:1376
    ds_read_b64 v[44:45], v2 offset:3520
    ds_read_b64 v[46:47], v2 offset:3528
    ds_read_b128 v[60:63], v3 offset:2880
    ds_read_b64 v[76:77], v2 offset:20160
    ds_read_b64 v[78:79], v2 offset:20168
    ds_read_b128 v[92:95], v3 offset:2896
    ds_read_b64 v[108:109], v2 offset:36800
    ds_read_b64 v[110:111], v2 offset:36808
    ds_read_b128 v[124:127], v3 offset:2912
    ds_read_b64 v[48:49], v2 offset:3008
    ds_read_b64 v[50:51], v2 offset:3016
    ds_read_b128 v[64:67], v3 offset:4416
    ds_read_b64 v[80:81], v2 offset:19648
    ds_read_b64 v[82:83], v2 offset:19656
    ds_read_b128 v[96:99], v3 offset:4432
    ds_read_b64 v[112:113], v2 offset:36288
    ds_read_b64 v[114:115], v2 offset:36296
    ds_read_b128 v[128:131], v3 offset:4448
    ds_read_b64 v[52:53], v2 offset:2496
    ds_read_b64 v[54:55], v2 offset:2504
    ds_read_b128 v[68:71], v3 offset:5952
    ds_read_b64 v[84:85], v2 offset:19136
    ds_read_b64 v[86:87], v2 offset:19144
    ds_read_b128 v[100:103], v3 offset:5968
    ds_read_b64 v[116:117], v2 offset:35776
    ds_read_b64 v[118:119], v2 offset:35784
    ds_read_b128 v[132:135], v3 offset:5984
    s_waitcnt lgkmcnt(0)
    v_mfma_f32_16x16x32_bf16 v[16:19], v[40:43], v[68:71], 0
    ds_read_b64 v[136:137], v2 offset:3968
    ds_read_b64 v[138:139], v2 offset:3976
    v_mfma_f32_16x16x32_bf16 v[20:23], v[40:43], v[64:67], 0
    ds_read_b128 v[152:155], v3 offset:1152
    ds_read_b64 v[168:169], v2 offset:20608
    v_mfma_f32_16x16x32_bf16 v[16:19], v[44:47], v[64:67], v[16:19]
    ds_read_b64 v[170:171], v2 offset:20616
    ds_read_b128 v[184:187], v3 offset:1168
    v_mfma_f32_16x16x32_bf16 v[20:23], v[44:47], v[60:63], v[20:23]
    ds_read_b64 v[200:201], v2 offset:37248
    ds_read_b64 v[202:203], v2 offset:37256
    v_mfma_f32_16x16x32_bf16 v[16:19], v[48:51], v[60:63], v[16:19]
    ds_read_b128 v[216:219], v3 offset:1184
    ds_read_b64 v[140:141], v2 offset:3456
    v_mfma_f32_16x16x32_bf16 v[20:23], v[48:51], v[56:59], v[20:23]
    ds_read_b64 v[142:143], v2 offset:3464
    ds_read_b128 v[156:159], v3 offset:2688
    v_mfma_f32_16x16x32_bf16 v[16:19], v[52:55], v[56:59], v[16:19]
    ds_read_b64 v[172:173], v2 offset:20096
    ds_read_b64 v[174:175], v2 offset:20104
    v_mfma_f32_16x16x32_bf16 v[24:27], v[76:79], v[96:99], 0
    ds_read_b128 v[188:191], v3 offset:2704
    ds_read_b64 v[204:205], v2 offset:36736
    v_mfma_f32_16x16x32_bf16 v[28:31], v[76:79], v[92:95], 0
    ds_read_b64 v[206:207], v2 offset:36744
    ds_read_b128 v[220:223], v3 offset:2720
    v_mfma_f32_16x16x32_bf16 v[24:27], v[80:83], v[92:95], v[24:27]
    ds_read_b64 v[144:145], v2 offset:2944
    ds_read_b64 v[146:147], v2 offset:2952
    v_mfma_f32_16x16x32_bf16 v[28:31], v[80:83], v[88:91], v[28:31]
    ds_read_b128 v[160:163], v3 offset:4224
    ds_read_b64 v[176:177], v2 offset:19584
    v_mfma_f32_16x16x32_bf16 v[24:27], v[84:87], v[88:91], v[24:27]
    ds_read_b64 v[178:179], v2 offset:19592
    ds_read_b128 v[192:195], v3 offset:4240
    v_mfma_f32_16x16x32_bf16 v[32:35], v[108:111], v[128:131], 0
    ds_read_b64 v[208:209], v2 offset:36224
    ds_read_b64 v[210:211], v2 offset:36232
    v_mfma_f32_16x16x32_bf16 v[36:39], v[108:111], v[124:127], 0
    ds_read_b128 v[224:227], v3 offset:4256
    ds_read_b64 v[148:149], v2 offset:2432
    v_mfma_f32_16x16x32_bf16 v[32:35], v[112:115], v[124:127], v[32:35]
    ds_read_b64 v[150:151], v2 offset:2440
    ds_read_b128 v[164:167], v3 offset:5760
    v_mfma_f32_16x16x32_bf16 v[36:39], v[112:115], v[120:123], v[36:39]
    ds_read_b64 v[180:181], v2 offset:19072
    v_mfma_f32_16x16x32_bf16 v[32:35], v[116:119], v[120:123], v[32:35]
    ds_read_b64 v[182:183], v2 offset:19080
    v_mfma_f32_16x16x32_bf16 v[28:31], v[72:75], v[96:99], v[28:31]
    ds_read_b128 v[196:199], v3 offset:5776
    v_mfma_f32_16x16x32_bf16 v[24:27], v[72:75], v[100:103], v[24:27]
    ds_read_b64 v[212:213], v2 offset:35712
    v_mfma_f32_16x16x32_bf16 v[36:39], v[104:107], v[128:131], v[36:39]
    ds_read_b64 v[214:215], v2 offset:35720
    v_mfma_f32_16x16x32_bf16 v[32:35], v[104:107], v[132:135], v[32:35]
    ds_read_b128 v[228:231], v3 offset:5792
    s_waitcnt lgkmcnt(0)
    s_cmp_ge_u32 s8, 27
    s_cbranch_scc1 L_no_s2_b
    s_waitcnt vmcnt(0)
    s_lshl_b32 s44, s4, 5
    s_add_u32 s44, s44, s5
    s_lshl_b32 s44, s44, 2
    s_add_u32 s44, s44, 0x1000
    s_mov_b64 exec, 1
    v_mov_b32 v252, 162308
    v_mov_b32 v253, 1
    ds_add_rtn_u32 v253, v252, v253
    s_mov_b64 exec, 0x3ff
    v_mov_b32 v252, s11
    v_mul_u32_u24 v254, 1024, v0
    s_waitcnt lgkmcnt(0)
    v_readfirstlane_b32 s45, v253
    s_cmp_lg_u32 s45, 3
    s_cbranch_scc1 L_noflag_s2b
    buffer_store_dword v252, v254, s[28:31], s44 offen sc1
L_noflag_s2b:
    s_mov_b64 exec, -1
L_no_s2_b:
    v_mfma_f32_16x16x32_bf16 v[16:19], v[136:139], v[164:167], v[16:19]
    ds_read_b64 v[40:41], v2 offset:3904
    ds_read_b64 v[42:43], v2 offset:3912
    v_mfma_f32_16x16x32_bf16 v[20:23], v[136:139], v[160:163], v[20:23]
    ds_read_b128 v[56:59], v3 offset:960
    ds_read_b64 v[72:73], v2 offset:20544
    v_mfma_f32_16x16x32_bf16 v[16:19], v[140:143], v[160:163], v[16:19]
    ds_read_b64 v[74:75], v2 offset:20552
    ds_read_b128 v[88:91], v3 offset:976
    v_mfma_f32_16x16x32_bf16 v[20:23], v[140:143], v[156:159], v[20:23]
    ds_read_b64 v[104:105], v2 offset:37184
    ds_read_b64 v[106:107], v2 offset:37192
    v_mfma_f32_16x16x32_bf16 v[16:19], v[144:147], v[156:159], v[16:19]
    ds_read_b128 v[120:123], v3 offset:992
    ds_read_b64 v[44:45], v2 offset:3392
    v_mfma_f32_16x16x32_bf16 v[20:23], v[144:147], v[152:155], v[20:23]
    ds_read_b64 v[46:47], v2 offset:3400
    ds_read_b128 v[60:63], v3 offset:2496
    v_mfma_f32_16x16x32_bf16 v[16:19], v[148:151], v[152:155], v[16:19]
    ds_read_b64 v[76:77], v2 offset:20032
    ds_read_b64 v[78:79], v2 offset:20040
    v_mfma_f32_16x16x32_bf16 v[24:27], v[172:175], v[192:195], v[24:27]
    ds_read_b128 v[92:95], v3 offset:2512
    ds_read_b64 v[108:109], v2 offset:36672
    v_mfma_f32_16x16x32_bf16 v[28:31], v[172:175], v[188:191], v[28:31]
    ds_read_b64 v[110:111], v2 offset:36680
    ds_read_b128 v[124:127], v3 offset:2528
    v_mfma_f32_16x16x32_bf16 v[24:27], v[176:179], v[188:191], v[24:27]
    ds_read_b64 v[48:49], v2 offset:2880
    ds_read_b64 v[50:51], v2 offset:2888
    v_mfma_f32_16x16x32_bf16 v[28:31], v[176:179], v[184:187], v[28:31]
    ds_read_b128 v[64:67], v3 offset:4032
    ds_read_b64 v[80:81], v2 offset:19520
    v_mfma_f32_16x16x32_bf16 v[24:27], v[180:183], v[184:187], v[24:27]
    ds_read_b64 v[82:83], v2 offset:19528
    ds_read_b128 v[96:99], v3 offset:4048
    v_mfma_f32_16x16x32_bf16 v[32:35], v[204:207], v[224:227], v[32:35]
    ds_read_b64 v[112:113], v2 offset:36160
    ds_read_b64 v[114:115], v2 offset:36168
    v_mfma_f32_16x16x32_bf16 v[36:39], v[204:207], v[220:223], v[36:39]
    ds_read_b128 v[128:131], v3 offset:4064
    ds_read_b64 v[52:53], v2 offset:2368
    v_mfma_f32_16x16x32_bf16 v[32:35], v[208:211], v[220:223], v[32:35]
    ds_read_b64 v[54:55], v2 offset:2376
    ds_read_b128 v[68:71], v3 offset:5568
    v_mfma_f32_16x16x32_bf16 v[36:39], v[208:211], v[216:219], v[36:39]
    ds_read_b64 v[84:85], v2 offset:19008
    v_mfma_f32_16x16x32_bf16 v[32:35], v[212:215], v[216:219], v[32:35]
    ds_read_b64 v[86:87], v2 offset:19016
    v_mfma_f32_16x16x32_bf16 v[28:31], v[168:171], v[192:195], v[28:31]
    ds_read_b128 v[100:103], v3 offset:5584
    v_mfma_f32_16x16x32_bf16 v[24:27], v[168:171], v[196:199], v[24:27]
    ds_read_b64 v[116:117], v2 offset:35648
    v_mfma_f32_16x16x32_bf16 v[36:39], v[200:203], v[224:227], v[36:39]
    ds_read_b64 v[118:119], v2 offset:35656
    v_mfma_f32_16x16x32_bf16 v[32:35], v[200:203], v[228:231], v[32:35]
    ds_read_b128 v[132:135], v3 offset:5600
    s_waitcnt lgkmcnt(0)
    v_mfma_f32_16x16x32_bf16 v[16:19], v[40:43], v[68:71], v[16:19]
    ds_read_b64 v[136:137], v2 offset:3840
    ds_read_b64 v[138:139], v2 offset:3848
    v_mfma_f32_16x16x32_bf16 v[20:23], v[40:43], v[64:67], v[20:23]
    ds_read_b128 v[152:155], v3 offset:768
    ds_read_b64 v[168:169], v2 offset:20480
    v_mfma_f32_16x16x32_bf16 v[16:19], v[44:47], v[64:67], v[16:19]
    ds_read_b64 v[170:171], v2 offset:20488
    ds_read_b128 v[184:187], v3 offset:784
    v_mfma_f32_16x16x32_bf16 v[20:23], v[44:47], v[60:63], v[20:23]
    ds_read_b64 v[200:201], v2 offset:37120
    ds_read_b64 v[202:203], v2 offset:37128
    v_mfma_f32_16x16x32_bf16 v[16:19], v[48:51], v[60:63], v[16:19]
    ds_read_b128 v[216:219], v3 offset:800
    ds_read_b64 v[140:141], v2 offset:3328
    v_mfma_f32_16x16x32_bf16 v[20:23], v[48:51], v[56:59], v[20:23]
    ds_read_b64 v[142:143], v2 offset:3336
    ds_read_b128 v[156:159], v3 offset:2304
    v_mfma_f32_16x16x32_bf16 v[16:19], v[52:55], v[56:59], v[16:19]
    ds_read_b64 v[172:173], v2 offset:19968
    ds_read_b64 v[174:175], v2 offset:19976
    v_mfma_f32_16x16x32_bf16 v[24:27], v[76:79], v[96:99], v[24:27]
    ds_read_b128 v[188:191], v3 offset:2320
    ds_read_b64 v[204:205], v2 offset:36608
    v_mfma_f32_16x16x32_bf16 v[28:31], v[76:79], v[92:95], v[28:31]
    ds_read_b64 v[206:207], v2 offset:36616
    ds_read_b128 v[220:223], v3 offset:2336
    v_mfma_f32_16x16x32_bf16 v[24:27], v[80:83], v[92:95], v[24:27]
    ds_read_b64 v[144:145], v2 offset:2816
    ds_read_b64 v[146:147], v2 offset:2824
    v_mfma_f32_16x16x32_bf16 v[28:31], v[80:83], v[88:91], v[28:31]
    ds_read_b128 v[160:163], v3 offset:3840
    ds_read_b64 v[176:177], v2 offset:19456
    v_mfma_f32_16x16x32_bf16 v[24:27], v[84:87], v[88:91], v[24:27]
    ds_read_b64 v[178:179], v2 offset:19464
    ds_read_b128 v[192:195], v3 offset:3856
    v_mfma_f32_16x16x32_bf16 v[32:35], v[108:111], v[128:131], v[32:35]
    ds_read_b64 v[208:209], v2 offset:36096
    ds_read_b64 v[210:211], v2 offset:36104
    v_mfma_f32_16x16x32_bf16 v[36:39], v[108:111], v[124:127], v[36:39]
    ds_read_b128 v[224:227], v3 offset:3872
    ds_read_b64 v[148:149], v2 offset:2304
    v_mfma_f32_16x16x32_bf16 v[32:35], v[112:115], v[124:127], v[32:35]
    ds_read_b64 v[150:151], v2 offset:2312
    ds_read_b128 v[164:167], v3 offset:5376
    v_mfma_f32_16x16x32_bf16 v[36:39], v[112:115], v[120:123], v[36:39]
    ds_read_b64 v[180:181], v2 offset:18944
    v_mfma_f32_16x16x32_bf16 v[32:35], v[116:119], v[120:123], v[32:35]
    ds_read_b64 v[182:183], v2 offset:18952
    v_mfma_f32_16x16x32_bf16 v[28:31], v[72:75], v[96:99], v[28:31]
    ds_read_b128 v[196:199], v3 offset:5392
    v_mfma_f32_16x16x32_bf16 v[24:27], v[72:75], v[100:103], v[24:27]
    ds_read_b64 v[212:213], v2 offset:35584
    v_mfma_f32_16x16x32_bf16 v[36:39], v[104:107], v[128:131], v[36:39]
    ds_read_b64 v[214:215], v2 offset:35592
    v_mfma_f32_16x16x32_bf16 v[32:35], v[104:107], v[132:135], v[32:35]
    ds_read_b128 v[228:231], v3 offset:5408
    s_waitcnt lgkmcnt(0)
    v_mfma_f32_16x16x32_bf16 v[16:19], v[136:139], v[164:167], v[16:19]
    ds_read_b64 v[40:41], v2 offset:3776
    ds_read_b64 v[42:43], v2 offset:3784
    v_mfma_f32_16x16x32_bf16 v[20:23], v[136:139], v[160:163], v[20:23]
    ds_read_b128 v[56:59], v3 offset:576
    ds_read_b64 v[72:73], v2 offset:20416
    v_mfma_f32_16x16x32_bf16 v[16:19], v[140:143], v[160:163], v[16:19]
    ds_read_b64 v[74:75], v2 offset:20424
    ds_read_b128 v[88:91], v3 offset:592
    v_mfma_f32_16x16x32_bf16 v[20:23], v[140:143], v[156:159], v[20:23]
    ds_read_b64 v[104:105], v2 offset:37056
    ds_read_b64 v[106:107], v2 offset:37064
    v_mfma_f32_16x16x32_bf16 v[16:19], v[144:147], v[156:159], v[16:19]
    ds_read_b128 v[120:123], v3 offset:608
    ds_read_b64 v[44:45], v2 offset:3264
    v_mfma_f32_16x16x32_bf16 v[20:23], v[144:147], v[152:155], v[20:23]
    ds_read_b64 v[46:47], v2 offset:3272
    ds_read_b128 v[60:63], v3 offset:2112
    v_mfma_f32_16x16x32_bf16 v[16:19], v[148:151], v[152:155], v[16:19]
    ds_read_b64 v[76:77], v2 offset:19904
    ds_read_b64 v[78:79], v2 offset:19912
    v_mfma_f32_16x16x32_bf16 v[24:27], v[172:175], v[192:195], v[24:27]
    ds_read_b128 v[92:95], v3 offset:2128
    ds_read_b64 v[108:109], v2 offset:36544
    v_mfma_f32_16x16x32_bf16 v[28:31], v[172:175], v[188:191], v[28:31]
    ds_read_b64 v[110:111], v2 offset:36552
    ds_read_b128 v[124:127], v3 offset:2144
    v_mfma_f32_16x16x32_bf16 v[24:27], v[176:179], v[188:191], v[24:27]
    ds_read_b64 v[48:49], v2 offset:2752
    ds_read_b64 v[50:51], v2 offset:2760
    v_mfma_f32_16x16x32_bf16 v[28:31], v[176:179], v[184:187], v[28:31]
    ds_read_b128 v[64:67], v3 offset:3648
    ds_read_b64 v[80:81], v2 offset:19392
    v_mfma_f32_16x16x32_bf16 v[24:27], v[180:183], v[184:187], v[24:27]
    ds_read_b64 v[82:83], v2 offset:19400
    ds_read_b128 v[96:99], v3 offset:3664
    v_mfma_f32_16x16x32_bf16 v[32:35], v[204:207], v[224:227], v[32:35]
    ds_read_b64 v[112:113], v2 offset:36032
    ds_read_b64 v[114:115], v2 offset:36040
    v_mfma_f32_16x16x32_bf16 v[36:39], v[204:207], v[220:223], v[36:39]
    ds_read_b128 v[128:131], v3 offset:3680
    ds_read_b64 v[52:53], v2 offset:2240
    v_mfma_f32_16x16x32_bf16 v[32:35], v[208:211], v[220:223], v[32:35]
    ds_read_b64 v[54:55], v2 offset:2248
    ds_read_b128 v[68:71], v3 offset:5184
    v_mfma_f32_16x16x32_bf16 v[36:39], v[208:211], v[216:219], v[36:39]
    ds_read_b64 v[84:85], v2 offset:18880
    v_mfma_f32_16x16x32_bf16 v[32:35], v[212:215], v[216:219], v[32:35]
    ds_read_b64 v[86:87], v2 offset:18888
    v_mfma_f32_16x16x32_bf16 v[28:31], v[168:171], v[192:195], v[28:31]
    ds_read_b128 v[100:103], v3 offset:5200
    v_mfma_f32_16x16x32_bf16 v[24:27], v[168:171], v[196:199], v[24:27]
    ds_read_b64 v[116:117], v2 offset:35520
    v_mfma_f32_16x16x32_bf16 v[36:39], v[200:203], v[224:227], v[36:39]
    ds_read_b64 v[118:119], v2 offset:35528
    v_mfma_f32_16x16x32_bf16 v[32:35], v[200:203], v[228:231], v[32:35]
    ds_read_b128 v[132:135], v3 offset:5216
    s_waitcnt lgkmcnt(0)
    v_mfma_f32_16x16x32_bf16 v[16:19], v[40:43], v[68:71], v[16:19]
    ds_read_b64 v[136:137], v2 offset:3712
    ds_read_b64 v[138:139], v2 offset:3720
    v_mfma_f32_16x16x32_bf16 v[20:23], v[40:43], v[64:67], v[20:23]
    ds_read_b128 v[152:155], v3 offset:384
    ds_read_b64 v[168:169], v2 offset:20352
    v_mfma_f32_16x16x32_bf16 v[16:19], v[44:47], v[64:67], v[16:19]
    ds_read_b64 v[170:171], v2 offset:20360
    ds_read_b128 v[184:187], v3 offset:400
    v_mfma_f32_16x16x32_bf16 v[20:23], v[44:47], v[60:63], v[20:23]
    ds_read_b64 v[200:201], v2 offset:36992
    ds_read_b64 v[202:203], v2 offset:37000
    v_mfma_f32_16x16x32_bf16 v[16:19], v[48:51], v[60:63], v[16:19]
    ds_read_b128 v[216:219], v3 offset:416
    ds_read_b64 v[140:141], v2 offset:3200
    v_mfma_f32_16x16x32_bf16 v[20:23], v[48:51], v[56:59], v[20:23]
    ds_read_b64 v[142:143], v2 offset:3208
    ds_read_b128 v[156:159], v3 offset:1920
    v_mfma_f32_16x16x32_bf16 v[16:19], v[52:55], v[56:59], v[16:19]
    ds_read_b64 v[172:173], v2 offset:19840
    ds_read_b64 v[174:175], v2 offset:19848
    v_mfma_f32_16x16x32_bf16 v[24:27], v[76:79], v[96:99], v[24:27]
    ds_read_b128 v[188:191], v3 offset:1936
    ds_read_b64 v[204:205], v2 offset:36480
    v_mfma_f32_16x16x32_bf16 v[28:31], v[76:79], v[92:95], v[28:31]
    ds_read_b64 v[206:207], v2 offset:36488
    ds_read_b128 v[220:223], v3 offset:1952
    v_mfma_f32_16x16x32_bf16 v[24:27], v[80:83], v[92:95], v[24:27]
    ds_read_b64 v[144:145], v2 offset:2688
    ds_read_b64 v[146:147], v2 offset:2696
    v_mfma_f32_16x16x32_bf16 v[28:31], v[80:83], v[88:91], v[28:31]
    ds_read_b128 v[160:163], v3 offset:3456
    ds_read_b64 v[176:177], v2 offset:19328
    v_mfma_f32_16x16x32_bf16 v[24:27], v[84:87], v[88:91], v[24:27]
    ds_read_b64 v[178:179], v2 offset:19336
    ds_read_b128 v[192:195], v3 offset:3472
    v_mfma_f32_16x16x32_bf16 v[32:35], v[108:111], v[128:131], v[32:35]
    ds_read_b64 v[208:209], v2 offset:35968
    ds_read_b64 v[210:211], v2 offset:35976
    v_mfma_f32_16x16x32_bf16 v[36:39], v[108:111], v[124:127], v[36:39]
    ds_read_b128 v[224:227], v3 offset:3488
    ds_read_b64 v[148:149], v2 offset:2176
    v_mfma_f32_16x16x32_bf16 v[32:35], v[112:115], v[124:127], v[32:35]
    ds_read_b64 v[150:151], v2 offset:2184
    ds_read_b128 v[164:167], v3 offset:4992
    v_mfma_f32_16x16x32_bf16 v[36:39], v[112:115], v[120:123], v[36:39]
    ds_read_b64 v[180:181], v2 offset:18816
    v_mfma_f32_16x16x32_bf16 v[32:35], v[116:119], v[120:123], v[32:35]
    ds_read_b64 v[182:183], v2 offset:18824
    v_mfma_f32_16x16x32_bf16 v[28:31], v[72:75], v[96:99], v[28:31]
    ds_read_b128 v[196:199], v3 offset:5008
    v_mfma_f32_16x16x32_bf16 v[24:27], v[72:75], v[100:103], v[24:27]
    ds_read_b64 v[212:213], v2 offset:35456
    v_mfma_f32_16x16x32_bf16 v[36:39], v[104:107], v[128:131], v[36:39]
    ds_read_b64 v[214:215], v2 offset:35464
    v_mfma_f32_16x16x32_bf16 v[32:35], v[104:107], v[132:135], v[32:35]
    ds_read_b128 v[228:231], v3 offset:5024
    s_waitcnt lgkmcnt(0)
    v_mfma_f32_16x16x32_bf16 v[16:19], v[136:139], v[164:167], v[16:19]
    ds_read_b64 v[40:41], v2 offset:3648
    ds_read_b64 v[42:43], v2 offset:3656
    v_mfma_f32_16x16x32_bf16 v[20:23], v[136:139], v[160:163], v[20:23]
    ds_read_b128 v[56:59], v3 offset:192
    ds_read_b64 v[72:73], v2 offset:20288
    v_mfma_f32_16x16x32_bf16 v[16:19], v[140:143], v[160:163], v[16:19]
    ds_read_b64 v[74:75], v2 offset:20296
    ds_read_b128 v[88:91], v3 offset:208
    v_mfma_f32_16x16x32_bf16 v[20:23], v[140:143], v[156:159], v[20:23]
    ds_read_b64 v[104:105], v2 offset:36928
    ds_read_b64 v[106:107], v2 offset:36936
    v_mfma_f32_16x16x32_bf16 v[16:19], v[144:147], v[156:159], v[16:19]
    ds_read_b128 v[120:123], v3 offset:224
    ds_read_b64 v[44:45], v2 offset:3136
    v_mfma_f32_16x16x32_bf16 v[20:23], v[144:147], v[152:155], v[20:23]
    ds_read_b64 v[46:47], v2 offset:3144
    ds_read_b128 v[60:63], v3 offset:1728
    v_mfma_f32_16x16x32_bf16 v[16:19], v[148:151], v[152:155], v[16:19]
    ds_read_b64 v[76:77], v2 offset:19776
    ds_read_b64 v[78:79], v2 offset:19784
    v_mfma_f32_16x16x32_bf16 v[24:27], v[172:175], v[192:195], v[24:27]
    ds_read_b128 v[92:95], v3 offset:1744
    ds_read_b64 v[108:109], v2 offset:36416
    v_mfma_f32_16x16x32_bf16 v[28:31], v[172:175], v[188:191], v[28:31]
    ds_read_b64 v[110:111], v2 offset:36424
    ds_read_b128 v[124:127], v3 offset:1760
    v_mfma_f32_16x16x32_bf16 v[24:27], v[176:179], v[188:191], v[24:27]
    ds_read_b64 v[48:49], v2 offset:2624
    ds_read_b64 v[50:51], v2 offset:2632
    v_mfma_f32_16x16x32_bf16 v[28:31], v[176:179], v[184:187], v[28:31]
    ds_read_b128 v[64:67], v3 offset:3264
    ds_read_b64 v[80:81], v2 offset:19264
    v_mfma_f32_16x16x32_bf16 v[24:27], v[180:183], v[184:187], v[24:27]
    ds_read_b64 v[82:83], v2 offset:19272
    ds_read_b128 v[96:99], v3 offset:3280
    v_mfma_f32_16x16x32_bf16 v[32:35], v[204:207], v[224:227], v[32:35]
    ds_read_b64 v[112:113], v2 offset:35904
    ds_read_b64 v[114:115], v2 offset:35912
    v_mfma_f32_16x16x32_bf16 v[36:39], v[204:207], v[220:223], v[36:39]
    ds_read_b128 v[128:131], v3 offset:3296
    ds_read_b64 v[52:53], v2 offset:2112
    v_mfma_f32_16x16x32_bf16 v[32:35], v[208:211], v[220:223], v[32:35]
    ds_read_b64 v[54:55], v2 offset:2120
    ds_read_b128 v[68:71], v3 offset:4800
    v_mfma_f32_16x16x32_bf16 v[36:39], v[208:211], v[216:219], v[36:39]
    ds_read_b64 v[84:85], v2 offset:18752
    v_mfma_f32_16x16x32_bf16 v[32:35], v[212:215], v[216:219], v[32:35]
    ds_read_b64 v[86:87], v2 offset:18760
    v_mfma_f32_16x16x32_bf16 v[28:31], v[168:171], v[192:195], v[28:31]
    ds_read_b128 v[100:103], v3 offset:4816
    v_mfma_f32_16x16x32_bf16 v[24:27], v[168:171], v[196:199], v[24:27]
    ds_read_b64 v[116:117], v2 offset:35392
    v_mfma_f32_16x16x32_bf16 v[36:39], v[200:203], v[224:227], v[36:39]
    ds_read_b64 v[118:119], v2 offset:35400
    v_mfma_f32_16x16x32_bf16 v[32:35], v[200:203], v[228:231], v[32:35]
    ds_read_b128 v[132:135], v3 offset:4832
    s_waitcnt lgkmcnt(0)
    v_mfma_f32_16x16x32_bf16 v[16:19], v[40:43], v[68:71], v[16:19]
    ds_read_b64 v[136:137], v2 offset:3584
    ds_read_b64 v[138:139], v2 offset:3592
    v_mfma_f32_16x16x32_bf16 v[20:23], v[40:43], v[64:67], v[20:23]
    ds_read_b128 v[152:155], v3 offset:0
    ds_read_b64 v[168:169], v2 offset:20224
    v_mfma_f32_16x16x32_bf16 v[16:19], v[44:47], v[64:67], v[16:19]
    ds_read_b64 v[170:171], v2 offset:20232
    ds_read_b128 v[184:187], v3 offset:16
    v_mfma_f32_16x16x32_bf16 v[20:23], v[44:47], v[60:63], v[20:23]
    ds_read_b64 v[200:201], v2 offset:36864
    ds_read_b64 v[202:203], v2 offset:36872
    v_mfma_f32_16x16x32_bf16 v[16:19], v[48:51], v[60:63], v[16:19]
    ds_read_b128 v[216:219], v3 offset:32
    ds_read_b64 v[140:141], v2 offset:3072
    v_mfma_f32_16x16x32_bf16 v[20:23], v[48:51], v[56:59], v[20:23]
    ds_read_b64 v[142:143], v2 offset:3080
    ds_read_b128 v[156:159], v3 offset:1536
    v_mfma_f32_16x16x32_bf16 v[16:19], v[52:55], v[56:59], v[16:19]
    ds_read_b64 v[172:173], v2 offset:19712
    ds_read_b64 v[174:175], v2 offset:19720
    v_mfma_f32_16x16x32_bf16 v[24:27], v[76:79], v[96:99], v[24:27]
    ds_read_b128 v[188:191], v3 offset:1552
    ds_read_b64 v[204:205], v2 offset:36352
    v_mfma_f32_16x16x32_bf16 v[28:31], v[76:79], v[92:95], v[28:31]
    ds_read_b64 v[206:207], v2 offset:36360
    ds_read_b128 v[220:223], v3 offset:1568
    v_mfma_f32_16x16x32_bf16 v[24:27], v[80:83], v[92:95], v[24:27]
    ds_read_b64 v[144:145], v2 offset:2560
    ds_read_b64 v[146:147], v2 offset:2568
    v_mfma_f32_16x16x32_bf16 v[28:31], v[80:83], v[88:91], v[28:31]
    ds_read_b128 v[160:163], v3 offset:3072
    ds_read_b64 v[176:177], v2 offset:19200
    v_mfma_f32_16x16x32_bf16 v[24:27], v[84:87], v[88:91], v[24:27]
    ds_read_b64 v[178:179], v2 offset:19208
    ds_read_b128 v[192:195], v3 offset:3088
    v_mfma_f32_16x16x32_bf16 v[32:35], v[108:111], v[128:131], v[32:35]
    ds_read_b64 v[208:209], v2 offset:35840
    ds_read_b64 v[210:211], v2 offset:35848
    v_mfma_f32_16x16x32_bf16 v[36:39], v[108:111], v[124:127], v[36:39]
    ds_read_b128 v[224:227], v3 offset:3104
    ds_read_b64 v[148:149], v2 offset:2048
    v_mfma_f32_16x16x32_bf16 v[32:35], v[112:115], v[124:127], v[32:35]
    ds_read_b64 v[150:151], v2 offset:2056
    ds_read_b128 v[164:167], v3 offset:4608
    v_mfma_f32_16x16x32_bf16 v[36:39], v[112:115], v[120:123], v[36:39]
    ds_read_b64 v[180:181], v2 offset:18688
    v_mfma_f32_16x16x32_bf16 v[32:35], v[116:119], v[120:123], v[32:35]
    ds_read_b64 v[182:183], v2 offset:18696
    v_mfma_f32_16x16x32_bf16 v[28:31], v[72:75], v[96:99], v[28:31]
    ds_read_b128 v[196:199], v3 offset:4624
    v_mfma_f32_16x16x32_bf16 v[24:27], v[72:75], v[100:103], v[24:27]
    ds_read_b64 v[212:213], v2 offset:35328
    v_mfma_f32_16x16x32_bf16 v[36:39], v[104:107], v[128:131], v[36:39]
    ds_read_b64 v[214:215], v2 offset:35336
    v_mfma_f32_16x16x32_bf16 v[32:35], v[104:107], v[132:135], v[32:35]
    ds_read_b128 v[228:231], v3 offset:4640
    s_waitcnt lgkmcnt(0)
    v_mfma_f32_16x16x32_bf16 v[16:19], v[136:139], v[164:167], v[16:19]
    v_mfma_f32_16x16x32_bf16 v[20:23], v[136:139], v[160:163], v[20:23]
    v_mfma_f32_16x16x32_bf16 v[16:19], v[140:143], v[160:163], v[16:19]
    v_mfma_f32_16x16x32_bf16 v[20:23], v[140:143], v[156:159], v[20:23]
    v_mfma_f32_16x16x32_bf16 v[16:19], v[144:147], v[156:159], v[16:19]
    v_mfma_f32_16x16x32_bf16 v[20:23], v[144:147], v[152:155], v[20:23]
    v_mfma_f32_16x16x32_bf16 v[16:19], v[148:151], v[152:155], v[16:19]
    v_mfma_f32_16x16x32_bf16 v[24:27], v[172:175], v[192:195], v[24:27]
    v_mfma_f32_16x16x32_bf16 v[28:31], v[172:175], v[188:191], v[28:31]
    v_mfma_f32_16x16x32_bf16 v[24:27], v[176:179], v[188:191], v[24:27]
    v_mfma_f32_16x16x32_bf16 v[28:31], v[176:179], v[184:187], v[28:31]
    v_mfma_f32_16x16x32_bf16 v[24:27], v[180:183], v[184:187], v[24:27]
    v_mfma_f32_16x16x32_bf16 v[32:35], v[204:207], v[224:227], v[32:35]
    v_mfma_f32_16x16x32_bf16 v[36:39], v[204:207], v[220:223], v[36:39]
    v_mfma_f32_16x16x32_bf16 v[32:35], v[208:211], v[220:223], v[32:35]
    v_mfma_f32_16x16x32_bf16 v[36:39], v[208:211], v[216:219], v[36:39]
    v_mfma_f32_16x16x32_bf16 v[32:35], v[212:215], v[216:219], v[32:35]
    v_mfma_f32_16x16x32_bf16 v[28:31], v[168:171], v[192:195], v[28:31]
    v_mfma_f32_16x16x32_bf16 v[24:27], v[168:171], v[196:199], v[24:27]
    v_mfma_f32_16x16x32_bf16 v[36:39], v[200:203], v[224:227], v[36:39]
    v_mfma_f32_16x16x32_bf16 v[32:35], v[200:203], v[228:231], v[32:35]
    s_waitcnt lgkmcnt(0)
    s_nop 7
    v_cvt_pk_bf16_f32 v20, v20, v21
    v_cvt_pk_bf16_f32 v21, v22, v23
    v_cvt_pk_bf16_f32 v22, v16, v17
    v_cvt_pk_bf16_f32 v23, v18, v19
    s_nop 1
    v_permlane16_swap_b32 v20, v22
    v_permlane16_swap_b32 v21, v23
    buffer_store_dwordx4 v[20:23], v4, s[28:31], s48 offen offset:1024 sc1
    v_cvt_pk_bf16_f32 v28, v28, v29
    v_cvt_pk_bf16_f32 v29, v30, v31
    v_cvt_pk_bf16_f32 v30, v24, v25
    v_cvt_pk_bf16_f32 v31, v26, v27
    s_nop 1
    v_permlane16_swap_b32 v28, v30
    v_permlane16_swap_b32 v29, v31
    buffer_store_dwordx4 v[28:31], v4, s[28:31], s49 offen offset:1024 sc1
    v_cvt_pk_bf16_f32 v36, v36, v37
    v_cvt_pk_bf16_f32 v37, v38, v39
    v_cvt_pk_bf16_f32 v38, v32, v33
    v_cvt_pk_bf16_f32 v39, v34, v35
    s_nop 1
    v_permlane16_swap_b32 v36, v38
    v_permlane16_swap_b32 v37, v39
    s_cmp_lt_u32 s10, 3
    s_cbranch_scc1 L_cv_skip_b
    buffer_store_dwordx4 v[36:39], v4, s[28:31], s50 offen offset:1024 sc1
L_cv_skip_b:
    s_branch L_conv_done
L_conv_idle:
    s_cmp_ge_u32 s8, 27
    s_cbranch_scc1 L_no_s2_i
    s_waitcnt vmcnt(0)
    s_lshl_b32 s44, s4, 5
    s_add_u32 s44, s44, s5
    s_lshl_b32 s44, s44, 2
    s_add_u32 s44, s44, 0x1000
    s_mov_b64 exec, 1
    v_mov_b32 v252, 162308
    v_mov_b32 v253, 1
    ds_add_rtn_u32 v253, v252, v253
    s_mov_b64 exec, 0x3ff
    v_mov_b32 v252, s11
    v_mul_u32_u24 v254, 1024, v0
    s_waitcnt lgkmcnt(0)
    v_readfirstlane_b32 s45, v253
    s_cmp_lg_u32 s45, 3
    s_cbranch_scc1 L_noflag_s2i
    buffer_store_dword v252, v254, s[28:31], s44 offen sc1
L_noflag_s2i:
    s_mov_b64 exec, -1
L_no_s2_i:
L_conv_done:
    s_cmp_lg_u32 s58, 0
    s_cbranch_scc1 L_m_f2
    s_waitcnt vmcnt(0)
    s_and_b32 s44, s2, 7
    s_lshl_b32 s44, s44, 5
    s_add_u32 s44, s44, s8
    s_lshl_b32 s44, s44, 2
    s_add_u32 s44, s44, 0x4000
    s_mov_b64 exec, 1
    v_mov_b32 v252, 162312
    v_mov_b32 v253, 1
    ds_add_rtn_u32 v253, v252, v253
    s_mov_b64 exec, 0xff
    v_mov_b32 v252, s11
    v_mul_u32_u24 v254, 1024, v0
    s_waitcnt lgkmcnt(0)
    v_readfirstlane_b32 s45, v253
    s_cmp_lg_u32 s45, 3
    s_cbranch_scc1 L_noflag_s3e
    buffer_store_dword v252, v254, s[28:31], s44 offen sc1
L_noflag_s3e:
    s_mov_b64 exec, -1
    s_branch L_m_end
L_m_f2:
    v_lshrrev_b32 v16, 4, v0
    v_bfe_u32 v17, v0, 2, 2
    v_lshl_add_u32 v18, v16, 3, v17
    v_lshlrev_b32 v18, 7, v18
    v_and_b32 v19, 3, v0
    v_lshl_add_u32 v18, v19, 3, v18
    v_lshrrev_b32 v17, 1, v17
    v_and_b32 v16, 1, v16
    v_lshl_add_u32 v17, v16, 1, v17
    v_xor_b32 v1, 0, v17
    v_lshl_add_u32 v2, v1, 5, v18
    v_xor_b32 v1, 1, v17
    v_lshl_add_u32 v3, v1, 5, v18
    v_xor_b32 v1, 2, v17
    v_lshl_add_u32 v4, v1, 5, v18
    v_xor_b32 v1, 3, v17
    v_lshl_add_u32 v5, v1, 5, v18
    s_lshr_b32 s44, s3, 1
    s_lshl_b32 s45, s44, 10
    v_lshl_add_u32 v14, v0, 4, s45
    s_lshl_b32 s44, s44, 12
    v_add_u32 v2, s44, v2
    v_add_u32 v6, 0x10000, v2
    v_add_u32 v10, 0x20000, v2
    v_add_u32 v3, s44, v3
    v_add_u32 v7, 0x10000, v3
    v_add_u32 v11, 0x20000, v3
    v_add_u32 v4, s44, v4
    v_add_u32 v8, 0x10000, v4
    v_add_u32 v12, 0x20000, v4
    v_add_u32 v5, s44, v5
    v_add_u32 v9, 0x10000, v5
    v_add_u32 v13, 0x20000, v5
    s_mul_i32 s44, s6, 6
    s_and_b32 s45, s3, 1
    s_mul_i32 s45, s45, 3
    s_add_u32 s44, s44, s45
    s_add_u32 s45, s44, 0
    s_min_u32 s45, s45, 127
    s_mul_i32 s45, s45, 55296
    s_add_u32 s48, s45, 0x800000
    s_add_u32 s45, s44, 1
    s_min_u32 s45, s45, 127
    s_mul_i32 s45, s45, 55296
    s_add_u32 s49, s45, 0x800000
    s_add_u32 s45, s44, 2
    s_min_u32 s45, s45, 127
    s_mul_i32 s45, s45, 55296
    s_add_u32 s50, s45, 0x800000
    s_barrier
    buffer_load_dwordx4 v[96:99], v14, s[28:31], s48 offen offset:0 sc1
    buffer_load_dwordx4 v[100:103], v14, s[28:31], s49 offen offset:0 sc1
    buffer_load_dwordx4 v[104:107], v14, s[28:31], s50 offen offset:0 sc1
    buffer_load_dwordx4 v[108:111], v14, s[28:31], s48 offen offset:2048 sc1
    s_add_u32 s48, s48, 4096
    buffer_load_dwordx4 v[112:115], v14, s[28:31], s49 offen offset:2048 sc1
    s_add_u32 s49, s49, 4096
    buffer_load_dwordx4 v[116:119], v14, s[28:31], s50 offen offset:2048 sc1
    s_add_u32 s50, s50, 4096
    buffer_load_dwordx4 v[120:123], v14, s[28:31], s48 offen offset:0 sc1
    buffer_load_dwordx4 v[124:127], v14, s[28:31], s49 offen offset:0 sc1
    buffer_load_dwordx4 v[128:131], v14, s[28:31], s50 offen offset:0 sc1
    buffer_load_dwordx4 v[132:135], v14, s[28:31], s48 offen offset:2048 sc1
    s_add_u32 s48, s48, 4096
    buffer_load_dwordx4 v[136:139], v14, s[28:31], s49 offen offset:2048 sc1
    s_add_u32 s49, s49, 4096
    buffer_load_dwordx4 v[140:143], v14, s[28:31], s50 offen offset:2048 sc1
    s_add_u32 s50, s50, 4096
    buffer_load_dwordx4 v[144:147], v14, s[28:31], s48 offen offset:0 sc1
    buffer_load_dwordx4 v[148:151], v14, s[28:31], s49 offen offset:0 sc1
    buffer_load_dwordx4 v[152:155], v14, s[28:31], s50 offen offset:0 sc1
    buffer_load_dwordx4 v[156:159], v14, s[28:31], s48 offen offset:2048 sc1
    s_add_u32 s48, s48, 4096
    buffer_load_dwordx4 v[160:163], v14, s[28:31], s49 offen offset:2048 sc1
    s_add_u32 s49, s49, 4096
    buffer_load_dwordx4 v[164:167], v14, s[28:31], s50 offen offset:2048 sc1
    s_add_u32 s50, s50, 4096
    ds_read_b64_tr_b16 v[64:65], v6 offset:16384
    ds_read_b64_tr_b16 v[66:67], v6 offset:16896
    ds_read_b64_tr_b16 v[68:69], v7 offset:16384
    ds_read_b64_tr_b16 v[70:71], v7 offset:16896
    ds_read_b64_tr_b16 v[72:73], v8 offset:16384
    ds_read_b64_tr_b16 v[74:75], v8 offset:16896
    ds_read_b64_tr_b16 v[76:77], v9 offset:16384
    ds_read_b64_tr_b16 v[78:79], v9 offset:16896
    s_waitcnt lgkmcnt(0)
    s_waitcnt vmcnt(15)
    v_mfma_f32_16x16x32_bf16 v[16:19], v[64:67], v[96:99], 0
    ds_read_b64_tr_b16 v[80:81], v6 offset:24576
    ds_read_b64_tr_b16 v[82:83], v6 offset:25088
    v_mfma_f32_16x16x32_bf16 v[32:35], v[64:67], v[100:103], 0
    ds_read_b64_tr_b16 v[84:85], v7 offset:24576
    ds_read_b64_tr_b16 v[86:87], v7 offset:25088
    v_mfma_f32_16x16x32_bf16 v[48:51], v[64:67], v[104:107], 0
    ds_read_b64_tr_b16 v[88:89], v8 offset:24576
    ds_read_b64_tr_b16 v[90:91], v8 offset:25088
    v_mfma_f32_16x16x32_bf16 v[52:55], v[68:71], v[104:107], 0
    ds_read_b64_tr_b16 v[92:93], v9 offset:24576
    ds_read_b64_tr_b16 v[94:95], v9 offset:25088
    v_mfma_f32_16x16x32_bf16 v[36:39], v[68:71], v[100:103], 0
    buffer_load_dwordx4 v[168:171], v14, s[28:31], s48 offen offset:0 sc1
    buffer_load_dwordx4 v[172:175], v14, s[28:31], s49 offen offset:0 sc1
    v_mfma_f32_16x16x32_bf16 v[20:23], v[68:71], v[96:99], 0
    buffer_load_dwordx4 v[176:179], v14, s[28:31], s50 offen offset:0 sc1
    v_mfma_f32_16x16x32_bf16 v[24:27], v[72:75], v[96:99], 0
    buffer_load_dwordx4 v[180:183], v14, s[28:31], s48 offen offset:2048 sc1
    v_mfma_f32_16x16x32_bf16 v[40:43], v[72:75], v[100:103], 0
    s_add_u32 s48, s48, 4096
    v_mfma_f32_16x16x32_bf16 v[56:59], v[72:75], v[104:107], 0
    buffer_load_dwordx4 v[184:187], v14, s[28:31], s49 offen offset:2048 sc1
    v_mfma_f32_16x16x32_bf16 v[60:63], v[76:79], v[104:107], 0
    s_add_u32 s49, s49, 4096
    v_mfma_f32_16x16x32_bf16 v[44:47], v[76:79], v[100:103], 0
    buffer_load_dwordx4 v[188:191], v14, s[28:31], s50 offen offset:2048 sc1
    v_mfma_f32_16x16x32_bf16 v[28:31], v[76:79], v[96:99], 0
    s_add_u32 s50, s50, 4096
    s_and_b32 s44, s2, 7
    s_lshl_b32 s44, s44, 5
    s_add_u32 s44, s44, s8
    s_lshl_b32 s44, s44, 2
    s_add_u32 s44, s44, 0x4000
    s_mov_b64 exec, 1
    v_mov_b32 v252, 162312
    v_mov_b32 v253, 1
    ds_add_rtn_u32 v253, v252, v253
    s_mov_b64 exec, 0xff
    v_mov_b32 v252, s11
    v_mul_u32_u24 v254, 1024, v0
    s_waitcnt lgkmcnt(0)
    v_readfirstlane_b32 s45, v253
    s_cmp_lg_u32 s45, 3
    s_cbranch_scc1 L_noflag_s3f
    buffer_store_dword v252, v254, s[28:31], s44 offen sc1
L_noflag_s3f:
    s_mov_b64 exec, -1
    s_waitcnt lgkmcnt(0)
    s_barrier
    s_waitcnt vmcnt(18)
    v_mfma_f32_16x16x32_bf16 v[16:19], v[80:83], v[108:111], v[16:19]
    ds_read_b64_tr_b16 v[64:65], v6 offset:32768
    v_mfma_f32_16x16x32_bf16 v[32:35], v[80:83], v[112:115], v[32:35]
    ds_read_b64_tr_b16 v[66:67], v6 offset:33280
    v_mfma_f32_16x16x32_bf16 v[48:51], v[80:83], v[116:119], v[48:51]
    buffer_load_dwordx4 v[96:99], v14, s[28:31], s48 offen offset:0 sc1
    v_mfma_f32_16x16x32_bf16 v[52:55], v[84:87], v[116:119], v[52:55]
    ds_read_b64_tr_b16 v[68:69], v7 offset:32768
    v_mfma_f32_16x16x32_bf16 v[36:39], v[84:87], v[112:115], v[36:39]
    ds_read_b64_tr_b16 v[70:71], v7 offset:33280
    v_mfma_f32_16x16x32_bf16 v[20:23], v[84:87], v[108:111], v[20:23]
    ds_read_b64_tr_b16 v[72:73], v8 offset:32768
    v_mfma_f32_16x16x32_bf16 v[24:27], v[88:91], v[108:111], v[24:27]
    buffer_load_dwordx4 v[100:103], v14, s[28:31], s49 offen offset:0 sc1
    v_mfma_f32_16x16x32_bf16 v[40:43], v[88:91], v[112:115], v[40:43]
    ds_read_b64_tr_b16 v[74:75], v8 offset:33280
    v_mfma_f32_16x16x32_bf16 v[56:59], v[88:91], v[116:119], v[56:59]
    ds_read_b64_tr_b16 v[76:77], v9 offset:32768
    ds_read_b64_tr_b16 v[78:79], v9 offset:33280
    v_mfma_f32_16x16x32_bf16 v[60:63], v[92:95], v[116:119], v[60:63]
    v_mfma_f32_16x16x32_bf16 v[44:47], v[92:95], v[112:115], v[44:47]
    buffer_load_dwordx4 v[104:107], v14, s[28:31], s50 offen offset:0 sc1
    v_mfma_f32_16x16x32_bf16 v[28:31], v[92:95], v[108:111], v[28:31]
    s_waitcnt lgkmcnt(0)
    s_waitcnt vmcnt(18)
    v_mfma_f32_16x16x32_bf16 v[16:19], v[64:67], v[120:123], v[16:19]
    ds_read_b64_tr_b16 v[80:81], v6 offset:40960
    v_mfma_f32_16x16x32_bf16 v[32:35], v[64:67], v[124:127], v[32:35]
    ds_read_b64_tr_b16 v[82:83], v6 offset:41472
    v_mfma_f32_16x16x32_bf16 v[48:51], v[64:67], v[128:131], v[48:51]
    buffer_load_dwordx4 v[108:111], v14, s[28:31], s48 offen offset:2048 sc1
    s_add_u32 s48, s48, 4096
    v_mfma_f32_16x16x32_bf16 v[52:55], v[68:71], v[128:131], v[52:55]
    ds_read_b64_tr_b16 v[84:85], v7 offset:40960
    v_mfma_f32_16x16x32_bf16 v[36:39], v[68:71], v[124:127], v[36:39]
    ds_read_b64_tr_b16 v[86:87], v7 offset:41472
    v_mfma_f32_16x16x32_bf16 v[20:23], v[68:71], v[120:123], v[20:23]
    ds_read_b64_tr_b16 v[88:89], v8 offset:40960
    v_mfma_f32_16x16x32_bf16 v[24:27], v[72:75], v[120:123], v[24:27]
    buffer_load_dwordx4 v[112:115], v14, s[28:31], s49 offen offset:2048 sc1
    s_add_u32 s49, s49, 4096
    v_mfma_f32_16x16x32_bf16 v[40:43], v[72:75], v[124:127], v[40:43]
    ds_read_b64_tr_b16 v[90:91], v8 offset:41472
    v_mfma_f32_16x16x32_bf16 v[56:59], v[72:75], v[128:131], v[56:59]
    ds_read_b64_tr_b16 v[92:93], v9 offset:40960
    ds_read_b64_tr_b16 v[94:95], v9 offset:41472
    v_mfma_f32_16x16x32_bf16 v[60:63], v[76:79], v[128:131], v[60:63]
    v_mfma_f32_16x16x32_bf16 v[44:47], v[76:79], v[124:127], v[44:47]
    buffer_load_dwordx4 v[116:119], v14, s[28:31], s50 offen offset:2048 sc1
    s_add_u32 s50, s50, 4096
    v_mfma_f32_16x16x32_bf16 v[28:31], v[76:79], v[120:123], v[28:31]
    s_waitcnt lgkmcnt(0)
    s_barrier
    s_waitcnt vmcnt(18)
    v_mfma_f32_16x16x32_bf16 v[16:19], v[80:83], v[132:135], v[16:19]
    ds_read_b64_tr_b16 v[64:65], v6 offset:49152
    v_mfma_f32_16x16x32_bf16 v[32:35], v[80:83], v[136:139], v[32:35]
    ds_read_b64_tr_b16 v[66:67], v6 offset:49664
    v_mfma_f32_16x16x32_bf16 v[48:51], v[80:83], v[140:143], v[48:51]
    buffer_load_dwordx4 v[120:123], v14, s[28:31], s48 offen offset:0 sc1
    v_mfma_f32_16x16x32_bf16 v[52:55], v[84:87], v[140:143], v[52:55]
    ds_read_b64_tr_b16 v[68:69], v7 offset:49152
    v_mfma_f32_16x16x32_bf16 v[36:39], v[84:87], v[136:139], v[36:39]
    ds_read_b64_tr_b16 v[70:71], v7 offset:49664
    v_mfma_f32_16x16x32_bf16 v[20:23], v[84:87], v[132:135], v[20:23]
    ds_read_b64_tr_b16 v[72:73], v8 offset:49152
    v_mfma_f32_16x16x32_bf16 v[24:27], v[88:91], v[132:135], v[24:27]
    buffer_load_dwordx4 v[124:127], v14, s[28:31], s49 offen offset:0 sc1
    v_mfma_f32_16x16x32_bf16 v[40:43], v[88:91], v[136:139], v[40:43]
    ds_read_b64_tr_b16 v[74:75], v8 offset:49664
    v_mfma_f32_16x16x32_bf16 v[56:59], v[88:91], v[140:143], v[56:59]
    ds_read_b64_tr_b16 v[76:77], v9 offset:49152
    ds_read_b64_tr_b16 v[78:79], v9 offset:49664
    v_mfma_f32_16x16x32_bf16 v[60:63], v[92:95], v[140:143], v[60:63]
    v_mfma_f32_16x16x32_bf16 v[44:47], v[92:95], v[136:139], v[44:47]
    buffer_load_dwordx4 v[128:131], v14, s[28:31], s50 offen offset:0 sc1
    v_mfma_f32_16x16x32_bf16 v[28:31], v[92:95], v[132:135], v[28:31]
    s_waitcnt lgkmcnt(0)
    s_waitcnt vmcnt(18)
    v_mfma_f32_16x16x32_bf16 v[16:19], v[64:67], v[144:147], v[16:19]
    ds_read_b64_tr_b16 v[80:81], v6 offset:57344
    v_mfma_f32_16x16x32_bf16 v[32:35], v[64:67], v[148:151], v[32:35]
    ds_read_b64_tr_b16 v[82:83], v6 offset:57856
    v_mfma_f32_16x16x32_bf16 v[48:51], v[64:67], v[152:155], v[48:51]
    buffer_load_dwordx4 v[132:135], v14, s[28:31], s48 offen offset:2048 sc1
    s_add_u32 s48, s48, 4096
    v_mfma_f32_16x16x32_bf16 v[52:55], v[68:71], v[152:155], v[52:55]
    ds_read_b64_tr_b16 v[84:85], v7 offset:57344
    v_mfma_f32_16x16x32_bf16 v[36:39], v[68:71], v[148:151], v[36:39]
    ds_read_b64_tr_b16 v[86:87], v7 offset:57856
    v_mfma_f32_16x16x32_bf16 v[20:23], v[68:71], v[144:147], v[20:23]
    ds_read_b64_tr_b16 v[88:89], v8 offset:57344
    v_mfma_f32_16x16x32_bf16 v[24:27], v[72:75], v[144:147], v[24:27]
    buffer_load_dwordx4 v[136:139], v14, s[28:31], s49 offen offset:2048 sc1
    s_add_u32 s49, s49, 4096
    v_mfma_f32_16x16x32_bf16 v[40:43], v[72:75], v[148:151], v[40:43]
    ds_read_b64_tr_b16 v[90:91], v8 offset:57856
    v_mfma_f32_16x16x32_bf16 v[56:59], v[72:75], v[152:155], v[56:59]
    ds_read_b64_tr_b16 v[92:93], v9 offset:57344
    ds_read_b64_tr_b16 v[94:95], v9 offset:57856
    v_mfma_f32_16x16x32_bf16 v[60:63], v[76:79], v[152:155], v[60:63]
    v_mfma_f32_16x16x32_bf16 v[44:47], v[76:79], v[148:151], v[44:47]
    buffer_load_dwordx4 v[140:143], v14, s[28:31], s50 offen offset:2048 sc1
    s_add_u32 s50, s50, 4096
    v_mfma_f32_16x16x32_bf16 v[28:31], v[76:79], v[144:147], v[28:31]
    s_waitcnt lgkmcnt(0)
    s_barrier
    s_waitcnt vmcnt(18)
    v_mfma_f32_16x16x32_bf16 v[16:19], v[80:83], v[156:159], v[16:19]
    ds_read_b64_tr_b16 v[64:65], v10 offset:0
    v_mfma_f32_16x16x32_bf16 v[32:35], v[80:83], v[160:163], v[32:35]
    ds_read_b64_tr_b16 v[66:67], v10 offset:512
    v_mfma_f32_16x16x32_bf16 v[48:51], v[80:83], v[164:167], v[48:51]
    buffer_load_dwordx4 v[144:147], v14, s[28:31], s48 offen offset:0 sc1
    v_mfma_f32_16x16x32_bf16 v[52:55], v[84:87], v[164:167], v[52:55]
    ds_read_b64_tr_b16 v[68:69], v11 offset:0
    v_mfma_f32_16x16x32_bf16 v[36:39], v[84:87], v[160:163], v[36:39]
    ds_read_b64_tr_b16 v[70:71], v11 offset:512
    v_mfma_f32_16x16x32_bf16 v[20:23], v[84:87], v[156:159], v[20:23]
    ds_read_b64_tr_b16 v[72:73], v12 offset:0
    v_mfma_f32_16x16x32_bf16 v[24:27], v[88:91], v[156:159], v[24:27]
    buffer_load_dwordx4 v[148:151], v14, s[28:31], s49 offen offset:0 sc1
    v_mfma_f32_16x16x32_bf16 v[40:43], v[88:91], v[160:163], v[40:43]
    ds_read_b64_tr_b16 v[74:75], v12 offset:512
    v_mfma_f32_16x16x32_bf16 v[56:59], v[88:91], v[164:167], v[56:59]
    ds_read_b64_tr_b16 v[76:77], v13 offset:0
    ds_read_b64_tr_b16 v[78:79], v13 offset:512
    v_mfma_f32_16x16x32_bf16 v[60:63], v[92:95], v[164:167], v[60:63]
    v_mfma_f32_16x16x32_bf16 v[44:47], v[92:95], v[160:163], v[44:47]
    buffer_load_dwordx4 v[152:155], v14, s[28:31], s50 offen offset:0 sc1
    v_mfma_f32_16x16x32_bf16 v[28:31], v[92:95], v[156:159], v[28:31]
    s_waitcnt lgkmcnt(0)
    s_waitcnt vmcnt(18)
    v_mfma_f32_16x16x32_bf16 v[16:19], v[64:67], v[168:171], v[16:19]
    ds_read_b64_tr_b16 v[80:81], v10 offset:8192
    v_mfma_f32_16x16x32_bf16 v[32:35], v[64:67], v[172:175], v[32:35]
    ds_read_b64_tr_b16 v[82:83], v10 offset:8704
    v_mfma_f32_16x16x32_bf16 v[48:51], v[64:67], v[176:179], v[48:51]
    buffer_load_dwordx4 v[156:159], v14, s[28:31], s48 offen offset:2048 sc1
    s_add_u32 s48, s48, 4096
    v_mfma_f32_16x16x32_bf16 v[52:55], v[68:71], v[176:179], v[52:55]
    ds_read_b64_tr_b16 v[84:85], v11 offset:8192
    v_mfma_f32_16x16x32_bf16 v[36:39], v[68:71], v[172:175], v[36:39]
    ds_read_b64_tr_b16 v[86:87], v11 offset:8704
    v_mfma_f32_16x16x32_bf16 v[20:23], v[68:71], v[168:171], v[20:23]
    ds_read_b64_tr_b16 v[88:89], v12 offset:8192
    v_mfma_f32_16x16x32_bf16 v[24:27], v[72:75], v[168:171], v[24:27]
    buffer_load_dwordx4 v[160:163], v14, s[28:31], s49 offen offset:2048 sc1
    s_add_u32 s49, s49, 4096
    v_mfma_f32_16x16x32_bf16 v[40:43], v[72:75], v[172:175], v[40:43]
    ds_read_b64_tr_b16 v[90:91], v12 offset:8704
    v_mfma_f32_16x16x32_bf16 v[56:59], v[72:75], v[176:179], v[56:59]
    ds_read_b64_tr_b16 v[92:93], v13 offset:8192
    ds_read_b64_tr_b16 v[94:95], v13 offset:8704
    v_mfma_f32_16x16x32_bf16 v[60:63], v[76:79], v[176:179], v[60:63]
    v_mfma_f32_16x16x32_bf16 v[44:47], v[76:79], v[172:175], v[44:47]
    buffer_load_dwordx4 v[164:167], v14, s[28:31], s50 offen offset:2048 sc1
    s_add_u32 s50, s50, 4096
    v_mfma_f32_16x16x32_bf16 v[28:31], v[76:79], v[168:171], v[28:31]
    s_waitcnt lgkmcnt(0)
    s_barrier
    s_waitcnt vmcnt(18)
    v_mfma_f32_16x16x32_bf16 v[16:19], v[80:83], v[180:183], v[16:19]
    ds_read_b64_tr_b16 v[64:65], v6 offset:0
    v_mfma_f32_16x16x32_bf16 v[32:35], v[80:83], v[184:187], v[32:35]
    ds_read_b64_tr_b16 v[66:67], v6 offset:512
    v_mfma_f32_16x16x32_bf16 v[48:51], v[80:83], v[188:191], v[48:51]
    buffer_load_dwordx4 v[168:171], v14, s[28:31], s48 offen offset:0 sc1
    v_mfma_f32_16x16x32_bf16 v[52:55], v[84:87], v[188:191], v[52:55]
    ds_read_b64_tr_b16 v[68:69], v7 offset:0
    v_mfma_f32_16x16x32_bf16 v[36:39], v[84:87], v[184:187], v[36:39]
    ds_read_b64_tr_b16 v[70:71], v7 offset:512
    v_mfma_f32_16x16x32_bf16 v[20:23], v[84:87], v[180:183], v[20:23]
    ds_read_b64_tr_b16 v[72:73], v8 offset:0
    v_mfma_f32_16x16x32_bf16 v[24:27], v[88:91], v[180:183], v[24:27]
    buffer_load_dwordx4 v[172:175], v14, s[28:31], s49 offen offset:0 sc1
    v_mfma_f32_16x16x32_bf16 v[40:43], v[88:91], v[184:187], v[40:43]
    ds_read_b64_tr_b16 v[74:75], v8 offset:512
    v_mfma_f32_16x16x32_bf16 v[56:59], v[88:91], v[188:191], v[56:59]
    ds_read_b64_tr_b16 v[76:77], v9 offset:0
    ds_read_b64_tr_b16 v[78:79], v9 offset:512
    v_mfma_f32_16x16x32_bf16 v[60:63], v[92:95], v[188:191], v[60:63]
    v_mfma_f32_16x16x32_bf16 v[44:47], v[92:95], v[184:187], v[44:47]
    buffer_load_dwordx4 v[176:179], v14, s[28:31], s50 offen offset:0 sc1
    v_mfma_f32_16x16x32_bf16 v[28:31], v[92:95], v[180:183], v[28:31]
    s_waitcnt lgkmcnt(0)
    s_waitcnt vmcnt(18)
    v_mfma_f32_16x16x32_bf16 v[16:19], v[64:67], v[96:99], v[16:19]
    ds_read_b64_tr_b16 v[80:81], v6 offset:8192
    v_mfma_f32_16x16x32_bf16 v[32:35], v[64:67], v[100:103], v[32:35]
    ds_read_b64_tr_b16 v[82:83], v6 offset:8704
    v_mfma_f32_16x16x32_bf16 v[48:51], v[64:67], v[104:107], v[48:51]
    buffer_load_dwordx4 v[180:183], v14, s[28:31], s48 offen offset:2048 sc1
    s_add_u32 s48, s48, 4096
    v_mfma_f32_16x16x32_bf16 v[52:55], v[68:71], v[104:107], v[52:55]
    ds_read_b64_tr_b16 v[84:85], v7 offset:8192
    v_mfma_f32_16x16x32_bf16 v[36:39], v[68:71], v[100:103], v[36:39]
    ds_read_b64_tr_b16 v[86:87], v7 offset:8704
    v_mfma_f32_16x16x32_bf16 v[20:23], v[68:71], v[96:99], v[20:23]
    ds_read_b64_tr_b16 v[88:89], v8 offset:8192
    v_mfma_f32_16x16x32_bf16 v[24:27], v[72:75], v[96:99], v[24:27]
    buffer_load_dwordx4 v[184:187], v14, s[28:31], s49 offen offset:2048 sc1
    s_add_u32 s49, s49, 4096
    v_mfma_f32_16x16x32_bf16 v[40:43], v[72:75], v[100:103], v[40:43]
    ds_read_b64_tr_b16 v[90:91], v8 offset:8704
    v_mfma_f32_16x16x32_bf16 v[56:59], v[72:75], v[104:107], v[56:59]
    ds_read_b64_tr_b16 v[92:93], v9 offset:8192
    ds_read_b64_tr_b16 v[94:95], v9 offset:8704
    v_mfma_f32_16x16x32_bf16 v[60:63], v[76:79], v[104:107], v[60:63]
    v_mfma_f32_16x16x32_bf16 v[44:47], v[76:79], v[100:103], v[44:47]
    buffer_load_dwordx4 v[188:191], v14, s[28:31], s50 offen offset:2048 sc1
    s_add_u32 s50, s50, 4096
    v_mfma_f32_16x16x32_bf16 v[28:31], v[76:79], v[96:99], v[28:31]
    s_waitcnt lgkmcnt(0)
    s_barrier
    s_waitcnt vmcnt(18)
    v_mfma_f32_16x16x32_bf16 v[16:19], v[80:83], v[108:111], v[16:19]
    ds_read_b64_tr_b16 v[64:65], v2 offset:0
    v_mfma_f32_16x16x32_bf16 v[32:35], v[80:83], v[112:115], v[32:35]
    ds_read_b64_tr_b16 v[66:67], v2 offset:512
    v_mfma_f32_16x16x32_bf16 v[48:51], v[80:83], v[116:119], v[48:51]
    buffer_load_dwordx4 v[96:99], v14, s[28:31], s48 offen offset:0 sc1
    v_mfma_f32_16x16x32_bf16 v[52:55], v[84:87], v[116:119], v[52:55]
    ds_read_b64_tr_b16 v[68:69], v3 offset:0
    v_mfma_f32_16x16x32_bf16 v[36:39], v[84:87], v[112:115], v[36:39]
    ds_read_b64_tr_b16 v[70:71], v3 offset:512
    v_mfma_f32_16x16x32_bf16 v[20:23], v[84:87], v[108:111], v[20:23]
    ds_read_b64_tr_b16 v[72:73], v4 offset:0
    v_mfma_f32_16x16x32_bf16 v[24:27], v[88:91], v[108:111], v[24:27]
    buffer_load_dwordx4 v[100:103], v14, s[28:31], s49 offen offset:0 sc1
    v_mfma_f32_16x16x32_bf16 v[40:43], v[88:91], v[112:115], v[40:43]
    ds_read_b64_tr_b16 v[74:75], v4 offset:512
    v_mfma_f32_16x16x32_bf16 v[56:59], v[88:91], v[116:119], v[56:59]
    ds_read_b64_tr_b16 v[76:77], v5 offset:0
    ds_read_b64_tr_b16 v[78:79], v5 offset:512
    v_mfma_f32_16x16x32_bf16 v[60:63], v[92:95], v[116:119], v[60:63]
    v_mfma_f32_16x16x32_bf16 v[44:47], v[92:95], v[112:115], v[44:47]
    buffer_load_dwordx4 v[104:107], v14, s[28:31], s50 offen offset:0 sc1
    v_mfma_f32_16x16x32_bf16 v[28:31], v[92:95], v[108:111], v[28:31]
    s_waitcnt lgkmcnt(0)
    s_waitcnt vmcnt(18)
    v_mfma_f32_16x16x32_bf16 v[16:19], v[64:67], v[120:123], v[16:19]
    ds_read_b64_tr_b16 v[80:81], v2 offset:8192
    v_mfma_f32_16x16x32_bf16 v[32:35], v[64:67], v[124:127], v[32:35]
    ds_read_b64_tr_b16 v[82:83], v2 offset:8704
    v_mfma_f32_16x16x32_bf16 v[48:51], v[64:67], v[128:131], v[48:51]
    buffer_load_dwordx4 v[108:111], v14, s[28:31], s48 offen offset:2048 sc1
    s_add_u32 s48, s48, 4096
    v_mfma_f32_16x16x32_bf16 v[52:55], v[68:71], v[128:131], v[52:55]
    ds_read_b64_tr_b16 v[84:85], v3 offset:8192
    v_mfma_f32_16x16x32_bf16 v[36:39], v[68:71], v[124:127], v[36:39]
    ds_read_b64_tr_b16 v[86:87], v3 offset:8704
    v_mfma_f32_16x16x32_bf16 v[20:23], v[68:71], v[120:123], v[20:23]
    ds_read_b64_tr_b16 v[88:89], v4 offset:8192
    v_mfma_f32_16x16x32_bf16 v[24:27], v[72:75], v[120:123], v[24:27]
    buffer_load_dwordx4 v[112:115], v14, s[28:31], s49 offen offset:2048 sc1
    s_add_u32 s49, s49, 4096
    v_mfma_f32_16x16x32_bf16 v[40:43], v[72:75], v[124:127], v[40:43]
    ds_read_b64_tr_b16 v[90:91], v4 offset:8704
    v_mfma_f32_16x16x32_bf16 v[56:59], v[72:75], v[128:131], v[56:59]
    ds_read_b64_tr_b16 v[92:93], v5 offset:8192
    ds_read_b64_tr_b16 v[94:95], v5 offset:8704
    v_mfma_f32_16x16x32_bf16 v[60:63], v[76:79], v[128:131], v[60:63]
    v_mfma_f32_16x16x32_bf16 v[44:47], v[76:79], v[124:127], v[44:47]
    buffer_load_dwordx4 v[116:119], v14, s[28:31], s50 offen offset:2048 sc1
    s_add_u32 s50, s50, 4096
    v_mfma_f32_16x16x32_bf16 v[28:31], v[76:79], v[120:123], v[28:31]
    s_waitcnt lgkmcnt(0)
    s_barrier
    s_waitcnt vmcnt(18)
    v_mfma_f32_16x16x32_bf16 v[16:19], v[80:83], v[132:135], v[16:19]
    ds_read_b64_tr_b16 v[64:65], v2 offset:16384
    v_mfma_f32_16x16x32_bf16 v[32:35], v[80:83], v[136:139], v[32:35]
    ds_read_b64_tr_b16 v[66:67], v2 offset:16896
    v_mfma_f32_16x16x32_bf16 v[48:51], v[80:83], v[140:143], v[48:51]
    buffer_load_dwordx4 v[120:123], v14, s[28:31], s48 offen offset:0 sc1
    v_mfma_f32_16x16x32_bf16 v[52:55], v[84:87], v[140:143], v[52:55]
    ds_read_b64_tr_b16 v[68:69], v3 offset:16384
    v_mfma_f32_16x16x32_bf16 v[36:39], v[84:87], v[136:139], v[36:39]
    ds_read_b64_tr_b16 v[70:71], v3 offset:16896
    v_mfma_f32_16x16x32_bf16 v[20:23], v[84:87], v[132:135], v[20:23]
    ds_read_b64_tr_b16 v[72:73], v4 offset:16384
    v_mfma_f32_16x16x32_bf16 v[24:27], v[88:91], v[132:135], v[24:27]
    buffer_load_dwordx4 v[124:127], v14, s[28:31], s49 offen offset:0 sc1
    v_mfma_f32_16x16x32_bf16 v[40:43], v[88:91], v[136:139], v[40:43]
    ds_read_b64_tr_b16 v[74:75], v4 offset:16896
    v_mfma_f32_16x16x32_bf16 v[56:59], v[88:91], v[140:143], v[56:59]
    ds_read_b64_tr_b16 v[76:77], v5 offset:16384
    ds_read_b64_tr_b16 v[78:79], v5 offset:16896
    v_mfma_f32_16x16x32_bf16 v[60:63], v[92:95], v[140:143], v[60:63]
    v_mfma_f32_16x16x32_bf16 v[44:47], v[92:95], v[136:139], v[44:47]
    buffer_load_dwordx4 v[128:131], v14, s[28:31], s50 offen offset:0 sc1
    v_mfma_f32_16x16x32_bf16 v[28:31], v[92:95], v[132:135], v[28:31]
    s_waitcnt lgkmcnt(0)
    s_waitcnt vmcnt(18)
    v_mfma_f32_16x16x32_bf16 v[16:19], v[64:67], v[144:147], v[16:19]
    ds_read_b64_tr_b16 v[80:81], v2 offset:24576
    v_mfma_f32_16x16x32_bf16 v[32:35], v[64:67], v[148:151], v[32:35]
    ds_read_b64_tr_b16 v[82:83], v2 offset:25088
    v_mfma_f32_16x16x32_bf16 v[48:51], v[64:67], v[152:155], v[48:51]
    buffer_load_dwordx4 v[132:135], v14, s[28:31], s48 offen offset:2048 sc1
    s_add_u32 s48, s48, 4096
    v_mfma_f32_16x16x32_bf16 v[52:55], v[68:71], v[152:155], v[52:55]
    ds_read_b64_tr_b16 v[84:85], v3 offset:24576
    v_mfma_f32_16x16x32_bf16 v[36:39], v[68:71], v[148:151], v[36:39]
    ds_read_b64_tr_b16 v[86:87], v3 offset:25088
    v_mfma_f32_16x16x32_bf16 v[20:23], v[68:71], v[144:147], v[20:23]
    ds_read_b64_tr_b16 v[88:89], v4 offset:24576
    v_mfma_f32_16x16x32_bf16 v[24:27], v[72:75], v[144:147], v[24:27]
    buffer_load_dwordx4 v[136:139], v14, s[28:31], s49 offen offset:2048 sc1
    s_add_u32 s49, s49, 4096
    v_mfma_f32_16x16x32_bf16 v[40:43], v[72:75], v[148:151], v[40:43]
    ds_read_b64_tr_b16 v[90:91], v4 offset:25088
    v_mfma_f32_16x16x32_bf16 v[56:59], v[72:75], v[152:155], v[56:59]
    ds_read_b64_tr_b16 v[92:93], v5 offset:24576
    ds_read_b64_tr_b16 v[94:95], v5 offset:25088
    v_mfma_f32_16x16x32_bf16 v[60:63], v[76:79], v[152:155], v[60:63]
    v_mfma_f32_16x16x32_bf16 v[44:47], v[76:79], v[148:151], v[44:47]
    buffer_load_dwordx4 v[140:143], v14, s[28:31], s50 offen offset:2048 sc1
    s_add_u32 s50, s50, 4096
    v_mfma_f32_16x16x32_bf16 v[28:31], v[76:79], v[144:147], v[28:31]
    s_waitcnt lgkmcnt(0)
    s_barrier
    s_waitcnt vmcnt(18)
    v_mfma_f32_16x16x32_bf16 v[16:19], v[80:83], v[156:159], v[16:19]
    ds_read_b64_tr_b16 v[64:65], v2 offset:32768
    v_mfma_f32_16x16x32_bf16 v[32:35], v[80:83], v[160:163], v[32:35]
    ds_read_b64_tr_b16 v[66:67], v2 offset:33280
    v_mfma_f32_16x16x32_bf16 v[48:51], v[80:83], v[164:167], v[48:51]
    buffer_load_dwordx4 v[144:147], v14, s[28:31], s48 offen offset:0 sc1
    v_mfma_f32_16x16x32_bf16 v[52:55], v[84:87], v[164:167], v[52:55]
    ds_read_b64_tr_b16 v[68:69], v3 offset:32768
    v_mfma_f32_16x16x32_bf16 v[36:39], v[84:87], v[160:163], v[36:39]
    ds_read_b64_tr_b16 v[70:71], v3 offset:33280
    v_mfma_f32_16x16x32_bf16 v[20:23], v[84:87], v[156:159], v[20:23]
    ds_read_b64_tr_b16 v[72:73], v4 offset:32768
    v_mfma_f32_16x16x32_bf16 v[24:27], v[88:91], v[156:159], v[24:27]
    buffer_load_dwordx4 v[148:151], v14, s[28:31], s49 offen offset:0 sc1
    v_mfma_f32_16x16x32_bf16 v[40:43], v[88:91], v[160:163], v[40:43]
    ds_read_b64_tr_b16 v[74:75], v4 offset:33280
    v_mfma_f32_16x16x32_bf16 v[56:59], v[88:91], v[164:167], v[56:59]
    ds_read_b64_tr_b16 v[76:77], v5 offset:32768
    ds_read_b64_tr_b16 v[78:79], v5 offset:33280
    v_mfma_f32_16x16x32_bf16 v[60:63], v[92:95], v[164:167], v[60:63]
    v_mfma_f32_16x16x32_bf16 v[44:47], v[92:95], v[160:163], v[44:47]
    buffer_load_dwordx4 v[152:155], v14, s[28:31], s50 offen offset:0 sc1
    v_mfma_f32_16x16x32_bf16 v[28:31], v[92:95], v[156:159], v[28:31]
    s_waitcnt lgkmcnt(0)
    s_waitcnt vmcnt(18)
    v_mfma_f32_16x16x32_bf16 v[16:19], v[64:67], v[168:171], v[16:19]
    ds_read_b64_tr_b16 v[80:81], v2 offset:40960
    v_mfma_f32_16x16x32_bf16 v[32:35], v[64:67], v[172:175], v[32:35]
    ds_read_b64_tr_b16 v[82:83], v2 offset:41472
    v_mfma_f32_16x16x32_bf16 v[48:51], v[64:67], v[176:179], v[48:51]
    buffer_load_dwordx4 v[156:159], v14, s[28:31], s48 offen offset:2048 sc1
    s_add_u32 s48, s48, 4096
    v_mfma_f32_16x16x32_bf16 v[52:55], v[68:71], v[176:179], v[52:55]
    ds_read_b64_tr_b16 v[84:85], v3 offset:40960
    v_mfma_f32_16x16x32_bf16 v[36:39], v[68:71], v[172:175], v[36:39]
    ds_read_b64_tr_b16 v[86:87], v3 offset:41472
    v_mfma_f32_16x16x32_bf16 v[20:23], v[68:71], v[168:171], v[20:23]
    ds_read_b64_tr_b16 v[88:89], v4 offset:40960
    v_mfma_f32_16x16x32_bf16 v[24:27], v[72:75], v[168:171], v[24:27]
    buffer_load_dwordx4 v[160:163], v14, s[28:31], s49 offen offset:2048 sc1
    s_add_u32 s49, s49, 4096
    v_mfma_f32_16x16x32_bf16 v[40:43], v[72:75], v[172:175], v[40:43]
    ds_read_b64_tr_b16 v[90:91], v4 offset:41472
    v_mfma_f32_16x16x32_bf16 v[56:59], v[72:75], v[176:179], v[56:59]
    ds_read_b64_tr_b16 v[92:93], v5 offset:40960
    ds_read_b64_tr_b16 v[94:95], v5 offset:41472
    v_mfma_f32_16x16x32_bf16 v[60:63], v[76:79], v[176:179], v[60:63]
    v_mfma_f32_16x16x32_bf16 v[44:47], v[76:79], v[172:175], v[44:47]
    buffer_load_dwordx4 v[164:167], v14, s[28:31], s50 offen offset:2048 sc1
    s_add_u32 s50, s50, 4096
    v_mfma_f32_16x16x32_bf16 v[28:31], v[76:79], v[168:171], v[28:31]
    s_waitcnt lgkmcnt(0)
    s_barrier
    s_waitcnt vmcnt(18)
    v_mfma_f32_16x16x32_bf16 v[16:19], v[80:83], v[180:183], v[16:19]
    ds_read_b64_tr_b16 v[64:65], v2 offset:49152
    v_mfma_f32_16x16x32_bf16 v[32:35], v[80:83], v[184:187], v[32:35]
    ds_read_b64_tr_b16 v[66:67], v2 offset:49664
    v_mfma_f32_16x16x32_bf16 v[48:51], v[80:83], v[188:191], v[48:51]
    buffer_load_dwordx4 v[168:171], v14, s[28:31], s48 offen offset:0 sc1
    v_mfma_f32_16x16x32_bf16 v[52:55], v[84:87], v[188:191], v[52:55]
    ds_read_b64_tr_b16 v[68:69], v3 offset:49152
    v_mfma_f32_16x16x32_bf16 v[36:39], v[84:87], v[184:187], v[36:39]
    ds_read_b64_tr_b16 v[70:71], v3 offset:49664
    v_mfma_f32_16x16x32_bf16 v[20:23], v[84:87], v[180:183], v[20:23]
    ds_read_b64_tr_b16 v[72:73], v4 offset:49152
    v_mfma_f32_16x16x32_bf16 v[24:27], v[88:91], v[180:183], v[24:27]
    buffer_load_dwordx4 v[172:175], v14, s[28:31], s49 offen offset:0 sc1
    v_mfma_f32_16x16x32_bf16 v[40:43], v[88:91], v[184:187], v[40:43]
    ds_read_b64_tr_b16 v[74:75], v4 offset:49664
    v_mfma_f32_16x16x32_bf16 v[56:59], v[88:91], v[188:191], v[56:59]
    ds_read_b64_tr_b16 v[76:77], v5 offset:49152
    ds_read_b64_tr_b16 v[78:79], v5 offset:49664
    v_mfma_f32_16x16x32_bf16 v[60:63], v[92:95], v[188:191], v[60:63]
    v_mfma_f32_16x16x32_bf16 v[44:47], v[92:95], v[184:187], v[44:47]
    buffer_load_dwordx4 v[176:179], v14, s[28:31], s50 offen offset:0 sc1
    v_mfma_f32_16x16x32_bf16 v[28:31], v[92:95], v[180:183], v[28:31]
    s_waitcnt lgkmcnt(0)
    s_waitcnt vmcnt(18)
    v_mfma_f32_16x16x32_bf16 v[16:19], v[64:67], v[96:99], v[16:19]
    ds_read_b64_tr_b16 v[80:81], v2 offset:57344
    v_mfma_f32_16x16x32_bf16 v[32:35], v[64:67], v[100:103], v[32:35]
    ds_read_b64_tr_b16 v[82:83], v2 offset:57856
    v_mfma_f32_16x16x32_bf16 v[48:51], v[64:67], v[104:107], v[48:51]
    buffer_load_dwordx4 v[180:183], v14, s[28:31], s48 offen offset:2048 sc1
    s_add_u32 s48, s48, 4096
    v_mfma_f32_16x16x32_bf16 v[52:55], v[68:71], v[104:107], v[52:55]
    ds_read_b64_tr_b16 v[84:85], v3 offset:57344
    v_mfma_f32_16x16x32_bf16 v[36:39], v[68:71], v[100:103], v[36:39]
    ds_read_b64_tr_b16 v[86:87], v3 offset:57856
    v_mfma_f32_16x16x32_bf16 v[20:23], v[68:71], v[96:99], v[20:23]
    ds_read_b64_tr_b16 v[88:89], v4 offset:57344
    v_mfma_f32_16x16x32_bf16 v[24:27], v[72:75], v[96:99], v[24:27]
    buffer_load_dwordx4 v[184:187], v14, s[28:31], s49 offen offset:2048 sc1
    s_add_u32 s49, s49, 4096
    v_mfma_f32_16x16x32_bf16 v[40:43], v[72:75], v[100:103], v[40:43]
    ds_read_b64_tr_b16 v[90:91], v4 offset:57856
    v_mfma_f32_16x16x32_bf16 v[56:59], v[72:75], v[104:107], v[56:59]
    ds_read_b64_tr_b16 v[92:93], v5 offset:57344
    ds_read_b64_tr_b16 v[94:95], v5 offset:57856
    v_mfma_f32_16x16x32_bf16 v[60:63], v[76:79], v[104:107], v[60:63]
    v_mfma_f32_16x16x32_bf16 v[44:47], v[76:79], v[100:103], v[44:47]
    buffer_load_dwordx4 v[188:191], v14, s[28:31], s50 offen offset:2048 sc1
    s_add_u32 s50, s50, 4096
    v_mfma_f32_16x16x32_bf16 v[28:31], v[76:79], v[96:99], v[28:31]
    s_waitcnt lgkmcnt(0)
    s_barrier
    s_waitcnt vmcnt(18)
    v_mfma_f32_16x16x32_bf16 v[16:19], v[80:83], v[108:111], v[16:19]
    ds_read_b64_tr_b16 v[64:65], v6 offset:16384
    v_mfma_f32_16x16x32_bf16 v[32:35], v[80:83], v[112:115], v[32:35]
    ds_read_b64_tr_b16 v[66:67], v6 offset:16896
    v_mfma_f32_16x16x32_bf16 v[48:51], v[80:83], v[116:119], v[48:51]
    buffer_load_dwordx4 v[96:99], v14, s[28:31], s48 offen offset:0 sc1
    v_mfma_f32_16x16x32_bf16 v[52:55], v[84:87], v[116:119], v[52:55]
    ds_read_b64_tr_b16 v[68:69], v7 offset:16384
    v_mfma_f32_16x16x32_bf16 v[36:39], v[84:87], v[112:115], v[36:39]
    ds_read_b64_tr_b16 v[70:71], v7 offset:16896
    v_mfma_f32_16x16x32_bf16 v[20:23], v[84:87], v[108:111], v[20:23]
    ds_read_b64_tr_b16 v[72:73], v8 offset:16384
    v_mfma_f32_16x16x32_bf16 v[24:27], v[88:91], v[108:111], v[24:27]
    buffer_load_dwordx4 v[100:103], v14, s[28:31], s49 offen offset:0 sc1
    v_mfma_f32_16x16x32_bf16 v[40:43], v[88:91], v[112:115], v[40:43]
    ds_read_b64_tr_b16 v[74:75], v8 offset:16896
    v_mfma_f32_16x16x32_bf16 v[56:59], v[88:91], v[116:119], v[56:59]
    ds_read_b64_tr_b16 v[76:77], v9 offset:16384
    ds_read_b64_tr_b16 v[78:79], v9 offset:16896
    v_mfma_f32_16x16x32_bf16 v[60:63], v[92:95], v[116:119], v[60:63]
    v_mfma_f32_16x16x32_bf16 v[44:47], v[92:95], v[112:115], v[44:47]
    buffer_load_dwordx4 v[104:107], v14, s[28:31], s50 offen offset:0 sc1
    v_mfma_f32_16x16x32_bf16 v[28:31], v[92:95], v[108:111], v[28:31]
    s_waitcnt lgkmcnt(0)
    s_waitcnt vmcnt(18)
    v_mfma_f32_16x16x32_bf16 v[16:19], v[64:67], v[120:123], v[16:19]
    ds_read_b64_tr_b16 v[80:81], v6 offset:24576
    v_mfma_f32_16x16x32_bf16 v[32:35], v[64:67], v[124:127], v[32:35]
    ds_read_b64_tr_b16 v[82:83], v6 offset:25088
    v_mfma_f32_16x16x32_bf16 v[48:51], v[64:67], v[128:131], v[48:51]
    buffer_load_dwordx4 v[108:111], v14, s[28:31], s48 offen offset:2048 sc1
    s_add_u32 s48, s48, 4096
    v_mfma_f32_16x16x32_bf16 v[52:55], v[68:71], v[128:131], v[52:55]
    ds_read_b64_tr_b16 v[84:85], v7 offset:24576
    v_mfma_f32_16x16x32_bf16 v[36:39], v[68:71], v[124:127], v[36:39]
    ds_read_b64_tr_b16 v[86:87], v7 offset:25088
    v_mfma_f32_16x16x32_bf16 v[20:23], v[68:71], v[120:123], v[20:23]
    ds_read_b64_tr_b16 v[88:89], v8 offset:24576
    v_mfma_f32_16x16x32_bf16 v[24:27], v[72:75], v[120:123], v[24:27]
    buffer_load_dwordx4 v[112:115], v14, s[28:31], s49 offen offset:2048 sc1
    s_add_u32 s49, s49, 4096
    v_mfma_f32_16x16x32_bf16 v[40:43], v[72:75], v[124:127], v[40:43]
    ds_read_b64_tr_b16 v[90:91], v8 offset:25088
    v_mfma_f32_16x16x32_bf16 v[56:59], v[72:75], v[128:131], v[56:59]
    ds_read_b64_tr_b16 v[92:93], v9 offset:24576
    ds_read_b64_tr_b16 v[94:95], v9 offset:25088
    v_mfma_f32_16x16x32_bf16 v[60:63], v[76:79], v[128:131], v[60:63]
    v_mfma_f32_16x16x32_bf16 v[44:47], v[76:79], v[124:127], v[44:47]
    buffer_load_dwordx4 v[116:119], v14, s[28:31], s50 offen offset:2048 sc1
    s_add_u32 s50, s50, 4096
    v_mfma_f32_16x16x32_bf16 v[28:31], v[76:79], v[120:123], v[28:31]
    s_waitcnt lgkmcnt(0)
    s_barrier
    s_waitcnt vmcnt(18)
    v_mfma_f32_16x16x32_bf16 v[16:19], v[80:83], v[132:135], v[16:19]
    ds_read_b64_tr_b16 v[64:65], v6 offset:32768
    v_mfma_f32_16x16x32_bf16 v[32:35], v[80:83], v[136:139], v[32:35]
    ds_read_b64_tr_b16 v[66:67], v6 offset:33280
    v_mfma_f32_16x16x32_bf16 v[48:51], v[80:83], v[140:143], v[48:51]
    buffer_load_dwordx4 v[120:123], v14, s[28:31], s48 offen offset:0 sc1
    v_mfma_f32_16x16x32_bf16 v[52:55], v[84:87], v[140:143], v[52:55]
    ds_read_b64_tr_b16 v[68:69], v7 offset:32768
    v_mfma_f32_16x16x32_bf16 v[36:39], v[84:87], v[136:139], v[36:39]
    ds_read_b64_tr_b16 v[70:71], v7 offset:33280
    v_mfma_f32_16x16x32_bf16 v[20:23], v[84:87], v[132:135], v[20:23]
    ds_read_b64_tr_b16 v[72:73], v8 offset:32768
    v_mfma_f32_16x16x32_bf16 v[24:27], v[88:91], v[132:135], v[24:27]
    buffer_load_dwordx4 v[124:127], v14, s[28:31], s49 offen offset:0 sc1
    v_mfma_f32_16x16x32_bf16 v[40:43], v[88:91], v[136:139], v[40:43]
    ds_read_b64_tr_b16 v[74:75], v8 offset:33280
    v_mfma_f32_16x16x32_bf16 v[56:59], v[88:91], v[140:143], v[56:59]
    ds_read_b64_tr_b16 v[76:77], v9 offset:32768
    ds_read_b64_tr_b16 v[78:79], v9 offset:33280
    v_mfma_f32_16x16x32_bf16 v[60:63], v[92:95], v[140:143], v[60:63]
    v_mfma_f32_16x16x32_bf16 v[44:47], v[92:95], v[136:139], v[44:47]
    buffer_load_dwordx4 v[128:131], v14, s[28:31], s50 offen offset:0 sc1
    v_mfma_f32_16x16x32_bf16 v[28:31], v[92:95], v[132:135], v[28:31]
    s_waitcnt lgkmcnt(0)
    s_waitcnt vmcnt(18)
    v_mfma_f32_16x16x32_bf16 v[16:19], v[64:67], v[144:147], v[16:19]
    ds_read_b64_tr_b16 v[80:81], v6 offset:40960
    ds_read_b64_tr_b16 v[82:83], v6 offset:41472
    v_mfma_f32_16x16x32_bf16 v[32:35], v[64:67], v[148:151], v[32:35]
    ds_read_b64_tr_b16 v[84:85], v7 offset:40960
    ds_read_b64_tr_b16 v[86:87], v7 offset:41472
    v_mfma_f32_16x16x32_bf16 v[48:51], v[64:67], v[152:155], v[48:51]
    ds_read_b64_tr_b16 v[88:89], v8 offset:40960
    ds_read_b64_tr_b16 v[90:91], v8 offset:41472
    v_mfma_f32_16x16x32_bf16 v[52:55], v[68:71], v[152:155], v[52:55]
    ds_read_b64_tr_b16 v[92:93], v9 offset:40960
    ds_read_b64_tr_b16 v[94:95], v9 offset:41472
    v_mfma_f32_16x16x32_bf16 v[36:39], v[68:71], v[148:151], v[36:39]
    s_mul_i32 s44, s3, 6144
    v_lshl_add_u32 v230, v0, 4, s44
    v_mfma_f32_16x16x32_bf16 v[20:23], v[68:71], v[144:147], v[20:23]
    v_add_u32 v228, 0, v230
    v_add_u32 v230, 36864, v230
    v_mfma_f32_16x16x32_bf16 v[24:27], v[72:75], v[144:147], v[24:27]
    s_xor_b32 s45, s3, 2
    s_mul_i32 s45, s45, 6144
    v_mfma_f32_16x16x32_bf16 v[40:43], v[72:75], v[148:151], v[40:43]
    s_add_u32 s45, s45, 0
    v_lshl_add_u32 v229, v0, 4, s45
    v_mfma_f32_16x16x32_bf16 v[56:59], v[72:75], v[152:155], v[56:59]
    v_and_b32 v233, 15, v0
    s_and_b32 s44, s3, 1
    v_mfma_f32_16x16x32_bf16 v[60:63], v[76:79], v[152:155], v[60:63]
    s_mul_i32 s44, s44, 48
    v_add_u32 v233, s44, v233
    v_mfma_f32_16x16x32_bf16 v[44:47], v[76:79], v[148:151], v[44:47]
    v_lshlrev_b32 v231, 3, v233
    v_mfma_f32_16x16x32_bf16 v[28:31], v[76:79], v[144:147], v[28:31]
    v_add_u32 v231, 159748, v231
    s_waitcnt lgkmcnt(0)
    s_barrier
    s_waitcnt vmcnt(15)
    v_mfma_f32_16x16x32_bf16 v[16:19], v[80:83], v[156:159], v[16:19]
    ds_read_b64_tr_b16 v[64:65], v6 offset:49152
    ds_read_b64_tr_b16 v[66:67], v6 offset:49664
    v_mfma_f32_16x16x32_bf16 v[32:35], v[80:83], v[160:163], v[32:35]
    ds_read_b64_tr_b16 v[68:69], v7 offset:49152
    ds_read_b64_tr_b16 v[70:71], v7 offset:49664
    v_mfma_f32_16x16x32_bf16 v[48:51], v[80:83], v[164:167], v[48:51]
    ds_read_b64_tr_b16 v[72:73], v8 offset:49152
    ds_read_b64_tr_b16 v[74:75], v8 offset:49664
    v_mfma_f32_16x16x32_bf16 v[52:55], v[84:87], v[164:167], v[52:55]
    ds_read_b64_tr_b16 v[76:77], v9 offset:49152
    ds_read_b64_tr_b16 v[78:79], v9 offset:49664
    v_mfma_f32_16x16x32_bf16 v[36:39], v[84:87], v[160:163], v[36:39]
    s_mul_i32 s44, s6, 96
    v_add_u32 v233, s44, v233
    v_mfma_f32_16x16x32_bf16 v[20:23], v[84:87], v[156:159], v[20:23]
    v_mul_u32_u24 v233, 1280, v233
    v_bfe_u32 v234, v0, 4, 1
    v_mfma_f32_16x16x32_bf16 v[24:27], v[88:91], v[156:159], v[24:27]
    v_lshl_add_u32 v233, v234, 5, v233
    v_lshrrev_b32 v234, 5, v0
    v_mfma_f32_16x16x32_bf16 v[40:43], v[88:91], v[160:163], v[40:43]
    v_lshl_add_u32 v233, v234, 4, v233
    s_lshr_b32 s44, s3, 1
    v_mfma_f32_16x16x32_bf16 v[56:59], v[88:91], v[164:167], v[56:59]
    s_lshl_b32 s44, s44, 6
    v_mfma_f32_16x16x32_bf16 v[60:63], v[92:95], v[164:167], v[60:63]
    s_lshl_b32 s45, s7, 7
    v_mfma_f32_16x16x32_bf16 v[44:47], v[92:95], v[160:163], v[44:47]
    s_add_u32 s44, s44, s45
    v_mfma_f32_16x16x32_bf16 v[28:31], v[92:95], v[156:159], v[28:31]
    v_add_u32 v232, s44, v233
    s_waitcnt lgkmcnt(0)
    s_waitcnt vmcnt(12)
    v_mfma_f32_16x16x32_bf16 v[16:19], v[64:67], v[168:171], v[16:19]
    ds_read_b64_tr_b16 v[80:81], v6 offset:57344
    v_mfma_f32_16x16x32_bf16 v[32:35], v[64:67], v[172:175], v[32:35]
    ds_read_b64_tr_b16 v[82:83], v6 offset:57856
    v_mfma_f32_16x16x32_bf16 v[48:51], v[64:67], v[176:179], v[48:51]
    ds_read_b64_tr_b16 v[84:85], v7 offset:57344
    v_mfma_f32_16x16x32_bf16 v[52:55], v[68:71], v[176:179], v[52:55]
    ds_read_b64_tr_b16 v[86:87], v7 offset:57856
    v_mfma_f32_16x16x32_bf16 v[36:39], v[68:71], v[172:175], v[36:39]
    ds_read_b64_tr_b16 v[88:89], v8 offset:57344
    v_mfma_f32_16x16x32_bf16 v[20:23], v[68:71], v[168:171], v[20:23]
    ds_read_b64_tr_b16 v[90:91], v8 offset:57856
    v_mfma_f32_16x16x32_bf16 v[24:27], v[72:75], v[168:171], v[24:27]
    ds_read_b64_tr_b16 v[92:93], v9 offset:57344
    v_mfma_f32_16x16x32_bf16 v[40:43], v[72:75], v[172:175], v[40:43]
    ds_read_b64_tr_b16 v[94:95], v9 offset:57856
    v_mfma_f32_16x16x32_bf16 v[56:59], v[72:75], v[176:179], v[56:59]
    ds_read_b32 v252, v231 offset:0
    v_mfma_f32_16x16x32_bf16 v[60:63], v[76:79], v[176:179], v[60:63]
    ds_read_b32 v253, v231 offset:128
    v_mfma_f32_16x16x32_bf16 v[44:47], v[76:79], v[172:175], v[44:47]
    ds_read_b32 v254, v231 offset:256
    v_mfma_f32_16x16x32_bf16 v[28:31], v[76:79], v[168:171], v[28:31]
    s_waitcnt lgkmcnt(0)
    s_barrier
    s_waitcnt vmcnt(9)
    v_mfma_f32_16x16x32_bf16 v[16:19], v[80:83], v[180:183], v[16:19]
    ds_read_b64_tr_b16 v[64:65], v10 offset:0
    v_mfma_f32_16x16x32_bf16 v[32:35], v[80:83], v[184:187], v[32:35]
    ds_read_b64_tr_b16 v[66:67], v10 offset:512
    v_mfma_f32_16x16x32_bf16 v[48:51], v[80:83], v[188:191], v[48:51]
    ds_read_b64_tr_b16 v[68:69], v11 offset:0
    v_mfma_f32_16x16x32_bf16 v[52:55], v[84:87], v[188:191], v[52:55]
    ds_read_b64_tr_b16 v[70:71], v11 offset:512
    v_mfma_f32_16x16x32_bf16 v[36:39], v[84:87], v[184:187], v[36:39]
    ds_read_b64_tr_b16 v[72:73], v12 offset:0
    v_mfma_f32_16x16x32_bf16 v[20:23], v[84:87], v[180:183], v[20:23]
    ds_read_b64_tr_b16 v[74:75], v12 offset:512
    v_mfma_f32_16x16x32_bf16 v[24:27], v[88:91], v[180:183], v[24:27]
    ds_read_b64_tr_b16 v[76:77], v13 offset:0
    v_mfma_f32_16x16x32_bf16 v[40:43], v[88:91], v[184:187], v[40:43]
    ds_read_b64_tr_b16 v[78:79], v13 offset:512
    v_mfma_f32_16x16x32_bf16 v[56:59], v[88:91], v[188:191], v[56:59]
    v_mfma_f32_16x16x32_bf16 v[60:63], v[92:95], v[188:191], v[60:63]
    v_mfma_f32_16x16x32_bf16 v[44:47], v[92:95], v[184:187], v[44:47]
    v_mfma_f32_16x16x32_bf16 v[28:31], v[92:95], v[180:183], v[28:31]
    s_waitcnt lgkmcnt(0)
    s_waitcnt vmcnt(6)
    v_mfma_f32_16x16x32_bf16 v[16:19], v[64:67], v[96:99], v[16:19]
    ds_read_b64_tr_b16 v[80:81], v10 offset:8192
    v_mfma_f32_16x16x32_bf16 v[32:35], v[64:67], v[100:103], v[32:35]
    ds_read_b64_tr_b16 v[82:83], v10 offset:8704
    v_mfma_f32_16x16x32_bf16 v[48:51], v[64:67], v[104:107], v[48:51]
    ds_read_b64_tr_b16 v[84:85], v11 offset:8192
    v_mfma_f32_16x16x32_bf16 v[52:55], v[68:71], v[104:107], v[52:55]
    ds_read_b64_tr_b16 v[86:87], v11 offset:8704
    v_mfma_f32_16x16x32_bf16 v[36:39], v[68:71], v[100:103], v[36:39]
    ds_read_b64_tr_b16 v[88:89], v12 offset:8192
    v_mfma_f32_16x16x32_bf16 v[20:23], v[68:71], v[96:99], v[20:23]
    ds_read_b64_tr_b16 v[90:91], v12 offset:8704
    v_mfma_f32_16x16x32_bf16 v[24:27], v[72:75], v[96:99], v[24:27]
    ds_read_b64_tr_b16 v[92:93], v13 offset:8192
    v_mfma_f32_16x16x32_bf16 v[40:43], v[72:75], v[100:103], v[40:43]
    ds_read_b64_tr_b16 v[94:95], v13 offset:8704
    v_mfma_f32_16x16x32_bf16 v[56:59], v[72:75], v[104:107], v[56:59]
    v_mfma_f32_16x16x32_bf16 v[60:63], v[76:79], v[104:107], v[60:63]
    v_mfma_f32_16x16x32_bf16 v[44:47], v[76:79], v[100:103], v[44:47]
    v_mfma_f32_16x16x32_bf16 v[28:31], v[76:79], v[96:99], v[28:31]
    s_waitcnt lgkmcnt(0)
    s_barrier
    s_waitcnt vmcnt(3)
    v_mfma_f32_16x16x32_bf16 v[16:19], v[80:83], v[108:111], v[16:19]
    ds_read_b64_tr_b16 v[64:65], v6 offset:0
    v_mfma_f32_16x16x32_bf16 v[32:35], v[80:83], v[112:115], v[32:35]
    ds_read_b64_tr_b16 v[66:67], v6 offset:512
    v_mfma_f32_16x16x32_bf16 v[48:51], v[80:83], v[116:119], v[48:51]
    ds_read_b64_tr_b16 v[68:69], v7 offset:0
    v_mfma_f32_16x16x32_bf16 v[52:55], v[84:87], v[116:119], v[52:55]
    ds_read_b64_tr_b16 v[70:71], v7 offset:512
    v_mfma_f32_16x16x32_bf16 v[36:39], v[84:87], v[112:115], v[36:39]
    ds_read_b64_tr_b16 v[72:73], v8 offset:0
    v_mfma_f32_16x16x32_bf16 v[20:23], v[84:87], v[108:111], v[20:23]
    ds_read_b64_tr_b16 v[74:75], v8 offset:512
    v_mfma_f32_16x16x32_bf16 v[24:27], v[88:91], v[108:111], v[24:27]
    ds_read_b64_tr_b16 v[76:77], v9 offset:0
    v_mfma_f32_16x16x32_bf16 v[40:43], v[88:91], v[112:115], v[40:43]
    ds_read_b64_tr_b16 v[78:79], v9 offset:512
    v_mfma_f32_16x16x32_bf16 v[56:59], v[88:91], v[116:119], v[56:59]
    v_mfma_f32_16x16x32_bf16 v[60:63], v[92:95], v[116:119], v[60:63]
    v_mfma_f32_16x16x32_bf16 v[44:47], v[92:95], v[112:115], v[44:47]
    v_mfma_f32_16x16x32_bf16 v[28:31], v[92:95], v[108:111], v[28:31]
    s_waitcnt lgkmcnt(0)
    s_waitcnt vmcnt(0)
    v_mfma_f32_16x16x32_bf16 v[16:19], v[64:67], v[120:123], v[16:19]
    v_mfma_f32_16x16x32_bf16 v[32:35], v[64:67], v[124:127], v[32:35]
    v_mfma_f32_16x16x32_bf16 v[48:51], v[64:67], v[128:131], v[48:51]
    v_mfma_f32_16x16x32_bf16 v[52:55], v[68:71], v[128:131], v[52:55]
    v_mfma_f32_16x16x32_bf16 v[36:39], v[68:71], v[124:127], v[36:39]
    v_mfma_f32_16x16x32_bf16 v[20:23], v[68:71], v[120:123], v[20:23]
    v_mfma_f32_16x16x32_bf16 v[24:27], v[72:75], v[120:123], v[24:27]
    v_mfma_f32_16x16x32_bf16 v[40:43], v[72:75], v[124:127], v[40:43]
    v_mfma_f32_16x16x32_bf16 v[56:59], v[72:75], v[128:131], v[56:59]
    v_mfma_f32_16x16x32_bf16 v[60:63], v[76:79], v[128:131], v[60:63]
    v_mfma_f32_16x16x32_bf16 v[44:47], v[76:79], v[124:127], v[44:47]
    v_mfma_f32_16x16x32_bf16 v[28:31], v[76:79], v[120:123], v[28:31]
    s_waitcnt lgkmcnt(0)
    s_cmp_ge_u32 s3, 2
    s_nop 5
    s_cbranch_scc1 L_f2_hi
    ds_write_b128 v228, v[24:27] offset:0
    ds_write_b128 v228, v[28:31] offset:1024
    ds_write_b128 v228, v[40:43] offset:2048
    ds_write_b128 v228, v[44:47] offset:3072
    ds_write_b128 v228, v[56:59] offset:4096
    ds_write_b128 v228, v[60:63] offset:5120
    s_mov_b32 s44, 0
    s_waitcnt lgkmcnt(0)
    s_barrier
    ds_read_b128 v[64:67], v229 offset:0
    ds_read_b128 v[96:99], v230 offset:0
    ds_read_b128 v[68:71], v229 offset:1024
    ds_read_b128 v[100:103], v230 offset:1024
    ds_read_b128 v[72:75], v229 offset:2048
    ds_read_b128 v[104:107], v230 offset:2048
    ds_read_b128 v[76:79], v229 offset:3072
    ds_read_b128 v[108:111], v230 offset:3072
    ds_read_b128 v[80:83], v229 offset:4096
    ds_read_b128 v[112:115], v230 offset:4096
    ds_read_b128 v[84:87], v229 offset:5120
    ds_read_b128 v[116:119], v230 offset:5120
    s_waitcnt lgkmcnt(8)
    v_pk_add_f32 v[16:17], v[16:17], v[64:65]
    v_pk_add_f32 v[18:19], v[18:19], v[66:67]
    v_pk_fma_f32 v[16:17], v[16:17], v[252:253], v[96:97] op_sel:[0,0,0] op_sel_hi:[1,0,1]
    v_pk_fma_f32 v[18:19], v[18:19], v[252:253], v[98:99] op_sel:[0,0,0] op_sel_hi:[1,0,1]
    v_cvt_pk_bf16_f32 v240, v16, v17
    v_cvt_pk_bf16_f32 v241, v18, v19
    v_pk_add_f32 v[20:21], v[20:21], v[68:69]
    v_pk_add_f32 v[22:23], v[22:23], v[70:71]
    v_pk_fma_f32 v[20:21], v[20:21], v[252:253], v[100:101] op_sel:[0,0,0] op_sel_hi:[1,0,1]
    v_pk_fma_f32 v[22:23], v[22:23], v[252:253], v[102:103] op_sel:[0,0,0] op_sel_hi:[1,0,1]
    v_cvt_pk_bf16_f32 v242, v20, v21
    v_cvt_pk_bf16_f32 v243, v22, v23
    s_nop 1
    v_permlane16_swap_b32 v240, v242
    v_permlane16_swap_b32 v241, v243
    buffer_store_dwordx4 v[240:243], v232, s[32:35], s44 offen sc1
    s_add_u32 s44, s44, 20480
    s_waitcnt lgkmcnt(4)
    v_pk_add_f32 v[32:33], v[32:33], v[72:73]
    v_pk_add_f32 v[34:35], v[34:35], v[74:75]
    v_pk_fma_f32 v[32:33], v[32:33], v[252:253], v[104:105] op_sel:[0,1,0] op_sel_hi:[1,1,1]
    v_pk_fma_f32 v[34:35], v[34:35], v[252:253], v[106:107] op_sel:[0,1,0] op_sel_hi:[1,1,1]
    v_cvt_pk_bf16_f32 v244, v32, v33
    v_cvt_pk_bf16_f32 v245, v34, v35
    v_pk_add_f32 v[36:37], v[36:37], v[76:77]
    v_pk_add_f32 v[38:39], v[38:39], v[78:79]
    v_pk_fma_f32 v[36:37], v[36:37], v[252:253], v[108:109] op_sel:[0,1,0] op_sel_hi:[1,1,1]
    v_pk_fma_f32 v[38:39], v[38:39], v[252:253], v[110:111] op_sel:[0,1,0] op_sel_hi:[1,1,1]
    v_cvt_pk_bf16_f32 v246, v36, v37
    v_cvt_pk_bf16_f32 v247, v38, v39
    s_nop 1
    v_permlane16_swap_b32 v244, v246
    v_permlane16_swap_b32 v245, v247
    buffer_store_dwordx4 v[244:247], v232, s[32:35], s44 offen sc1
    s_add_u32 s44, s44, 20480
    s_waitcnt lgkmcnt(0)
    v_pk_add_f32 v[48:49], v[48:49], v[80:81]
    v_pk_add_f32 v[50:51], v[50:51], v[82:83]
    v_pk_fma_f32 v[48:49], v[48:49], v[254:255], v[112:113] op_sel:[0,0,0] op_sel_hi:[1,0,1]
    v_pk_fma_f32 v[50:51], v[50:51], v[254:255], v[114:115] op_sel:[0,0,0] op_sel_hi:[1,0,1]
    v_cvt_pk_bf16_f32 v248, v48, v49
    v_cvt_pk_bf16_f32 v249, v50, v51
    v_pk_add_f32 v[52:53], v[52:53], v[84:85]
    v_pk_add_f32 v[54:55], v[54:55], v[86:87]
    v_pk_fma_f32 v[52:53], v[52:53], v[254:255], v[116:117] op_sel:[0,0,0] op_sel_hi:[1,0,1]
    v_pk_fma_f32 v[54:55], v[54:55], v[254:255], v[118:119] op_sel:[0,0,0] op_sel_hi:[1,0,1]
    v_cvt_pk_bf16_f32 v250, v52, v53
    v_cvt_pk_bf16_f32 v251, v54, v55
    s_nop 1
    v_permlane16_swap_b32 v248, v250
    v_permlane16_swap_b32 v249, v251
    buffer_store_dwordx4 v[248:251], v232, s[32:35], s44 offen sc1
    s_branch L_m_end
L_f2_hi:
    ds_write_b128 v228, v[16:19] offset:0
    ds_write_b128 v228, v[20:23] offset:1024
    ds_write_b128 v228, v[32:35] offset:2048
    ds_write_b128 v228, v[36:39] offset:3072
    ds_write_b128 v228, v[48:51] offset:4096
    ds_write_b128 v228, v[52:55] offset:5120
    s_mov_b32 s44, 0
    s_waitcnt lgkmcnt(0)
    s_barrier
    ds_read_b128 v[64:67], v229 offset:0
    ds_read_b128 v[96:99], v230 offset:0
    ds_read_b128 v[68:71], v229 offset:1024
    ds_read_b128 v[100:103], v230 offset:1024
    ds_read_b128 v[72:75], v229 offset:2048
    ds_read_b128 v[104:107], v230 offset:2048
    ds_read_b128 v[76:79], v229 offset:3072
    ds_read_b128 v[108:111], v230 offset:3072
    ds_read_b128 v[80:83], v229 offset:4096
    ds_read_b128 v[112:115], v230 offset:4096
    ds_read_b128 v[84:87], v229 offset:5120
    ds_read_b128 v[116:119], v230 offset:5120
    s_waitcnt lgkmcnt(8)
    v_pk_add_f32 v[24:25], v[24:25], v[64:65]
    v_pk_add_f32 v[26:27], v[26:27], v[66:67]
    v_pk_fma_f32 v[24:25], v[24:25], v[252:253], v[96:97] op_sel:[0,0,0] op_sel_hi:[1,0,1]
    v_pk_fma_f32 v[26:27], v[26:27], v[252:253], v[98:99] op_sel:[0,0,0] op_sel_hi:[1,0,1]
    v_cvt_pk_bf16_f32 v240, v24, v25
    v_cvt_pk_bf16_f32 v241, v26, v27
    v_pk_add_f32 v[28:29], v[28:29], v[68:69]
    v_pk_add_f32 v[30:31], v[30:31], v[70:71]
    v_pk_fma_f32 v[28:29], v[28:29], v[252:253], v[100:101] op_sel:[0,0,0] op_sel_hi:[1,0,1]
    v_pk_fma_f32 v[30:31], v[30:31], v[252:253], v[102:103] op_sel:[0,0,0] op_sel_hi:[1,0,1]
    v_cvt_pk_bf16_f32 v242, v28, v29
    v_cvt_pk_bf16_f32 v243, v30, v31
    s_nop 1
    v_permlane16_swap_b32 v240, v242
    v_permlane16_swap_b32 v241, v243
    buffer_store_dwordx4 v[240:243], v232, s[32:35], s44 offen sc1
    s_add_u32 s44, s44, 20480
    s_waitcnt lgkmcnt(4)
    v_pk_add_f32 v[40:41], v[40:41], v[72:73]
    v_pk_add_f32 v[42:43], v[42:43], v[74:75]
    v_pk_fma_f32 v[40:41], v[40:41], v[252:253], v[104:105] op_sel:[0,1,0] op_sel_hi:[1,1,1]
    v_pk_fma_f32 v[42:43], v[42:43], v[252:253], v[106:107] op_sel:[0,1,0] op_sel_hi:[1,1,1]
    v_cvt_pk_bf16_f32 v244, v40, v41
    v_cvt_pk_bf16_f32 v245, v42, v43
    v_pk_add_f32 v[44:45], v[44:45], v[76:77]
    v_pk_add_f32 v[46:47], v[46:47], v[78:79]
    v_pk_fma_f32 v[44:45], v[44:45], v[252:253], v[108:109] op_sel:[0,1,0] op_sel_hi:[1,1,1]
    v_pk_fma_f32 v[46:47], v[46:47], v[252:253], v[110:111] op_sel:[0,1,0] op_sel_hi:[1,1,1]
    v_cvt_pk_bf16_f32 v246, v44, v45
    v_cvt_pk_bf16_f32 v247, v46, v47
    s_nop 1
    v_permlane16_swap_b32 v244, v246
    v_permlane16_swap_b32 v245, v247
    buffer_store_dwordx4 v[244:247], v232, s[32:35], s44 offen sc1
    s_add_u32 s44, s44, 20480
    s_waitcnt lgkmcnt(0)
    v_pk_add_f32 v[56:57], v[56:57], v[80:81]
    v_pk_add_f32 v[58:59], v[58:59], v[82:83]
    v_pk_fma_f32 v[56:57], v[56:57], v[254:255], v[112:113] op_sel:[0,0,0] op_sel_hi:[1,0,1]
    v_pk_fma_f32 v[58:59], v[58:59], v[254:255], v[114:115] op_sel:[0,0,0] op_sel_hi:[1,0,1]
    v_cvt_pk_bf16_f32 v248, v56, v57
    v_cvt_pk_bf16_f32 v249, v58, v59
    v_pk_add_f32 v[60:61], v[60:61], v[84:85]
    v_pk_add_f32 v[62:63], v[62:63], v[86:87]
    v_pk_fma_f32 v[60:61], v[60:61], v[254:255], v[116:117] op_sel:[0,0,0] op_sel_hi:[1,0,1]
    v_pk_fma_f32 v[62:63], v[62:63], v[254:255], v[118:119] op_sel:[0,0,0] op_sel_hi:[1,0,1]
    v_cvt_pk_bf16_f32 v250, v60, v61
    v_cvt_pk_bf16_f32 v251, v62, v63
    s_nop 1
    v_permlane16_swap_b32 v248, v250
    v_permlane16_swap_b32 v249, v251
    buffer_store_dwordx4 v[248:251], v232, s[32:35], s44 offen sc1
L_m_end:
    s_endpgm
L_spare:
    s_and_b32 s44, s2, 7
    s_mul_i32 s44, s44, 5
    s_add_u32 s44, s44, s8
    s_sub_u32 s54, s44, 27
    s_lshl_b32 s44, s54, 2
    s_and_b32 s45, s3, 3
    s_add_u32 s44, s44, s45
    s_lshr_b32 s45, s3, 2
    s_mul_i32 s45, s45, 160
    s_add_u32 s55, s44, s45
    s_sub_u32 s46, s55, 256
    s_add_u32 s47, s55, 64
    s_cmp_lt_u32 s55, 152
    s_cselect_b32 s47, s47, 999
    s_cmp_ge_u32 s55, 256
    s_cselect_b32 s56, s46, s47
    s_waitcnt lgkmcnt(0)
    s_mov_b32 s12, s64
    s_mov_b32 s13, s65
    s_mov_b32 s14, 0x280000
    s_mov_b32 s15, 0x20000
    s_mov_b32 s28, s94
    s_mov_b32 s29, s95
    s_mov_b32 s30, 0x10000000
    s_mov_b32 s31, 0x20000
    s_mov_b32 s36, s92
    s_mov_b32 s37, s93
    s_mov_b32 s38, 0x100
    s_mov_b32 s39, 0x20000
    s_cmp_ge_u32 s55, 256
    s_cbranch_scc1 L_sp_a
    v_lshlrev_b32 v2, 2, v0
    s_mul_i32 s47, s55, 10240
    buffer_load_dword v116, v2, s[12:15], s47 offen offset:0
    buffer_load_dword v117, v2, s[12:15], s47 offen offset:256
    buffer_load_dword v118, v2, s[12:15], s47 offen offset:512
    buffer_load_dword v119, v2, s[12:15], s47 offen offset:768
    buffer_load_dword v120, v2, s[12:15], s47 offen offset:1024
    s_add_u32 s47, s47, 1280
    buffer_load_dword v121, v2, s[12:15], s47 offen offset:0
    buffer_load_dword v122, v2, s[12:15], s47 offen offset:256
    buffer_load_dword v123, v2, s[12:15], s47 offen offset:512
    buffer_load_dword v124, v2, s[12:15], s47 offen offset:768
    buffer_load_dword v125, v2, s[12:15], s47 offen offset:1024
    s_add_u32 s47, s47, 1280
    buffer_load_dword v126, v2, s[12:15], s47 offen offset:0
    buffer_load_dword v127, v2, s[12:15], s47 offen offset:256
    buffer_load_dword v128, v2, s[12:15], s47 offen offset:512
    buffer_load_dword v129, v2, s[12:15], s47 offen offset:768
    buffer_load_dword v130, v2, s[12:15], s47 offen offset:1024
    s_add_u32 s47, s47, 1280
    buffer_load_dword v131, v2, s[12:15], s47 offen offset:0
    buffer_load_dword v132, v2, s[12:15], s47 offen offset:256
    buffer_load_dword v133, v2, s[12:15], s47 offen offset:512
    buffer_load_dword v134, v2, s[12:15], s47 offen offset:768
    buffer_load_dword v135, v2, s[12:15], s47 offen offset:1024
    s_add_u32 s47, s47, 1280
    buffer_load_dword v136, v2, s[12:15], s47 offen offset:0
    buffer_load_dword v137, v2, s[12:15], s47 offen offset:256
    buffer_load_dword v138, v2, s[12:15], s47 offen offset:512
    buffer_load_dword v139, v2, s[12:15], s47 offen offset:768
    buffer_load_dword v140, v2, s[12:15], s47 offen offset:1024
    s_add_u32 s47, s47, 1280
    buffer_load_dword v141, v2, s[12:15], s47 offen offset:0
    buffer_load_dword v142, v2, s[12:15], s47 offen offset:256
    buffer_load_dword v143, v2, s[12:15], s47 offen offset:512
    buffer_load_dword v144, v2, s[12:15], s47 offen offset:768
    buffer_load_dword v145, v2, s[12:15], s47 offen offset:1024
    s_add_u32 s47, s47, 1280
    buffer_load_dword v146, v2, s[12:15], s47 offen offset:0
    buffer_load_dword v147, v2, s[12:15], s47 offen offset:256
    buffer_load_dword v148, v2, s[12:15], s47 offen offset:512
    buffer_load_dword v149, v2, s[12:15], s47 offen offset:768
    buffer_load_dword v150, v2, s[12:15], s47 offen offset:1024
    s_add_u32 s47, s47, 1280
    buffer_load_dword v151, v2, s[12:15], s47 offen offset:0
    buffer_load_dword v152, v2, s[12:15], s47 offen offset:256
    buffer_load_dword v153, v2, s[12:15], s47 offen offset:512
    buffer_load_dword v154, v2, s[12:15], s47 offen offset:768
    buffer_load_dword v155, v2, s[12:15], s47 offen offset:1024
L_sp_a:
    s_and_b32 s44, s3, 3
    s_lshl_b32 s44, s44, 5
    v_bfe_u32 v10, v0, 2, 1
    v_lshlrev_b32 v10, 4, v10
    v_lshrrev_b32 v11, 4, v0
    v_lshl_add_u32 v10, v11, 2, v10
    v_and_b32 v11, 3, v0
    v_add3_u32 v10, v10, v11, s44
    v_and_b32 v11, 15, v0
    v_cvt_f32_u32 v50, v11
    v_bfe_u32 v11, v0, 3, 1
    v_add_u32 v11, s9, v11
    v_lshrrev_b32 v14, 7, v11
    v_lshlrev_b32 v14, 7, v14
    v_and_b32 v15, 63, v11
    v_lshl_add_u32 v14, v15, 1, v14
    v_bfe_u32 v15, v11, 6, 1
    v_add_lshl_u32 v11, v14, v15, 1
    v_lshlrev_b32 v1, 7, v11
    v_lshl_add_u32 v10, v10, 1, v1
    global_load_ushort v108, v10, s[66:67]
    global_load_ushort v109, v10, s[68:69]
    global_load_ushort v110, v10, s[70:71]
    global_load_ushort v111, v10, s[72:73]
    global_load_ushort v112, v10, s[74:75]
    global_load_ushort v113, v10, s[76:77]
    global_load_ushort v114, v11, s[78:79]
    global_load_ushort v115, v11, s[80:81]
    s_barrier
    s_cmp_ge_u32 s56, 216
    s_cbranch_scc1 L_sp_b
    s_cmp_ge_u32 s56, 108
    s_cselect_b32 s40, s86, s84
    s_cselect_b32 s41, s87, s85
    s_cselect_b32 s46, 108, 0
    s_mov_b32 s42, 0x21c000
    s_mov_b32 s43, 0x20000
    s_sub_u32 s46, s56, s46
    s_and_b32 s47, s46, 3
    s_mul_i32 s47, s47, 552960
    s_lshr_b32 s46, s46, 2
    s_lshl_b32 s46, s46, 7
    s_add_u32 s59, s46, s47
    v_lshrrev_b32 v6, 3, v0
    v_mul_u32_u24 v6, 3456, v6
    v_and_b32 v3, 7, v0
    v_lshl_add_u32 v6, v3, 4, v6
    buffer_load_dwordx4 v[16:19], v6, s[40:43], s59 offen
    s_add_u32 s59, s59, 27648
    buffer_load_dwordx4 v[20:23], v6, s[40:43], s59 offen
    s_add_u32 s59, s59, 27648
    buffer_load_dwordx4 v[24:27], v6, s[40:43], s59 offen
    s_add_u32 s59, s59, 27648
    buffer_load_dwordx4 v[28:31], v6, s[40:43], s59 offen
    s_add_u32 s59, s59, 27648
    buffer_load_dwordx4 v[32:35], v6, s[40:43], s59 offen
    s_add_u32 s59, s59, 27648
    buffer_load_dwordx4 v[36:39], v6, s[40:43], s59 offen
    s_add_u32 s59, s59, 27648
    buffer_load_dwordx4 v[40:43], v6, s[40:43], s59 offen
    s_add_u32 s59, s59, 27648
    buffer_load_dwordx4 v[44:47], v6, s[40:43], s59 offen
    s_add_u32 s59, s59, 27648
    buffer_load_dwordx4 v[48:51], v6, s[40:43], s59 offen
    s_add_u32 s59, s59, 27648
    buffer_load_dwordx4 v[52:55], v6, s[40:43], s59 offen
    s_add_u32 s59, s59, 27648
    buffer_load_dwordx4 v[56:59], v6, s[40:43], s59 offen
    s_add_u32 s59, s59, 27648
    buffer_load_dwordx4 v[60:63], v6, s[40:43], s59 offen
    s_add_u32 s59, s59, 27648
    buffer_load_dwordx4 v[64:67], v6, s[40:43], s59 offen
    s_add_u32 s59, s59, 27648
    buffer_load_dwordx4 v[68:71], v6, s[40:43], s59 offen
    s_add_u32 s59, s59, 27648
    buffer_load_dwordx4 v[72:75], v6, s[40:43], s59 offen
    s_add_u32 s59, s59, 27648
    buffer_load_dwordx4 v[76:79], v6, s[40:43], s59 offen
    s_add_u32 s59, s59, 27648
    buffer_load_dwordx4 v[80:83], v6, s[40:43], s59 offen
    s_add_u32 s59, s59, 27648
    buffer_load_dwordx4 v[84:87], v6, s[40:43], s59 offen
    s_add_u32 s59, s59, 27648
    buffer_load_dwordx4 v[88:91], v6, s[40:43], s59 offen
    s_add_u32 s59, s59, 27648
    buffer_load_dwordx4 v[92:95], v6, s[40:43], s59 offen
    s_add_u32 s59, s59, 27648
L_sp_b:
    v_lshlrev_b32 v252, 2, v0
    v_add_u32 v252, 162304, v252
    v_mov_b32 v253, 0
    s_mov_b64 exec, 0xff
    ds_write_b32 v252, v253
    s_mov_b64 exec, -1
    s_cmp_ge_u32 s55, 256
    s_cbranch_scc1 L_sp_g
    s_cmp_ge_u32 s56, 216
    s_cbranch_scc1 L_sp_h
    s_waitcnt vmcnt(28)
    s_branch L_sp_i
L_sp_h:
    s_waitcnt vmcnt(8)
L_sp_i:
    s_mov_b32 s48, 0x3f803f80
    s_mov_b32 s49, 0xffff0000
    v_dot2_f32_bf16 v156, v116, s48, 0
    v_dot2_f32_bf16 v157, v121, s48, 0
    v_dot2_f32_bf16 v158, v126, s48, 0
    v_dot2_f32_bf16 v159, v131, s48, 0
    v_dot2_f32_bf16 v160, v136, s48, 0
    v_dot2_f32_bf16 v161, v141, s48, 0
    v_dot2_f32_bf16 v162, v146, s48, 0
    v_dot2_f32_bf16 v163, v151, s48, 0
    v_dot2_f32_bf16 v164, v116, v116, 0
    v_dot2_f32_bf16 v165, v121, v121, 0
    v_dot2_f32_bf16 v166, v126, v126, 0
    v_dot2_f32_bf16 v167, v131, v131, 0
    v_dot2_f32_bf16 v168, v136, v136, 0
    v_dot2_f32_bf16 v169, v141, v141, 0
    v_dot2_f32_bf16 v170, v146, v146, 0
    v_dot2_f32_bf16 v171, v151, v151, 0
    v_dot2_f32_bf16 v156, v117, s48, v156
    v_dot2_f32_bf16 v157, v122, s48, v157
    v_dot2_f32_bf16 v158, v127, s48, v158
    v_dot2_f32_bf16 v159, v132, s48, v159
    v_dot2_f32_bf16 v160, v137, s48, v160
    v_dot2_f32_bf16 v161, v142, s48, v161
    v_dot2_f32_bf16 v162, v147, s48, v162
    v_dot2_f32_bf16 v163, v152, s48, v163
    v_dot2_f32_bf16 v164, v117, v117, v164
    v_dot2_f32_bf16 v165, v122, v122, v165
    v_dot2_f32_bf16 v166, v127, v127, v166
    v_dot2_f32_bf16 v167, v132, v132, v167
    v_dot2_f32_bf16 v168, v137, v137, v168
    v_dot2_f32_bf16 v169, v142, v142, v169
    v_dot2_f32_bf16 v170, v147, v147, v170
    v_dot2_f32_bf16 v171, v152, v152, v171
    v_dot2_f32_bf16 v156, v118, s48, v156
    v_dot2_f32_bf16 v157, v123, s48, v157
    v_dot2_f32_bf16 v158, v128, s48, v158
    v_dot2_f32_bf16 v159, v133, s48, v159
    v_dot2_f32_bf16 v160, v138, s48, v160
    v_dot2_f32_bf16 v161, v143, s48, v161
    v_dot2_f32_bf16 v162, v148, s48, v162
    v_dot2_f32_bf16 v163, v153, s48, v163
    v_dot2_f32_bf16 v164, v118, v118, v164
    v_dot2_f32_bf16 v165, v123, v123, v165
    v_dot2_f32_bf16 v166, v128, v128, v166
    v_dot2_f32_bf16 v167, v133, v133, v167
    v_dot2_f32_bf16 v168, v138, v138, v168
    v_dot2_f32_bf16 v169, v143, v143, v169
    v_dot2_f32_bf16 v170, v148, v148, v170
    v_dot2_f32_bf16 v171, v153, v153, v171
    v_dot2_f32_bf16 v156, v119, s48, v156
    v_dot2_f32_bf16 v157, v124, s48, v157
    v_dot2_f32_bf16 v158, v129, s48, v158
    v_dot2_f32_bf16 v159, v134, s48, v159
    v_dot2_f32_bf16 v160, v139, s48, v160
    v_dot2_f32_bf16 v161, v144, s48, v161
    v_dot2_f32_bf16 v162, v149, s48, v162
    v_dot2_f32_bf16 v163, v154, s48, v163
    v_dot2_f32_bf16 v164, v119, v119, v164
    v_dot2_f32_bf16 v165, v124, v124, v165
    v_dot2_f32_bf16 v166, v129, v129, v166
    v_dot2_f32_bf16 v167, v134, v134, v167
    v_dot2_f32_bf16 v168, v139, v139, v168
    v_dot2_f32_bf16 v169, v144, v144, v169
    v_dot2_f32_bf16 v170, v149, v149, v170
    v_dot2_f32_bf16 v171, v154, v154, v171
    v_dot2_f32_bf16 v156, v120, s48, v156
    v_dot2_f32_bf16 v157, v125, s48, v157
    v_dot2_f32_bf16 v158, v130, s48, v158
    v_dot2_f32_bf16 v159, v135, s48, v159
    v_dot2_f32_bf16 v160, v140, s48, v160
    v_dot2_f32_bf16 v161, v145, s48, v161
    v_dot2_f32_bf16 v162, v150, s48, v162
    v_dot2_f32_bf16 v163, v155, s48, v163
    v_dot2_f32_bf16 v164, v120, v120, v164
    v_dot2_f32_bf16 v165, v125, v125, v165
    v_dot2_f32_bf16 v166, v130, v130, v166
    v_dot2_f32_bf16 v167, v135, v135, v167
    v_dot2_f32_bf16 v168, v140, v140, v168
    v_dot2_f32_bf16 v169, v145, v145, v169
    v_dot2_f32_bf16 v170, v150, v150, v170
    v_dot2_f32_bf16 v171, v155, v155, v171
    s_nop 2
    v_permlane32_swap_b32 v156, v160
    v_permlane32_swap_b32 v157, v161
    v_permlane32_swap_b32 v158, v162
    v_permlane32_swap_b32 v159, v163
    v_add_f32 v156, v156, v160
    v_add_f32 v157, v157, v161
    v_add_f32 v158, v158, v162
    v_add_f32 v159, v159, v163
    s_nop 0
    v_permlane16_swap_b32 v156, v158
    v_permlane16_swap_b32 v157, v159
    s_nop 0
    v_add_f32 v156, v156, v158
    v_add_f32 v157, v157, v159
    s_nop 1
    v_add_f32_dpp v156, v156, v156 row_ror:8 row_mask:0xf bank_mask:0x3
    v_add_f32_dpp v156, v157, v157 row_ror:8 row_mask:0xf bank_mask:0xc
    v_permlane32_swap_b32 v164, v168
    v_permlane32_swap_b32 v165, v169
    v_permlane32_swap_b32 v166, v170
    v_permlane32_swap_b32 v167, v171
    v_add_f32 v164, v164, v168
    v_add_f32 v165, v165, v169
    v_add_f32 v166, v166, v170
    v_add_f32 v167, v167, v171
    s_nop 0
    v_permlane16_swap_b32 v164, v166
    v_permlane16_swap_b32 v165, v167
    s_nop 0
    v_add_f32 v164, v164, v166
    v_add_f32 v165, v165, v167
    s_nop 1
    v_add_f32_dpp v164, v164, v164 row_ror:8 row_mask:0xf bank_mask:0x3
    v_add_f32_dpp v164, v165, v165 row_ror:8 row_mask:0xf bank_mask:0xc
    s_nop 0
    v_add_f32_dpp v156, v156, v156 quad_perm:[1,0,3,2] row_mask:0xf bank_mask:0xf
    v_add_f32_dpp v164, v164, v164 quad_perm:[1,0,3,2] row_mask:0xf bank_mask:0xf
    s_nop 0
    v_add_f32_dpp v156, v156, v156 quad_perm:[2,3,0,1] row_mask:0xf bank_mask:0xf
    v_add_f32_dpp v164, v164, v164 quad_perm:[2,3,0,1] row_mask:0xf bank_mask:0xf
    s_nop 0
    v_add_f32_dpp v156, v156, v156 row_half_mirror row_mask:0xf bank_mask:0xf
    v_add_f32_dpp v164, v164, v164 row_half_mirror row_mask:0xf bank_mask:0xf
    v_mul_f32 v156, 0x3acccccd, v156
    v_mul_f32 v164, 0x3acccccd, v164
    v_fma_f32 v164, -v156, v156, v164
    v_max_f32 v164, 0, v164
    v_cvt_pk_bf16_f32 v158, v156, v164
    v_lshlrev_b32 v4, 16, v158
    v_and_b32 v164, s49, v158
    v_add_f32 v164, 0x3727c5ac, v164
    v_cvt_pk_bf16_f32 v164, v164, v164
    v_lshlrev_b32 v164, 16, v164
    v_sqrt_f32 v164, v164
    s_mul_i32 s57, s55, 10240
    v_cvt_pk_bf16_f32 v164, v164, v164
    v_lshlrev_b32 v164, 16, v164
    v_rcp_f32 v164, v164
    s_add_u32 s57, s57, 0x100000
    v_mul_f32 v5, v164, v164
    v_mul_f32 v156, v4, v164
    v_lshlrev_b32 v2, 4, v0
    v_readlane_b32 s16, v164, 0
    v_readlane_b32 s17, v156, 0
    v_readlane_b32 s18, v164, 8
    v_readlane_b32 s19, v156, 8
    v_readlane_b32 s20, v164, 16
    v_readlane_b32 s21, v156, 16
    v_readlane_b32 s22, v164, 24
    v_readlane_b32 s23, v156, 24
    v_readlane_b32 s24, v164, 32
    v_readlane_b32 s25, v156, 32
    v_readlane_b32 s26, v164, 40
    v_readlane_b32 s27, v156, 40
    v_readlane_b32 s32, v164, 48
    v_readlane_b32 s33, v156, 48
    v_readlane_b32 s34, v164, 56
    v_readlane_b32 s35, v156, 56
    s_lshl_b32 s47, s55, 6
    s_add_u32 s47, s47, 0x10000
    s_mov_b32 exec_lo, 0x01010101
    s_mov_b32 exec_hi, 0x01010101
    buffer_store_dwordx2 v[4:5], v0, s[28:31], s47 offen sc1
    s_mov_b64 exec, -1
    v_lshlrev_b32 v172, 16, v116
    v_and_b32 v173, s49, v116
    v_lshlrev_b32 v174, 16, v121
    v_and_b32 v175, s49, v121
    v_lshlrev_b32 v176, 16, v126
    v_and_b32 v177, s49, v126
    v_lshlrev_b32 v178, 16, v131
    v_and_b32 v179, s49, v131
    v_lshlrev_b32 v180, 16, v136
    v_and_b32 v181, s49, v136
    v_lshlrev_b32 v182, 16, v141
    v_and_b32 v183, s49, v141
    v_lshlrev_b32 v184, 16, v146
    v_and_b32 v185, s49, v146
    v_lshlrev_b32 v186, 16, v151
    v_and_b32 v187, s49, v151
    v_pk_fma_f32 v[172:173], v[172:173], s[16:17], s[16:17] op_sel:[0,0,1] op_sel_hi:[1,0,1] neg_lo:[0,0,1] neg_hi:[0,0,1]
    v_pk_fma_f32 v[174:175], v[174:175], s[18:19], s[18:19] op_sel:[0,0,1] op_sel_hi:[1,0,1] neg_lo:[0,0,1] neg_hi:[0,0,1]
    v_pk_fma_f32 v[176:177], v[176:177], s[20:21], s[20:21] op_sel:[0,0,1] op_sel_hi:[1,0,1] neg_lo:[0,0,1] neg_hi:[0,0,1]
    v_pk_fma_f32 v[178:179], v[178:179], s[22:23], s[22:23] op_sel:[0,0,1] op_sel_hi:[1,0,1] neg_lo:[0,0,1] neg_hi:[0,0,1]
    v_pk_fma_f32 v[180:181], v[180:181], s[24:25], s[24:25] op_sel:[0,0,1] op_sel_hi:[1,0,1] neg_lo:[0,0,1] neg_hi:[0,0,1]
    v_pk_fma_f32 v[182:183], v[182:183], s[26:27], s[26:27] op_sel:[0,0,1] op_sel_hi:[1,0,1] neg_lo:[0,0,1] neg_hi:[0,0,1]
    v_pk_fma_f32 v[184:185], v[184:185], s[32:33], s[32:33] op_sel:[0,0,1] op_sel_hi:[1,0,1] neg_lo:[0,0,1] neg_hi:[0,0,1]
    v_pk_fma_f32 v[186:187], v[186:187], s[34:35], s[34:35] op_sel:[0,0,1] op_sel_hi:[1,0,1] neg_lo:[0,0,1] neg_hi:[0,0,1]
    v_cvt_pk_bf16_f32 v204, v172, v174
    v_cvt_pk_bf16_f32 v205, v176, v178
    v_cvt_pk_bf16_f32 v206, v180, v182
    v_cvt_pk_bf16_f32 v207, v184, v186
    buffer_store_dwordx4 v[204:207], v2, s[28:31], s57 offen offset:0 sc1
    v_cvt_pk_bf16_f32 v208, v173, v175
    v_cvt_pk_bf16_f32 v209, v177, v179
    v_cvt_pk_bf16_f32 v210, v181, v183
    v_cvt_pk_bf16_f32 v211, v185, v187
    buffer_store_dwordx4 v[208:211], v2, s[28:31], s57 offen offset:1024 sc1
    s_add_u32 s57, s57, 2048
    v_lshlrev_b32 v188, 16, v117
    v_and_b32 v189, s49, v117
    v_lshlrev_b32 v190, 16, v122
    v_and_b32 v191, s49, v122
    v_lshlrev_b32 v192, 16, v127
    v_and_b32 v193, s49, v127
    v_lshlrev_b32 v194, 16, v132
    v_and_b32 v195, s49, v132
    v_lshlrev_b32 v196, 16, v137
    v_and_b32 v197, s49, v137
    v_lshlrev_b32 v198, 16, v142
    v_and_b32 v199, s49, v142
    v_lshlrev_b32 v200, 16, v147
    v_and_b32 v201, s49, v147
    v_lshlrev_b32 v202, 16, v152
    v_and_b32 v203, s49, v152
    v_pk_fma_f32 v[188:189], v[188:189], s[16:17], s[16:17] op_sel:[0,0,1] op_sel_hi:[1,0,1] neg_lo:[0,0,1] neg_hi:[0,0,1]
    v_pk_fma_f32 v[190:191], v[190:191], s[18:19], s[18:19] op_sel:[0,0,1] op_sel_hi:[1,0,1] neg_lo:[0,0,1] neg_hi:[0,0,1]
    v_pk_fma_f32 v[192:193], v[192:193], s[20:21], s[20:21] op_sel:[0,0,1] op_sel_hi:[1,0,1] neg_lo:[0,0,1] neg_hi:[0,0,1]
    v_pk_fma_f32 v[194:195], v[194:195], s[22:23], s[22:23] op_sel:[0,0,1] op_sel_hi:[1,0,1] neg_lo:[0,0,1] neg_hi:[0,0,1]
    v_pk_fma_f32 v[196:197], v[196:197], s[24:25], s[24:25] op_sel:[0,0,1] op_sel_hi:[1,0,1] neg_lo:[0,0,1] neg_hi:[0,0,1]
    v_pk_fma_f32 v[198:199], v[198:199], s[26:27], s[26:27] op_sel:[0,0,1] op_sel_hi:[1,0,1] neg_lo:[0,0,1] neg_hi:[0,0,1]
    v_pk_fma_f32 v[200:201], v[200:201], s[32:33], s[32:33] op_sel:[0,0,1] op_sel_hi:[1,0,1] neg_lo:[0,0,1] neg_hi:[0,0,1]
    v_pk_fma_f32 v[202:203], v[202:203], s[34:35], s[34:35] op_sel:[0,0,1] op_sel_hi:[1,0,1] neg_lo:[0,0,1] neg_hi:[0,0,1]
    v_cvt_pk_bf16_f32 v212, v188, v190
    v_cvt_pk_bf16_f32 v213, v192, v194
    v_cvt_pk_bf16_f32 v214, v196, v198
    v_cvt_pk_bf16_f32 v215, v200, v202
    buffer_store_dwordx4 v[212:215], v2, s[28:31], s57 offen offset:0 sc1
    v_cvt_pk_bf16_f32 v216, v189, v191
    v_cvt_pk_bf16_f32 v217, v193, v195
    v_cvt_pk_bf16_f32 v218, v197, v199
    v_cvt_pk_bf16_f32 v219, v201, v203
    buffer_store_dwordx4 v[216:219], v2, s[28:31], s57 offen offset:1024 sc1
    s_add_u32 s57, s57, 2048
    v_lshlrev_b32 v172, 16, v118
    v_and_b32 v173, s49, v118
    v_lshlrev_b32 v174, 16, v123
    v_and_b32 v175, s49, v123
    v_lshlrev_b32 v176, 16, v128
    v_and_b32 v177, s49, v128
    v_lshlrev_b32 v178, 16, v133
    v_and_b32 v179, s49, v133
    v_lshlrev_b32 v180, 16, v138
    v_and_b32 v181, s49, v138
    v_lshlrev_b32 v182, 16, v143
    v_and_b32 v183, s49, v143
    v_lshlrev_b32 v184, 16, v148
    v_and_b32 v185, s49, v148
    v_lshlrev_b32 v186, 16, v153
    v_and_b32 v187, s49, v153
    v_pk_fma_f32 v[172:173], v[172:173], s[16:17], s[16:17] op_sel:[0,0,1] op_sel_hi:[1,0,1] neg_lo:[0,0,1] neg_hi:[0,0,1]
    v_pk_fma_f32 v[174:175], v[174:175], s[18:19], s[18:19] op_sel:[0,0,1] op_sel_hi:[1,0,1] neg_lo:[0,0,1] neg_hi:[0,0,1]
    v_pk_fma_f32 v[176:177], v[176:177], s[20:21], s[20:21] op_sel:[0,0,1] op_sel_hi:[1,0,1] neg_lo:[0,0,1] neg_hi:[0,0,1]
    v_pk_fma_f32 v[178:179], v[178:179], s[22:23], s[22:23] op_sel:[0,0,1] op_sel_hi:[1,0,1] neg_lo:[0,0,1] neg_hi:[0,0,1]
    v_pk_fma_f32 v[180:181], v[180:181], s[24:25], s[24:25] op_sel:[0,0,1] op_sel_hi:[1,0,1] neg_lo:[0,0,1] neg_hi:[0,0,1]
    v_pk_fma_f32 v[182:183], v[182:183], s[26:27], s[26:27] op_sel:[0,0,1] op_sel_hi:[1,0,1] neg_lo:[0,0,1] neg_hi:[0,0,1]
    v_pk_fma_f32 v[184:185], v[184:185], s[32:33], s[32:33] op_sel:[0,0,1] op_sel_hi:[1,0,1] neg_lo:[0,0,1] neg_hi:[0,0,1]
    v_pk_fma_f32 v[186:187], v[186:187], s[34:35], s[34:35] op_sel:[0,0,1] op_sel_hi:[1,0,1] neg_lo:[0,0,1] neg_hi:[0,0,1]
    v_cvt_pk_bf16_f32 v220, v172, v174
    v_cvt_pk_bf16_f32 v221, v176, v178
    v_cvt_pk_bf16_f32 v222, v180, v182
    v_cvt_pk_bf16_f32 v223, v184, v186
    buffer_store_dwordx4 v[220:223], v2, s[28:31], s57 offen offset:0 sc1
    v_cvt_pk_bf16_f32 v224, v173, v175
    v_cvt_pk_bf16_f32 v225, v177, v179
    v_cvt_pk_bf16_f32 v226, v181, v183
    v_cvt_pk_bf16_f32 v227, v185, v187
    buffer_store_dwordx4 v[224:227], v2, s[28:31], s57 offen offset:1024 sc1
    s_add_u32 s57, s57, 2048
    v_lshlrev_b32 v188, 16, v119
    v_and_b32 v189, s49, v119
    v_lshlrev_b32 v190, 16, v124
    v_and_b32 v191, s49, v124
    v_lshlrev_b32 v192, 16, v129
    v_and_b32 v193, s49, v129
    v_lshlrev_b32 v194, 16, v134
    v_and_b32 v195, s49, v134
    v_lshlrev_b32 v196, 16, v139
    v_and_b32 v197, s49, v139
    v_lshlrev_b32 v198, 16, v144
    v_and_b32 v199, s49, v144
    v_lshlrev_b32 v200, 16, v149
    v_and_b32 v201, s49, v149
    v_lshlrev_b32 v202, 16, v154
    v_and_b32 v203, s49, v154
    v_pk_fma_f32 v[188:189], v[188:189], s[16:17], s[16:17] op_sel:[0,0,1] op_sel_hi:[1,0,1] neg_lo:[0,0,1] neg_hi:[0,0,1]
    v_pk_fma_f32 v[190:191], v[190:191], s[18:19], s[18:19] op_sel:[0,0,1] op_sel_hi:[1,0,1] neg_lo:[0,0,1] neg_hi:[0,0,1]
    v_pk_fma_f32 v[192:193], v[192:193], s[20:21], s[20:21] op_sel:[0,0,1] op_sel_hi:[1,0,1] neg_lo:[0,0,1] neg_hi:[0,0,1]
    v_pk_fma_f32 v[194:195], v[194:195], s[22:23], s[22:23] op_sel:[0,0,1] op_sel_hi:[1,0,1] neg_lo:[0,0,1] neg_hi:[0,0,1]
    v_pk_fma_f32 v[196:197], v[196:197], s[24:25], s[24:25] op_sel:[0,0,1] op_sel_hi:[1,0,1] neg_lo:[0,0,1] neg_hi:[0,0,1]
    v_pk_fma_f32 v[198:199], v[198:199], s[26:27], s[26:27] op_sel:[0,0,1] op_sel_hi:[1,0,1] neg_lo:[0,0,1] neg_hi:[0,0,1]
    v_pk_fma_f32 v[200:201], v[200:201], s[32:33], s[32:33] op_sel:[0,0,1] op_sel_hi:[1,0,1] neg_lo:[0,0,1] neg_hi:[0,0,1]
    v_pk_fma_f32 v[202:203], v[202:203], s[34:35], s[34:35] op_sel:[0,0,1] op_sel_hi:[1,0,1] neg_lo:[0,0,1] neg_hi:[0,0,1]
    v_cvt_pk_bf16_f32 v228, v188, v190
    v_cvt_pk_bf16_f32 v229, v192, v194
    v_cvt_pk_bf16_f32 v230, v196, v198
    v_cvt_pk_bf16_f32 v231, v200, v202
    buffer_store_dwordx4 v[228:231], v2, s[28:31], s57 offen offset:0 sc1
    v_cvt_pk_bf16_f32 v232, v189, v191
    v_cvt_pk_bf16_f32 v233, v193, v195
    v_cvt_pk_bf16_f32 v234, v197, v199
    v_cvt_pk_bf16_f32 v235, v201, v203
    buffer_store_dwordx4 v[232:235], v2, s[28:31], s57 offen offset:1024 sc1
    s_add_u32 s57, s57, 2048
    v_lshlrev_b32 v172, 16, v120
    v_and_b32 v173, s49, v120
    v_lshlrev_b32 v174, 16, v125
    v_and_b32 v175, s49, v125
    v_lshlrev_b32 v176, 16, v130
    v_and_b32 v177, s49, v130
    v_lshlrev_b32 v178, 16, v135
    v_and_b32 v179, s49, v135
    v_lshlrev_b32 v180, 16, v140
    v_and_b32 v181, s49, v140
    v_lshlrev_b32 v182, 16, v145
    v_and_b32 v183, s49, v145
    v_lshlrev_b32 v184, 16, v150
    v_and_b32 v185, s49, v150
    v_lshlrev_b32 v186, 16, v155
    v_and_b32 v187, s49, v155
    v_pk_fma_f32 v[172:173], v[172:173], s[16:17], s[16:17] op_sel:[0,0,1] op_sel_hi:[1,0,1] neg_lo:[0,0,1] neg_hi:[0,0,1]
    v_pk_fma_f32 v[174:175], v[174:175], s[18:19], s[18:19] op_sel:[0,0,1] op_sel_hi:[1,0,1] neg_lo:[0,0,1] neg_hi:[0,0,1]
    v_pk_fma_f32 v[176:177], v[176:177], s[20:21], s[20:21] op_sel:[0,0,1] op_sel_hi:[1,0,1] neg_lo:[0,0,1] neg_hi:[0,0,1]
    v_pk_fma_f32 v[178:179], v[178:179], s[22:23], s[22:23] op_sel:[0,0,1] op_sel_hi:[1,0,1] neg_lo:[0,0,1] neg_hi:[0,0,1]
    v_pk_fma_f32 v[180:181], v[180:181], s[24:25], s[24:25] op_sel:[0,0,1] op_sel_hi:[1,0,1] neg_lo:[0,0,1] neg_hi:[0,0,1]
    v_pk_fma_f32 v[182:183], v[182:183], s[26:27], s[26:27] op_sel:[0,0,1] op_sel_hi:[1,0,1] neg_lo:[0,0,1] neg_hi:[0,0,1]
    v_pk_fma_f32 v[184:185], v[184:185], s[32:33], s[32:33] op_sel:[0,0,1] op_sel_hi:[1,0,1] neg_lo:[0,0,1] neg_hi:[0,0,1]
    v_pk_fma_f32 v[186:187], v[186:187], s[34:35], s[34:35] op_sel:[0,0,1] op_sel_hi:[1,0,1] neg_lo:[0,0,1] neg_hi:[0,0,1]
    v_cvt_pk_bf16_f32 v204, v172, v174
    v_cvt_pk_bf16_f32 v205, v176, v178
    v_cvt_pk_bf16_f32 v206, v180, v182
    v_cvt_pk_bf16_f32 v207, v184, v186
    buffer_store_dwordx4 v[204:207], v2, s[28:31], s57 offen offset:0 sc1
    v_cvt_pk_bf16_f32 v208, v173, v175
    v_cvt_pk_bf16_f32 v209, v177, v179
    v_cvt_pk_bf16_f32 v210, v181, v183
    v_cvt_pk_bf16_f32 v211, v185, v187
    buffer_store_dwordx4 v[208:211], v2, s[28:31], s57 offen offset:1024 sc1
    s_waitcnt vmcnt(11)
    s_branch L_sp_c
L_sp_g:
    s_waitcnt vmcnt(0)
L_sp_c:
    s_cmp_ge_u32 s56, 216
    s_cbranch_scc1 L_sp_d
    v_and_b32 v6, 15, v0
    v_lshrrev_b32 v7, 1, v6
    v_and_b32 v6, 1, v6
    v_lshlrev_b32 v6, 4, v6
    v_mov_b32 v8, 0x3f80
    v_lshlrev_b32 v6, v6, v8
    v_cmp_eq_u32 vcc, 0, v7
    s_nop 1
    v_cndmask_b32 v236, 0, v6, vcc
    v_cmp_eq_u32 vcc, 1, v7
    s_nop 1
    v_cndmask_b32 v237, 0, v6, vcc
    v_cmp_eq_u32 vcc, 2, v7
    s_nop 1
    v_cndmask_b32 v238, 0, v6, vcc
    v_cmp_eq_u32 vcc, 3, v7
    s_nop 1
    v_cndmask_b32 v239, 0, v6, vcc
    s_nop 1
    v_mfma_f32_16x16x32_bf16 v[240:243], v[16:19], v[236:239], 0
    v_mfma_f32_16x16x32_bf16 v[240:243], v[20:23], v[236:239], v[240:243]
    v_mfma_f32_16x16x32_bf16 v[240:243], v[24:27], v[236:239], v[240:243]
    v_mfma_f32_16x16x32_bf16 v[240:243], v[28:31], v[236:239], v[240:243]
    v_mfma_f32_16x16x32_bf16 v[240:243], v[32:35], v[236:239], v[240:243]
    v_mfma_f32_16x16x32_bf16 v[240:243], v[36:39], v[236:239], v[240:243]
    v_mfma_f32_16x16x32_bf16 v[240:243], v[40:43], v[236:239], v[240:243]
    v_mfma_f32_16x16x32_bf16 v[240:243], v[44:47], v[236:239], v[240:243]
    v_mfma_f32_16x16x32_bf16 v[240:243], v[48:51], v[236:239], v[240:243]
    v_mfma_f32_16x16x32_bf16 v[240:243], v[52:55], v[236:239], v[240:243]
    v_mfma_f32_16x16x32_bf16 v[240:243], v[56:59], v[236:239], v[240:243]
    v_mfma_f32_16x16x32_bf16 v[240:243], v[60:63], v[236:239], v[240:243]
    v_mfma_f32_16x16x32_bf16 v[240:243], v[64:67], v[236:239], v[240:243]
    v_mfma_f32_16x16x32_bf16 v[240:243], v[68:71], v[236:239], v[240:243]
    v_mfma_f32_16x16x32_bf16 v[240:243], v[72:75], v[236:239], v[240:243]
    v_mfma_f32_16x16x32_bf16 v[240:243], v[76:79], v[236:239], v[240:243]
    v_mfma_f32_16x16x32_bf16 v[240:243], v[80:83], v[236:239], v[240:243]
    v_mfma_f32_16x16x32_bf16 v[240:243], v[84:87], v[236:239], v[240:243]
    v_mfma_f32_16x16x32_bf16 v[240:243], v[88:91], v[236:239], v[240:243]
    v_mfma_f32_16x16x32_bf16 v[240:243], v[92:95], v[236:239], v[240:243]
    s_and_b32 s46, s56, 3
    s_mul_i32 s46, s46, 13824
    s_lshr_b32 s47, s56, 2
    s_lshl_b32 s47, s47, 8
    s_add_u32 s46, s46, s47
    s_add_u32 s46, s46, 0x20000
    v_bfe_u32 v2, v0, 4, 1
    v_lshlrev_b32 v2, 5, v2
    v_lshrrev_b32 v6, 5, v0
    v_lshl_add_u32 v2, v6, 4, v2
    v_and_b32 v6, 15, v0
    v_add_lshl_u32 v2, v2, v6, 2
    s_nop 7
    v_permlane32_swap_b32 v240, v242
    v_permlane32_swap_b32 v241, v243
    s_nop 0
    v_add_f32 v240, v240, v242
    v_add_f32 v241, v241, v243
    s_nop 1
    v_mov_b32_dpp v240, v241 row_shr:8 row_mask:0xf bank_mask:0xc
    buffer_store_dword v240, v2, s[28:31], s46 offen sc1
L_sp_d:
    v_mov_b32 v3, 0
    buffer_load_dword v3, v3, s[36:39], 0 offen sc1
    s_waitcnt vmcnt(0) lgkmcnt(0)
    v_readfirstlane_b32 s11, v3
    s_cmp_eq_u32 s11, 0
    s_cbranch_scc1 L_slow_sc_1
L_back_sc_1:
    s_barrier
    s_lshl_b32 s44, s54, 2
    s_add_u32 s44, s44, 0x0
    s_cmp_eq_u32 s3, 4
    s_cselect_b32 s45, 0, 0x20000000
    v_mov_b32 v252, s11
    v_mul_u32_u24 v253, 256, v0
    v_or_b32 v253, s45, v253
    s_mov_b64 exec, 0xff
    buffer_store_dword v252, v253, s[28:31], s44 offen sc1
    s_mov_b64 exec, -1
    s_mov_b32 s16, s84
    s_mov_b32 s17, s85
    s_mov_b32 s18, 0x21c000
    s_mov_b32 s19, 0x20000
    s_mov_b32 s20, s86
    s_mov_b32 s21, s87
    s_mov_b32 s22, 0x21c000
    s_mov_b32 s23, 0x20000
    s_mov_b32 s24, s88
    s_mov_b32 s25, s89
    s_mov_b32 s26, 0x21c000
    s_mov_b32 s27, 0x20000
    s_mul_i32 s26, s26, s58
    s_mov_b32 s32, s90
    s_mov_b32 s33, s91
    s_mov_b32 s34, 0x280000
    s_mov_b32 s35, 0x20000
    s_cmp_ge_u32 s3, 4
    s_cbranch_scc1 L_spare_aux
    v_mov_b32 v76, 0
    v_mov_b32 v77, 0
    v_mov_b32 v78, 0
    v_mov_b32 v79, 0
    v_mov_b32 v80, 0
    v_mov_b32 v81, 0
    v_mov_b32 v82, 0
    v_mov_b32 v83, 0
    v_mov_b32 v84, 0
    v_mov_b32 v85, 0
    v_mov_b32 v86, 0
    v_mov_b32 v87, 0
    v_mov_b32 v88, 0
    v_mov_b32 v89, 0
    v_mov_b32 v90, 0
    v_mov_b32 v91, 0
    s_mov_b32 s97, 0
    s_nop 7
    s_and_b32 s44, s3, 3
    s_mul_i32 s44, s44, 3072
    s_add_u32 s44, s44, 147456
    v_lshl_add_u32 v1, v0, 4, s44
    s_mov_b64 exec, 1
    v_add_f32 v76, s97, v76
    s_mov_b64 exec, -1
    v_mov_b32 v85, v86
    v_mov_b32 v86, v88
    v_mov_b32 v87, v90
    ds_write_b128 v1, v[76:79] offset:0
    ds_write_b128 v1, v[80:83] offset:1024
    ds_write_b128 v1, v[84:87] offset:2048
    s_mov_b32 s40, s88
    s_mov_b32 s41, s89
    s_mov_b32 s42, 0x21c000
    s_mov_b32 s43, 0x20000
    s_lshl_b32 s44, s54, 2
    s_add_u32 s44, s44, s3
    s_mul_i32 s44, s44, 13824
    v_lshl_add_u32 v1, v0, 7, s44
    s_mov_b32 exec_hi, 0x3fffff
    buffer_load_dword v16, v1, s[40:43], 0 offen
    v_add_u32 v1, 6912, v1
    buffer_load_dword v17, v1, s[40:43], 0 offen
    s_mov_b32 exec_hi, -1
    s_waitcnt vmcnt(0) lgkmcnt(0)
    s_barrier
    s_barrier
    s_branch L_m_post
L_spare_aux:
    s_and_b32 s44, s3, 3
    s_and_b32 s45, s44, 1
    s_lshl_b32 s45, s45, 1
    v_bfe_u32 v10, v0, 4, 1
    v_or_b32 v10, s45, v10
    v_lshlrev_b32 v10, 1, v10
    v_and_b32 v11, 7, v0
    v_xor_b32 v10, v10, v11
    v_lshrrev_b32 v11, 3, v0
    s_lshl_b32 s45, s44, 3
    v_add_u32 v11, s45, v11
    v_mul_u32_u24 v11, 1280, v11
    v_lshl_add_u32 v11, v10, 4, v11
    s_lshl_b32 s45, s7, 7
    v_add_u32 v6, s45, v11
    v_and_b32 v11, 15, v0
    v_cvt_f32_u32 v50, v11
    v_lshlrev_b32 v114, 16, v114
    v_lshlrev_b32 v108, 16, v108
    v_lshlrev_b32 v109, 16, v109
    v_lshlrev_b32 v110, 16, v110
    v_lshlrev_b32 v111, 16, v111
    v_lshlrev_b32 v112, 16, v112
    v_lshlrev_b32 v113, 16, v113
    v_lshlrev_b32 v115, 16, v115
    v_mul_f32 v114, 0x3fb8aa3b, v114
    v_exp_f32 v114, v114
    v_readlane_b32 s97, v115, 0
    v_readlane_b32 s98, v115, 8
    v_cvt_pk_bf16_f32 v114, v114, v114
    v_lshlrev_b32 v114, 16, v114
    v_mul_f32 v108, v114, v108
    v_mul_f32 v109, v114, v109
    v_mul_f32 v110, v114, v110
    v_mul_f32 v111, v114, v111
    v_mul_f32 v40, 0x3fb8aa3b, v108
    v_mul_f32 v109, 0x3e22f983, v109
    v_rndne_f32 v116, v109
    v_sub_f32 v41, v109, v116
    v_mul_f32 v42, v112, v110
    v_mul_f32 v43, v112, v111
    v_fma_f32 v42, -v113, v111, v42
    v_fmac_f32 v43, v113, v110
    s_and_b32 s44, s3, 3
    s_cmp_eq_u32 s44, 0
    s_cselect_b32 s97, s97, 0
    s_cselect_b32 s98, s98, 0
    v_mul_f32 v117, 0x43800000, v41
    v_mul_f32 v116, 0x43800000, v40
    v_fract_f32 v117, v117
    v_exp_f32 v116, v116
    v_cos_f32 v118, v117
    v_sin_f32 v119, v117
    s_nop 0
    v_mul_f32 v118, v116, v118
    v_mul_f32 v119, v116, v119
    v_mul_f32 v44, v42, v118
    v_mul_f32 v45, v42, v119
    v_fma_f32 v44, -v43, v119, v44
    v_fmac_f32 v45, v43, v118
    v_mul_f32 v117, 0x44000000, v41
    v_mul_f32 v116, 0x44000000, v40
    v_fract_f32 v117, v117
    v_exp_f32 v116, v116
    v_cos_f32 v118, v117
    v_sin_f32 v119, v117
    s_nop 0
    v_mul_f32 v118, v116, v118
    v_mul_f32 v119, v116, v119
    v_mul_f32 v46, v42, v118
    v_mul_f32 v47, v42, v119
    v_fma_f32 v46, -v43, v119, v46
    v_fmac_f32 v47, v43, v118
    v_mul_f32 v117, 0x44c00000, v41
    v_mul_f32 v116, 0x44c00000, v40
    v_fract_f32 v117, v117
    v_exp_f32 v116, v116
    v_cos_f32 v118, v117
    v_sin_f32 v119, v117
    s_nop 0
    v_mul_f32 v118, v116, v118
    v_mul_f32 v119, v116, v119
    v_mul_f32 v48, v42, v118
    v_mul_f32 v49, v42, v119
    v_fma_f32 v48, -v43, v119, v48
    v_fmac_f32 v49, v43, v118
    v_mul_f32_dpp v121, v40, v50 row_newbcast:0 row_mask:0xf bank_mask:0xf
    v_mul_f32_dpp v127, v40, v50 row_newbcast:1 row_mask:0xf bank_mask:0xf
    v_mul_f32_dpp v120, v41, v50 row_newbcast:0 row_mask:0xf bank_mask:0xf
    v_mul_f32_dpp v126, v41, v50 row_newbcast:1 row_mask:0xf bank_mask:0xf
    v_exp_f32 v121, v121
    v_exp_f32 v127, v127
    v_cos_f32 v122, v120
    v_cos_f32 v128, v126
    v_sin_f32 v123, v120
    v_sin_f32 v129, v126
    v_mul_f32 v122, v121, v122
    v_mul_f32 v128, v127, v128
    v_mul_f32 v123, v121, v123
    v_mul_f32 v129, v127, v129
    v_cvt_pk_bf16_f32 v52, v122, v123
    v_cvt_pk_bf16_f32 v53, v128, v129
    v_pk_mul_f32 v[124:125], v[122:123], v[122:123] op_sel:[1,1] op_sel_hi:[0,1]
    v_pk_mul_f32 v[130:131], v[128:129], v[128:129] op_sel:[1,1] op_sel_hi:[0,1]
    v_pk_fma_f32 v[122:123], v[122:123], v[122:123], v[124:125] op_sel:[0,0,0] op_sel_hi:[0,1,1] neg_lo:[0,0,1]
    v_pk_fma_f32 v[128:129], v[128:129], v[128:129], v[130:131] op_sel:[0,0,0] op_sel_hi:[0,1,1] neg_lo:[0,0,1]
    v_pk_mul_f32 v[124:125], v[122:123], v[122:123] op_sel:[1,1] op_sel_hi:[0,1]
    v_pk_mul_f32 v[130:131], v[128:129], v[128:129] op_sel:[1,1] op_sel_hi:[0,1]
    v_pk_fma_f32 v[122:123], v[122:123], v[122:123], v[124:125] op_sel:[0,0,0] op_sel_hi:[0,1,1] neg_lo:[0,0,1]
    v_pk_fma_f32 v[128:129], v[128:129], v[128:129], v[130:131] op_sel:[0,0,0] op_sel_hi:[0,1,1] neg_lo:[0,0,1]
    v_cvt_pk_bf16_f32 v56, v122, v123
    v_cvt_pk_bf16_f32 v57, v128, v129
    v_pk_mul_f32 v[124:125], v[122:123], v[122:123] op_sel:[1,1] op_sel_hi:[0,1]
    v_pk_mul_f32 v[130:131], v[128:129], v[128:129] op_sel:[1,1] op_sel_hi:[0,1]
    v_pk_fma_f32 v[122:123], v[122:123], v[122:123], v[124:125] op_sel:[0,0,0] op_sel_hi:[0,1,1] neg_lo:[0,0,1]
    v_pk_fma_f32 v[128:129], v[128:129], v[128:129], v[130:131] op_sel:[0,0,0] op_sel_hi:[0,1,1] neg_lo:[0,0,1]
    v_pk_mul_f32 v[124:125], v[122:123], v[122:123] op_sel:[1,1] op_sel_hi:[0,1]
    v_pk_mul_f32 v[130:131], v[128:129], v[128:129] op_sel:[1,1] op_sel_hi:[0,1]
    v_pk_fma_f32 v[122:123], v[122:123], v[122:123], v[124:125] op_sel:[0,0,0] op_sel_hi:[0,1,1] neg_lo:[0,0,1]
    v_pk_fma_f32 v[128:129], v[128:129], v[128:129], v[130:131] op_sel:[0,0,0] op_sel_hi:[0,1,1] neg_lo:[0,0,1]
    v_mul_f32_dpp v124, v42, v122 row_newbcast:0 row_mask:0xf bank_mask:0xf
    v_mul_f32_dpp v130, v42, v128 row_newbcast:1 row_mask:0xf bank_mask:0xf
    v_mul_f32_dpp v125, -v42, v123 row_newbcast:0 row_mask:0xf bank_mask:0xf
    v_mul_f32_dpp v131, -v42, v129 row_newbcast:1 row_mask:0xf bank_mask:0xf
    v_fmac_f32_dpp v124, -v43, v123 row_newbcast:0 row_mask:0xf bank_mask:0xf
    v_fmac_f32_dpp v130, -v43, v129 row_newbcast:1 row_mask:0xf bank_mask:0xf
    v_fmac_f32_dpp v125, -v43, v122 row_newbcast:0 row_mask:0xf bank_mask:0xf
    v_fmac_f32_dpp v131, -v43, v128 row_newbcast:1 row_mask:0xf bank_mask:0xf
    v_cvt_pk_bf16_f32 v60, v124, v125
    v_cvt_pk_bf16_f32 v61, v130, v131
    v_mul_f32_dpp v124, v44, v122 row_newbcast:0 row_mask:0xf bank_mask:0xf
    v_mul_f32_dpp v130, v44, v128 row_newbcast:1 row_mask:0xf bank_mask:0xf
    v_mul_f32_dpp v125, -v44, v123 row_newbcast:0 row_mask:0xf bank_mask:0xf
    v_mul_f32_dpp v131, -v44, v129 row_newbcast:1 row_mask:0xf bank_mask:0xf
    v_fmac_f32_dpp v124, -v45, v123 row_newbcast:0 row_mask:0xf bank_mask:0xf
    v_fmac_f32_dpp v130, -v45, v129 row_newbcast:1 row_mask:0xf bank_mask:0xf
    v_fmac_f32_dpp v125, -v45, v122 row_newbcast:0 row_mask:0xf bank_mask:0xf
    v_fmac_f32_dpp v131, -v45, v128 row_newbcast:1 row_mask:0xf bank_mask:0xf
    v_cvt_pk_bf16_f32 v64, v124, v125
    v_cvt_pk_bf16_f32 v65, v130, v131
    v_pk_mul_f32 v[124:125], v[122:123], v[122:123] op_sel:[1,1] op_sel_hi:[0,1]
    v_pk_mul_f32 v[130:131], v[128:129], v[128:129] op_sel:[1,1] op_sel_hi:[0,1]
    v_pk_fma_f32 v[122:123], v[122:123], v[122:123], v[124:125] op_sel:[0,0,0] op_sel_hi:[0,1,1] neg_lo:[0,0,1]
    v_pk_fma_f32 v[128:129], v[128:129], v[128:129], v[130:131] op_sel:[0,0,0] op_sel_hi:[0,1,1] neg_lo:[0,0,1]
    v_pk_mul_f32 v[124:125], v[122:123], v[122:123] op_sel:[1,1] op_sel_hi:[0,1]
    v_pk_mul_f32 v[130:131], v[128:129], v[128:129] op_sel:[1,1] op_sel_hi:[0,1]
    v_pk_fma_f32 v[122:123], v[122:123], v[122:123], v[124:125] op_sel:[0,0,0] op_sel_hi:[0,1,1] neg_lo:[0,0,1]
    v_pk_fma_f32 v[128:129], v[128:129], v[128:129], v[130:131] op_sel:[0,0,0] op_sel_hi:[0,1,1] neg_lo:[0,0,1]
    v_mul_f32_dpp v124, v46, v122 row_newbcast:0 row_mask:0xf bank_mask:0xf
    v_mul_f32_dpp v130, v46, v128 row_newbcast:1 row_mask:0xf bank_mask:0xf
    v_mul_f32_dpp v125, -v46, v123 row_newbcast:0 row_mask:0xf bank_mask:0xf
    v_mul_f32_dpp v131, -v46, v129 row_newbcast:1 row_mask:0xf bank_mask:0xf
    v_fmac_f32_dpp v124, -v47, v123 row_newbcast:0 row_mask:0xf bank_mask:0xf
    v_fmac_f32_dpp v130, -v47, v129 row_newbcast:1 row_mask:0xf bank_mask:0xf
    v_fmac_f32_dpp v125, -v47, v122 row_newbcast:0 row_mask:0xf bank_mask:0xf
    v_fmac_f32_dpp v131, -v47, v128 row_newbcast:1 row_mask:0xf bank_mask:0xf
    v_cvt_pk_bf16_f32 v68, v124, v125
    v_cvt_pk_bf16_f32 v69, v130, v131
    v_mul_f32_dpp v124, v48, v122 row_newbcast:0 row_mask:0xf bank_mask:0xf
    v_mul_f32_dpp v130, v48, v128 row_newbcast:1 row_mask:0xf bank_mask:0xf
    v_mul_f32_dpp v125, -v48, v123 row_newbcast:0 row_mask:0xf bank_mask:0xf
    v_mul_f32_dpp v131, -v48, v129 row_newbcast:1 row_mask:0xf bank_mask:0xf
    v_fmac_f32_dpp v124, -v49, v123 row_newbcast:0 row_mask:0xf bank_mask:0xf
    v_fmac_f32_dpp v130, -v49, v129 row_newbcast:1 row_mask:0xf bank_mask:0xf
    v_fmac_f32_dpp v125, -v49, v122 row_newbcast:0 row_mask:0xf bank_mask:0xf
    v_fmac_f32_dpp v131, -v49, v128 row_newbcast:1 row_mask:0xf bank_mask:0xf
    v_cvt_pk_bf16_f32 v72, v124, v125
    v_cvt_pk_bf16_f32 v73, v130, v131
    v_mul_f32_dpp v121, v40, v50 row_newbcast:2 row_mask:0xf bank_mask:0xf
    v_mul_f32_dpp v127, v40, v50 row_newbcast:3 row_mask:0xf bank_mask:0xf
    v_mul_f32_dpp v120, v41, v50 row_newbcast:2 row_mask:0xf bank_mask:0xf
    v_mul_f32_dpp v126, v41, v50 row_newbcast:3 row_mask:0xf bank_mask:0xf
    v_exp_f32 v121, v121
    v_exp_f32 v127, v127
    v_cos_f32 v122, v120
    v_cos_f32 v128, v126
    v_sin_f32 v123, v120
    v_sin_f32 v129, v126
    v_mul_f32 v122, v121, v122
    v_mul_f32 v128, v127, v128
    v_mul_f32 v123, v121, v123
    v_mul_f32 v129, v127, v129
    v_cvt_pk_bf16_f32 v54, v122, v123
    v_cvt_pk_bf16_f32 v55, v128, v129
    v_pk_mul_f32 v[124:125], v[122:123], v[122:123] op_sel:[1,1] op_sel_hi:[0,1]
    v_pk_mul_f32 v[130:131], v[128:129], v[128:129] op_sel:[1,1] op_sel_hi:[0,1]
    v_pk_fma_f32 v[122:123], v[122:123], v[122:123], v[124:125] op_sel:[0,0,0] op_sel_hi:[0,1,1] neg_lo:[0,0,1]
    v_pk_fma_f32 v[128:129], v[128:129], v[128:129], v[130:131] op_sel:[0,0,0] op_sel_hi:[0,1,1] neg_lo:[0,0,1]
    v_pk_mul_f32 v[124:125], v[122:123], v[122:123] op_sel:[1,1] op_sel_hi:[0,1]
    v_pk_mul_f32 v[130:131], v[128:129], v[128:129] op_sel:[1,1] op_sel_hi:[0,1]
    v_pk_fma_f32 v[122:123], v[122:123], v[122:123], v[124:125] op_sel:[0,0,0] op_sel_hi:[0,1,1] neg_lo:[0,0,1]
    v_pk_fma_f32 v[128:129], v[128:129], v[128:129], v[130:131] op_sel:[0,0,0] op_sel_hi:[0,1,1] neg_lo:[0,0,1]
    v_cvt_pk_bf16_f32 v58, v122, v123
    v_cvt_pk_bf16_f32 v59, v128, v129
    v_pk_mul_f32 v[124:125], v[122:123], v[122:123] op_sel:[1,1] op_sel_hi:[0,1]
    v_pk_mul_f32 v[130:131], v[128:129], v[128:129] op_sel:[1,1] op_sel_hi:[0,1]
    v_pk_fma_f32 v[122:123], v[122:123], v[122:123], v[124:125] op_sel:[0,0,0] op_sel_hi:[0,1,1] neg_lo:[0,0,1]
    v_pk_fma_f32 v[128:129], v[128:129], v[128:129], v[130:131] op_sel:[0,0,0] op_sel_hi:[0,1,1] neg_lo:[0,0,1]
    v_pk_mul_f32 v[124:125], v[122:123], v[122:123] op_sel:[1,1] op_sel_hi:[0,1]
    v_pk_mul_f32 v[130:131], v[128:129], v[128:129] op_sel:[1,1] op_sel_hi:[0,1]
    v_pk_fma_f32 v[122:123], v[122:123], v[122:123], v[124:125] op_sel:[0,0,0] op_sel_hi:[0,1,1] neg_lo:[0,0,1]
    v_pk_fma_f32 v[128:129], v[128:129], v[128:129], v[130:131] op_sel:[0,0,0] op_sel_hi:[0,1,1] neg_lo:[0,0,1]
    v_mul_f32_dpp v124, v42, v122 row_newbcast:2 row_mask:0xf bank_mask:0xf
    v_mul_f32_dpp v130, v42, v128 row_newbcast:3 row_mask:0xf bank_mask:0xf
    v_mul_f32_dpp v125, -v42, v123 row_newbcast:2 row_mask:0xf bank_mask:0xf
    v_mul_f32_dpp v131, -v42, v129 row_newbcast:3 row_mask:0xf bank_mask:0xf
    v_fmac_f32_dpp v124, -v43, v123 row_newbcast:2 row_mask:0xf bank_mask:0xf
    v_fmac_f32_dpp v130, -v43, v129 row_newbcast:3 row_mask:0xf bank_mask:0xf
    v_fmac_f32_dpp v125, -v43, v122 row_newbcast:2 row_mask:0xf bank_mask:0xf
    v_fmac_f32_dpp v131, -v43, v128 row_newbcast:3 row_mask:0xf bank_mask:0xf
    v_cvt_pk_bf16_f32 v62, v124, v125
    v_cvt_pk_bf16_f32 v63, v130, v131
    v_mul_f32_dpp v124, v44, v122 row_newbcast:2 row_mask:0xf bank_mask:0xf
    v_mul_f32_dpp v130, v44, v128 row_newbcast:3 row_mask:0xf bank_mask:0xf
    v_mul_f32_dpp v125, -v44, v123 row_newbcast:2 row_mask:0xf bank_mask:0xf
    v_mul_f32_dpp v131, -v44, v129 row_newbcast:3 row_mask:0xf bank_mask:0xf
    v_fmac_f32_dpp v124, -v45, v123 row_newbcast:2 row_mask:0xf bank_mask:0xf
    v_fmac_f32_dpp v130, -v45, v129 row_newbcast:3 row_mask:0xf bank_mask:0xf
    v_fmac_f32_dpp v125, -v45, v122 row_newbcast:2 row_mask:0xf bank_mask:0xf
    v_fmac_f32_dpp v131, -v45, v128 row_newbcast:3 row_mask:0xf bank_mask:0xf
    v_cvt_pk_bf16_f32 v66, v124, v125
    v_cvt_pk_bf16_f32 v67, v130, v131
    v_pk_mul_f32 v[124:125], v[122:123], v[122:123] op_sel:[1,1] op_sel_hi:[0,1]
    v_pk_mul_f32 v[130:131], v[128:129], v[128:129] op_sel:[1,1] op_sel_hi:[0,1]
    v_pk_fma_f32 v[122:123], v[122:123], v[122:123], v[124:125] op_sel:[0,0,0] op_sel_hi:[0,1,1] neg_lo:[0,0,1]
    v_pk_fma_f32 v[128:129], v[128:129], v[128:129], v[130:131] op_sel:[0,0,0] op_sel_hi:[0,1,1] neg_lo:[0,0,1]
    v_pk_mul_f32 v[124:125], v[122:123], v[122:123] op_sel:[1,1] op_sel_hi:[0,1]
    v_pk_mul_f32 v[130:131], v[128:129], v[128:129] op_sel:[1,1] op_sel_hi:[0,1]
    v_pk_fma_f32 v[122:123], v[122:123], v[122:123], v[124:125] op_sel:[0,0,0] op_sel_hi:[0,1,1] neg_lo:[0,0,1]
    v_pk_fma_f32 v[128:129], v[128:129], v[128:129], v[130:131] op_sel:[0,0,0] op_sel_hi:[0,1,1] neg_lo:[0,0,1]
    v_mul_f32_dpp v124, v46, v122 row_newbcast:2 row_mask:0xf bank_mask:0xf
    v_mul_f32_dpp v130, v46, v128 row_newbcast:3 row_mask:0xf bank_mask:0xf
    v_mul_f32_dpp v125, -v46, v123 row_newbcast:2 row_mask:0xf bank_mask:0xf
    v_mul_f32_dpp v131, -v46, v129 row_newbcast:3 row_mask:0xf bank_mask:0xf
    v_fmac_f32_dpp v124, -v47, v123 row_newbcast:2 row_mask:0xf bank_mask:0xf
    v_fmac_f32_dpp v130, -v47, v129 row_newbcast:3 row_mask:0xf bank_mask:0xf
    v_fmac_f32_dpp v125, -v47, v122 row_newbcast:2 row_mask:0xf bank_mask:0xf
    v_fmac_f32_dpp v131, -v47, v128 row_newbcast:3 row_mask:0xf bank_mask:0xf
    v_cvt_pk_bf16_f32 v70, v124, v125
    v_cvt_pk_bf16_f32 v71, v130, v131
    v_mul_f32_dpp v124, v48, v122 row_newbcast:2 row_mask:0xf bank_mask:0xf
    v_mul_f32_dpp v130, v48, v128 row_newbcast:3 row_mask:0xf bank_mask:0xf
    v_mul_f32_dpp v125, -v48, v123 row_newbcast:2 row_mask:0xf bank_mask:0xf
    v_mul_f32_dpp v131, -v48, v129 row_newbcast:3 row_mask:0xf bank_mask:0xf
    v_fmac_f32_dpp v124, -v49, v123 row_newbcast:2 row_mask:0xf bank_mask:0xf
    v_fmac_f32_dpp v130, -v49, v129 row_newbcast:3 row_mask:0xf bank_mask:0xf
    v_fmac_f32_dpp v125, -v49, v122 row_newbcast:2 row_mask:0xf bank_mask:0xf
    v_fmac_f32_dpp v131, -v49, v128 row_newbcast:3 row_mask:0xf bank_mask:0xf
    v_cvt_pk_bf16_f32 v74, v124, v125
    v_cvt_pk_bf16_f32 v75, v130, v131
    s_nop 1
    v_mfma_f32_16x16x32_bf16 v[76:79], v[52:55], v[60:63], 0
    v_mfma_f32_16x16x32_bf16 v[84:87], v[52:55], v[64:67], 0
    v_mfma_f32_16x16x32_bf16 v[80:83], v[56:59], v[68:71], 0
    v_mfma_f32_16x16x32_bf16 v[88:91], v[56:59], v[72:75], 0
    v_mul_f32_dpp v121, v40, v50 row_newbcast:4 row_mask:0xf bank_mask:0xf
    v_mul_f32_dpp v127, v40, v50 row_newbcast:5 row_mask:0xf bank_mask:0xf
    v_mul_f32_dpp v120, v41, v50 row_newbcast:4 row_mask:0xf bank_mask:0xf
    v_mul_f32_dpp v126, v41, v50 row_newbcast:5 row_mask:0xf bank_mask:0xf
    v_exp_f32 v121, v121
    v_exp_f32 v127, v127
    v_cos_f32 v122, v120
    v_cos_f32 v128, v126
    v_sin_f32 v123, v120
    v_sin_f32 v129, v126
    v_mul_f32 v122, v121, v122
    v_mul_f32 v128, v127, v128
    v_mul_f32 v123, v121, v123
    v_mul_f32 v129, v127, v129
    v_cvt_pk_bf16_f32 v52, v122, v123
    v_cvt_pk_bf16_f32 v53, v128, v129
    v_pk_mul_f32 v[124:125], v[122:123], v[122:123] op_sel:[1,1] op_sel_hi:[0,1]
    v_pk_mul_f32 v[130:131], v[128:129], v[128:129] op_sel:[1,1] op_sel_hi:[0,1]
    v_pk_fma_f32 v[122:123], v[122:123], v[122:123], v[124:125] op_sel:[0,0,0] op_sel_hi:[0,1,1] neg_lo:[0,0,1]
    v_pk_fma_f32 v[128:129], v[128:129], v[128:129], v[130:131] op_sel:[0,0,0] op_sel_hi:[0,1,1] neg_lo:[0,0,1]
    v_pk_mul_f32 v[124:125], v[122:123], v[122:123] op_sel:[1,1] op_sel_hi:[0,1]
    v_pk_mul_f32 v[130:131], v[128:129], v[128:129] op_sel:[1,1] op_sel_hi:[0,1]
    v_pk_fma_f32 v[122:123], v[122:123], v[122:123], v[124:125] op_sel:[0,0,0] op_sel_hi:[0,1,1] neg_lo:[0,0,1]
    v_pk_fma_f32 v[128:129], v[128:129], v[128:129], v[130:131] op_sel:[0,0,0] op_sel_hi:[0,1,1] neg_lo:[0,0,1]
    v_cvt_pk_bf16_f32 v56, v122, v123
    v_cvt_pk_bf16_f32 v57, v128, v129
    v_pk_mul_f32 v[124:125], v[122:123], v[122:123] op_sel:[1,1] op_sel_hi:[0,1]
    v_pk_mul_f32 v[130:131], v[128:129], v[128:129] op_sel:[1,1] op_sel_hi:[0,1]
    v_pk_fma_f32 v[122:123], v[122:123], v[122:123], v[124:125] op_sel:[0,0,0] op_sel_hi:[0,1,1] neg_lo:[0,0,1]
    v_pk_fma_f32 v[128:129], v[128:129], v[128:129], v[130:131] op_sel:[0,0,0] op_sel_hi:[0,1,1] neg_lo:[0,0,1]
    v_pk_mul_f32 v[124:125], v[122:123], v[122:123] op_sel:[1,1] op_sel_hi:[0,1]
    v_pk_mul_f32 v[130:131], v[128:129], v[128:129] op_sel:[1,1] op_sel_hi:[0,1]
    v_pk_fma_f32 v[122:123], v[122:123], v[122:123], v[124:125] op_sel:[0,0,0] op_sel_hi:[0,1,1] neg_lo:[0,0,1]
    v_pk_fma_f32 v[128:129], v[128:129], v[128:129], v[130:131] op_sel:[0,0,0] op_sel_hi:[0,1,1] neg_lo:[0,0,1]
    v_mul_f32_dpp v124, v42, v122 row_newbcast:4 row_mask:0xf bank_mask:0xf
    v_mul_f32_dpp v130, v42, v128 row_newbcast:5 row_mask:0xf bank_mask:0xf
    v_mul_f32_dpp v125, -v42, v123 row_newbcast:4 row_mask:0xf bank_mask:0xf
    v_mul_f32_dpp v131, -v42, v129 row_newbcast:5 row_mask:0xf bank_mask:0xf
    v_fmac_f32_dpp v124, -v43, v123 row_newbcast:4 row_mask:0xf bank_mask:0xf
    v_fmac_f32_dpp v130, -v43, v129 row_newbcast:5 row_mask:0xf bank_mask:0xf
    v_fmac_f32_dpp v125, -v43, v122 row_newbcast:4 row_mask:0xf bank_mask:0xf
    v_fmac_f32_dpp v131, -v43, v128 row_newbcast:5 row_mask:0xf bank_mask:0xf
    v_cvt_pk_bf16_f32 v60, v124, v125
    v_cvt_pk_bf16_f32 v61, v130, v131
    v_mul_f32_dpp v124, v44, v122 row_newbcast:4 row_mask:0xf bank_mask:0xf
    v_mul_f32_dpp v130, v44, v128 row_newbcast:5 row_mask:0xf bank_mask:0xf
    v_mul_f32_dpp v125, -v44, v123 row_newbcast:4 row_mask:0xf bank_mask:0xf
    v_mul_f32_dpp v131, -v44, v129 row_newbcast:5 row_mask:0xf bank_mask:0xf
    v_fmac_f32_dpp v124, -v45, v123 row_newbcast:4 row_mask:0xf bank_mask:0xf
    v_fmac_f32_dpp v130, -v45, v129 row_newbcast:5 row_mask:0xf bank_mask:0xf
    v_fmac_f32_dpp v125, -v45, v122 row_newbcast:4 row_mask:0xf bank_mask:0xf
    v_fmac_f32_dpp v131, -v45, v128 row_newbcast:5 row_mask:0xf bank_mask:0xf
    v_cvt_pk_bf16_f32 v64, v124, v125
    v_cvt_pk_bf16_f32 v65, v130, v131
    v_pk_mul_f32 v[124:125], v[122:123], v[122:123] op_sel:[1,1] op_sel_hi:[0,1]
    v_pk_mul_f32 v[130:131], v[128:129], v[128:129] op_sel:[1,1] op_sel_hi:[0,1]
    v_pk_fma_f32 v[122:123], v[122:123], v[122:123], v[124:125] op_sel:[0,0,0] op_sel_hi:[0,1,1] neg_lo:[0,0,1]
    v_pk_fma_f32 v[128:129], v[128:129], v[128:129], v[130:131] op_sel:[0,0,0] op_sel_hi:[0,1,1] neg_lo:[0,0,1]
    v_pk_mul_f32 v[124:125], v[122:123], v[122:123] op_sel:[1,1] op_sel_hi:[0,1]
    v_pk_mul_f32 v[130:131], v[128:129], v[128:129] op_sel:[1,1] op_sel_hi:[0,1]
    v_pk_fma_f32 v[122:123], v[122:123], v[122:123], v[124:125] op_sel:[0,0,0] op_sel_hi:[0,1,1] neg_lo:[0,0,1]
    v_pk_fma_f32 v[128:129], v[128:129], v[128:129], v[130:131] op_sel:[0,0,0] op_sel_hi:[0,1,1] neg_lo:[0,0,1]
    v_mul_f32_dpp v124, v46, v122 row_newbcast:4 row_mask:0xf bank_mask:0xf
    v_mul_f32_dpp v130, v46, v128 row_newbcast:5 row_mask:0xf bank_mask:0xf
    v_mul_f32_dpp v125, -v46, v123 row_newbcast:4 row_mask:0xf bank_mask:0xf
    v_mul_f32_dpp v131, -v46, v129 row_newbcast:5 row_mask:0xf bank_mask:0xf
    v_fmac_f32_dpp v124, -v47, v123 row_newbcast:4 row_mask:0xf bank_mask:0xf
    v_fmac_f32_dpp v130, -v47, v129 row_newbcast:5 row_mask:0xf bank_mask:0xf
    v_fmac_f32_dpp v125, -v47, v122 row_newbcast:4 row_mask:0xf bank_mask:0xf
    v_fmac_f32_dpp v131, -v47, v128 row_newbcast:5 row_mask:0xf bank_mask:0xf
    v_cvt_pk_bf16_f32 v68, v124, v125
    v_cvt_pk_bf16_f32 v69, v130, v131
    v_mul_f32_dpp v124, v48, v122 row_newbcast:4 row_mask:0xf bank_mask:0xf
    v_mul_f32_dpp v130, v48, v128 row_newbcast:5 row_mask:0xf bank_mask:0xf
    v_mul_f32_dpp v125, -v48, v123 row_newbcast:4 row_mask:0xf bank_mask:0xf
    v_mul_f32_dpp v131, -v48, v129 row_newbcast:5 row_mask:0xf bank_mask:0xf
    v_fmac_f32_dpp v124, -v49, v123 row_newbcast:4 row_mask:0xf bank_mask:0xf
    v_fmac_f32_dpp v130, -v49, v129 row_newbcast:5 row_mask:0xf bank_mask:0xf
    v_fmac_f32_dpp v125, -v49, v122 row_newbcast:4 row_mask:0xf bank_mask:0xf
    v_fmac_f32_dpp v131, -v49, v128 row_newbcast:5 row_mask:0xf bank_mask:0xf
    v_cvt_pk_bf16_f32 v72, v124, v125
    v_cvt_pk_bf16_f32 v73, v130, v131
    v_mul_f32_dpp v121, v40, v50 row_newbcast:6 row_mask:0xf bank_mask:0xf
    v_mul_f32_dpp v127, v40, v50 row_newbcast:7 row_mask:0xf bank_mask:0xf
    v_mul_f32_dpp v120, v41, v50 row_newbcast:6 row_mask:0xf bank_mask:0xf
    v_mul_f32_dpp v126, v41, v50 row_newbcast:7 row_mask:0xf bank_mask:0xf
    v_exp_f32 v121, v121
    v_exp_f32 v127, v127
    v_cos_f32 v122, v120
    v_cos_f32 v128, v126
    v_sin_f32 v123, v120
    v_sin_f32 v129, v126
    v_mul_f32 v122, v121, v122
    v_mul_f32 v128, v127, v128
    v_mul_f32 v123, v121, v123
    v_mul_f32 v129, v127, v129
    v_cvt_pk_bf16_f32 v54, v122, v123
    v_cvt_pk_bf16_f32 v55, v128, v129
    v_pk_mul_f32 v[124:125], v[122:123], v[122:123] op_sel:[1,1] op_sel_hi:[0,1]
    v_pk_mul_f32 v[130:131], v[128:129], v[128:129] op_sel:[1,1] op_sel_hi:[0,1]
    v_pk_fma_f32 v[122:123], v[122:123], v[122:123], v[124:125] op_sel:[0,0,0] op_sel_hi:[0,1,1] neg_lo:[0,0,1]
    v_pk_fma_f32 v[128:129], v[128:129], v[128:129], v[130:131] op_sel:[0,0,0] op_sel_hi:[0,1,1] neg_lo:[0,0,1]
    v_pk_mul_f32 v[124:125], v[122:123], v[122:123] op_sel:[1,1] op_sel_hi:[0,1]
    v_pk_mul_f32 v[130:131], v[128:129], v[128:129] op_sel:[1,1] op_sel_hi:[0,1]
    v_pk_fma_f32 v[122:123], v[122:123], v[122:123], v[124:125] op_sel:[0,0,0] op_sel_hi:[0,1,1] neg_lo:[0,0,1]
    v_pk_fma_f32 v[128:129], v[128:129], v[128:129], v[130:131] op_sel:[0,0,0] op_sel_hi:[0,1,1] neg_lo:[0,0,1]
    v_cvt_pk_bf16_f32 v58, v122, v123
    v_cvt_pk_bf16_f32 v59, v128, v129
    v_pk_mul_f32 v[124:125], v[122:123], v[122:123] op_sel:[1,1] op_sel_hi:[0,1]
    v_pk_mul_f32 v[130:131], v[128:129], v[128:129] op_sel:[1,1] op_sel_hi:[0,1]
    v_pk_fma_f32 v[122:123], v[122:123], v[122:123], v[124:125] op_sel:[0,0,0] op_sel_hi:[0,1,1] neg_lo:[0,0,1]
    v_pk_fma_f32 v[128:129], v[128:129], v[128:129], v[130:131] op_sel:[0,0,0] op_sel_hi:[0,1,1] neg_lo:[0,0,1]
    v_pk_mul_f32 v[124:125], v[122:123], v[122:123] op_sel:[1,1] op_sel_hi:[0,1]
    v_pk_mul_f32 v[130:131], v[128:129], v[128:129] op_sel:[1,1] op_sel_hi:[0,1]
    v_pk_fma_f32 v[122:123], v[122:123], v[122:123], v[124:125] op_sel:[0,0,0] op_sel_hi:[0,1,1] neg_lo:[0,0,1]
    v_pk_fma_f32 v[128:129], v[128:129], v[128:129], v[130:131] op_sel:[0,0,0] op_sel_hi:[0,1,1] neg_lo:[0,0,1]
    v_mul_f32_dpp v124, v42, v122 row_newbcast:6 row_mask:0xf bank_mask:0xf
    v_mul_f32_dpp v130, v42, v128 row_newbcast:7 row_mask:0xf bank_mask:0xf
    v_mul_f32_dpp v125, -v42, v123 row_newbcast:6 row_mask:0xf bank_mask:0xf
    v_mul_f32_dpp v131, -v42, v129 row_newbcast:7 row_mask:0xf bank_mask:0xf
    v_fmac_f32_dpp v124, -v43, v123 row_newbcast:6 row_mask:0xf bank_mask:0xf
    v_fmac_f32_dpp v130, -v43, v129 row_newbcast:7 row_mask:0xf bank_mask:0xf
    v_fmac_f32_dpp v125, -v43, v122 row_newbcast:6 row_mask:0xf bank_mask:0xf
    v_fmac_f32_dpp v131, -v43, v128 row_newbcast:7 row_mask:0xf bank_mask:0xf
    v_cvt_pk_bf16_f32 v62, v124, v125
    v_cvt_pk_bf16_f32 v63, v130, v131
    v_mul_f32_dpp v124, v44, v122 row_newbcast:6 row_mask:0xf bank_mask:0xf
    v_mul_f32_dpp v130, v44, v128 row_newbcast:7 row_mask:0xf bank_mask:0xf
    v_mul_f32_dpp v125, -v44, v123 row_newbcast:6 row_mask:0xf bank_mask:0xf
    v_mul_f32_dpp v131, -v44, v129 row_newbcast:7 row_mask:0xf bank_mask:0xf
    v_fmac_f32_dpp v124, -v45, v123 row_newbcast:6 row_mask:0xf bank_mask:0xf
    v_fmac_f32_dpp v130, -v45, v129 row_newbcast:7 row_mask:0xf bank_mask:0xf
    v_fmac_f32_dpp v125, -v45, v122 row_newbcast:6 row_mask:0xf bank_mask:0xf
    v_fmac_f32_dpp v131, -v45, v128 row_newbcast:7 row_mask:0xf bank_mask:0xf
    v_cvt_pk_bf16_f32 v66, v124, v125
    v_cvt_pk_bf16_f32 v67, v130, v131
    v_pk_mul_f32 v[124:125], v[122:123], v[122:123] op_sel:[1,1] op_sel_hi:[0,1]
    v_pk_mul_f32 v[130:131], v[128:129], v[128:129] op_sel:[1,1] op_sel_hi:[0,1]
    v_pk_fma_f32 v[122:123], v[122:123], v[122:123], v[124:125] op_sel:[0,0,0] op_sel_hi:[0,1,1] neg_lo:[0,0,1]
    v_pk_fma_f32 v[128:129], v[128:129], v[128:129], v[130:131] op_sel:[0,0,0] op_sel_hi:[0,1,1] neg_lo:[0,0,1]
    v_pk_mul_f32 v[124:125], v[122:123], v[122:123] op_sel:[1,1] op_sel_hi:[0,1]
    v_pk_mul_f32 v[130:131], v[128:129], v[128:129] op_sel:[1,1] op_sel_hi:[0,1]
    v_pk_fma_f32 v[122:123], v[122:123], v[122:123], v[124:125] op_sel:[0,0,0] op_sel_hi:[0,1,1] neg_lo:[0,0,1]
    v_pk_fma_f32 v[128:129], v[128:129], v[128:129], v[130:131] op_sel:[0,0,0] op_sel_hi:[0,1,1] neg_lo:[0,0,1]
    v_mul_f32_dpp v124, v46, v122 row_newbcast:6 row_mask:0xf bank_mask:0xf
    v_mul_f32_dpp v130, v46, v128 row_newbcast:7 row_mask:0xf bank_mask:0xf
    v_mul_f32_dpp v125, -v46, v123 row_newbcast:6 row_mask:0xf bank_mask:0xf
    v_mul_f32_dpp v131, -v46, v129 row_newbcast:7 row_mask:0xf bank_mask:0xf
    v_fmac_f32_dpp v124, -v47, v123 row_newbcast:6 row_mask:0xf bank_mask:0xf
    v_fmac_f32_dpp v130, -v47, v129 row_newbcast:7 row_mask:0xf bank_mask:0xf
    v_fmac_f32_dpp v125, -v47, v122 row_newbcast:6 row_mask:0xf bank_mask:0xf
    v_fmac_f32_dpp v131, -v47, v128 row_newbcast:7 row_mask:0xf bank_mask:0xf
    v_cvt_pk_bf16_f32 v70, v124, v125
    v_cvt_pk_bf16_f32 v71, v130, v131
    v_mul_f32_dpp v124, v48, v122 row_newbcast:6 row_mask:0xf bank_mask:0xf
    v_mul_f32_dpp v130, v48, v128 row_newbcast:7 row_mask:0xf bank_mask:0xf
    v_mul_f32_dpp v125, -v48, v123 row_newbcast:6 row_mask:0xf bank_mask:0xf
    v_mul_f32_dpp v131, -v48, v129 row_newbcast:7 row_mask:0xf bank_mask:0xf
    v_fmac_f32_dpp v124, -v49, v123 row_newbcast:6 row_mask:0xf bank_mask:0xf
    v_fmac_f32_dpp v130, -v49, v129 row_newbcast:7 row_mask:0xf bank_mask:0xf
    v_fmac_f32_dpp v125, -v49, v122 row_newbcast:6 row_mask:0xf bank_mask:0xf
    v_fmac_f32_dpp v131, -v49, v128 row_newbcast:7 row_mask:0xf bank_mask:0xf
    v_cvt_pk_bf16_f32 v74, v124, v125
    v_cvt_pk_bf16_f32 v75, v130, v131
    s_nop 1
    v_mfma_f32_16x16x32_bf16 v[76:79], v[52:55], v[60:63], v[76:79]
    v_mfma_f32_16x16x32_bf16 v[84:87], v[52:55], v[64:67], v[84:87]
    v_mfma_f32_16x16x32_bf16 v[80:83], v[56:59], v[68:71], v[80:83]
    v_mfma_f32_16x16x32_bf16 v[88:91], v[56:59], v[72:75], v[88:91]
    v_mul_f32_dpp v121, v40, v50 row_newbcast:8 row_mask:0xf bank_mask:0xf
    v_mul_f32_dpp v127, v40, v50 row_newbcast:9 row_mask:0xf bank_mask:0xf
    v_mul_f32_dpp v120, v41, v50 row_newbcast:8 row_mask:0xf bank_mask:0xf
    v_mul_f32_dpp v126, v41, v50 row_newbcast:9 row_mask:0xf bank_mask:0xf
    v_exp_f32 v121, v121
    v_exp_f32 v127, v127
    v_cos_f32 v122, v120
    v_cos_f32 v128, v126
    v_sin_f32 v123, v120
    v_sin_f32 v129, v126
    v_mul_f32 v122, v121, v122
    v_mul_f32 v128, v127, v128
    v_mul_f32 v123, v121, v123
    v_mul_f32 v129, v127, v129
    v_cvt_pk_bf16_f32 v52, v122, v123
    v_cvt_pk_bf16_f32 v53, v128, v129
    v_pk_mul_f32 v[124:125], v[122:123], v[122:123] op_sel:[1,1] op_sel_hi:[0,1]
    v_pk_mul_f32 v[130:131], v[128:129], v[128:129] op_sel:[1,1] op_sel_hi:[0,1]
    v_pk_fma_f32 v[122:123], v[122:123], v[122:123], v[124:125] op_sel:[0,0,0] op_sel_hi:[0,1,1] neg_lo:[0,0,1]
    v_pk_fma_f32 v[128:129], v[128:129], v[128:129], v[130:131] op_sel:[0,0,0] op_sel_hi:[0,1,1] neg_lo:[0,0,1]
    v_pk_mul_f32 v[124:125], v[122:123], v[122:123] op_sel:[1,1] op_sel_hi:[0,1]
    v_pk_mul_f32 v[130:131], v[128:129], v[128:129] op_sel:[1,1] op_sel_hi:[0,1]
    v_pk_fma_f32 v[122:123], v[122:123], v[122:123], v[124:125] op_sel:[0,0,0] op_sel_hi:[0,1,1] neg_lo:[0,0,1]
    v_pk_fma_f32 v[128:129], v[128:129], v[128:129], v[130:131] op_sel:[0,0,0] op_sel_hi:[0,1,1] neg_lo:[0,0,1]
    v_cvt_pk_bf16_f32 v56, v122, v123
    v_cvt_pk_bf16_f32 v57, v128, v129
    v_pk_mul_f32 v[124:125], v[122:123], v[122:123] op_sel:[1,1] op_sel_hi:[0,1]
    v_pk_mul_f32 v[130:131], v[128:129], v[128:129] op_sel:[1,1] op_sel_hi:[0,1]
    v_pk_fma_f32 v[122:123], v[122:123], v[122:123], v[124:125] op_sel:[0,0,0] op_sel_hi:[0,1,1] neg_lo:[0,0,1]
    v_pk_fma_f32 v[128:129], v[128:129], v[128:129], v[130:131] op_sel:[0,0,0] op_sel_hi:[0,1,1] neg_lo:[0,0,1]
    v_pk_mul_f32 v[124:125], v[122:123], v[122:123] op_sel:[1,1] op_sel_hi:[0,1]
    v_pk_mul_f32 v[130:131], v[128:129], v[128:129] op_sel:[1,1] op_sel_hi:[0,1]
    v_pk_fma_f32 v[122:123], v[122:123], v[122:123], v[124:125] op_sel:[0,0,0] op_sel_hi:[0,1,1] neg_lo:[0,0,1]
    v_pk_fma_f32 v[128:129], v[128:129], v[128:129], v[130:131] op_sel:[0,0,0] op_sel_hi:[0,1,1] neg_lo:[0,0,1]
    v_mul_f32_dpp v124, v42, v122 row_newbcast:8 row_mask:0xf bank_mask:0xf
    v_mul_f32_dpp v130, v42, v128 row_newbcast:9 row_mask:0xf bank_mask:0xf
    v_mul_f32_dpp v125, -v42, v123 row_newbcast:8 row_mask:0xf bank_mask:0xf
    v_mul_f32_dpp v131, -v42, v129 row_newbcast:9 row_mask:0xf bank_mask:0xf
    v_fmac_f32_dpp v124, -v43, v123 row_newbcast:8 row_mask:0xf bank_mask:0xf
    v_fmac_f32_dpp v130, -v43, v129 row_newbcast:9 row_mask:0xf bank_mask:0xf
    v_fmac_f32_dpp v125, -v43, v122 row_newbcast:8 row_mask:0xf bank_mask:0xf
    v_fmac_f32_dpp v131, -v43, v128 row_newbcast:9 row_mask:0xf bank_mask:0xf
    v_cvt_pk_bf16_f32 v60, v124, v125
    v_cvt_pk_bf16_f32 v61, v130, v131
    v_mul_f32_dpp v124, v44, v122 row_newbcast:8 row_mask:0xf bank_mask:0xf
    v_mul_f32_dpp v130, v44, v128 row_newbcast:9 row_mask:0xf bank_mask:0xf
    v_mul_f32_dpp v125, -v44, v123 row_newbcast:8 row_mask:0xf bank_mask:0xf
    v_mul_f32_dpp v131, -v44, v129 row_newbcast:9 row_mask:0xf bank_mask:0xf
    v_fmac_f32_dpp v124, -v45, v123 row_newbcast:8 row_mask:0xf bank_mask:0xf
    v_fmac_f32_dpp v130, -v45, v129 row_newbcast:9 row_mask:0xf bank_mask:0xf
    v_fmac_f32_dpp v125, -v45, v122 row_newbcast:8 row_mask:0xf bank_mask:0xf
    v_fmac_f32_dpp v131, -v45, v128 row_newbcast:9 row_mask:0xf bank_mask:0xf
    v_cvt_pk_bf16_f32 v64, v124, v125
    v_cvt_pk_bf16_f32 v65, v130, v131
    v_pk_mul_f32 v[124:125], v[122:123], v[122:123] op_sel:[1,1] op_sel_hi:[0,1]
    v_pk_mul_f32 v[130:131], v[128:129], v[128:129] op_sel:[1,1] op_sel_hi:[0,1]
    v_pk_fma_f32 v[122:123], v[122:123], v[122:123], v[124:125] op_sel:[0,0,0] op_sel_hi:[0,1,1] neg_lo:[0,0,1]
    v_pk_fma_f32 v[128:129], v[128:129], v[128:129], v[130:131] op_sel:[0,0,0] op_sel_hi:[0,1,1] neg_lo:[0,0,1]
    v_pk_mul_f32 v[124:125], v[122:123], v[122:123] op_sel:[1,1] op_sel_hi:[0,1]
    v_pk_mul_f32 v[130:131], v[128:129], v[128:129] op_sel:[1,1] op_sel_hi:[0,1]
    v_pk_fma_f32 v[122:123], v[122:123], v[122:123], v[124:125] op_sel:[0,0,0] op_sel_hi:[0,1,1] neg_lo:[0,0,1]
    v_pk_fma_f32 v[128:129], v[128:129], v[128:129], v[130:131] op_sel:[0,0,0] op_sel_hi:[0,1,1] neg_lo:[0,0,1]
    v_mul_f32_dpp v124, v46, v122 row_newbcast:8 row_mask:0xf bank_mask:0xf
    v_mul_f32_dpp v130, v46, v128 row_newbcast:9 row_mask:0xf bank_mask:0xf
    v_mul_f32_dpp v125, -v46, v123 row_newbcast:8 row_mask:0xf bank_mask:0xf
    v_mul_f32_dpp v131, -v46, v129 row_newbcast:9 row_mask:0xf bank_mask:0xf
    v_fmac_f32_dpp v124, -v47, v123 row_newbcast:8 row_mask:0xf bank_mask:0xf
    v_fmac_f32_dpp v130, -v47, v129 row_newbcast:9 row_mask:0xf bank_mask:0xf
    v_fmac_f32_dpp v125, -v47, v122 row_newbcast:8 row_mask:0xf bank_mask:0xf
    v_fmac_f32_dpp v131, -v47, v128 row_newbcast:9 row_mask:0xf bank_mask:0xf
    v_cvt_pk_bf16_f32 v68, v124, v125
    v_cvt_pk_bf16_f32 v69, v130, v131
    v_mul_f32_dpp v124, v48, v122 row_newbcast:8 row_mask:0xf bank_mask:0xf
    v_mul_f32_dpp v130, v48, v128 row_newbcast:9 row_mask:0xf bank_mask:0xf
    v_mul_f32_dpp v125, -v48, v123 row_newbcast:8 row_mask:0xf bank_mask:0xf
    v_mul_f32_dpp v131, -v48, v129 row_newbcast:9 row_mask:0xf bank_mask:0xf
    v_fmac_f32_dpp v124, -v49, v123 row_newbcast:8 row_mask:0xf bank_mask:0xf
    v_fmac_f32_dpp v130, -v49, v129 row_newbcast:9 row_mask:0xf bank_mask:0xf
    v_fmac_f32_dpp v125, -v49, v122 row_newbcast:8 row_mask:0xf bank_mask:0xf
    v_fmac_f32_dpp v131, -v49, v128 row_newbcast:9 row_mask:0xf bank_mask:0xf
    v_cvt_pk_bf16_f32 v72, v124, v125
    v_cvt_pk_bf16_f32 v73, v130, v131
    v_mul_f32_dpp v121, v40, v50 row_newbcast:10 row_mask:0xf bank_mask:0xf
    v_mul_f32_dpp v127, v40, v50 row_newbcast:11 row_mask:0xf bank_mask:0xf
    v_mul_f32_dpp v120, v41, v50 row_newbcast:10 row_mask:0xf bank_mask:0xf
    v_mul_f32_dpp v126, v41, v50 row_newbcast:11 row_mask:0xf bank_mask:0xf
    v_exp_f32 v121, v121
    v_exp_f32 v127, v127
    v_cos_f32 v122, v120
    v_cos_f32 v128, v126
    v_sin_f32 v123, v120
    v_sin_f32 v129, v126
    v_mul_f32 v122, v121, v122
    v_mul_f32 v128, v127, v128
    v_mul_f32 v123, v121, v123
    v_mul_f32 v129, v127, v129
    v_cvt_pk_bf16_f32 v54, v122, v123
    v_cvt_pk_bf16_f32 v55, v128, v129
    v_pk_mul_f32 v[124:125], v[122:123], v[122:123] op_sel:[1,1] op_sel_hi:[0,1]
    v_pk_mul_f32 v[130:131], v[128:129], v[128:129] op_sel:[1,1] op_sel_hi:[0,1]
    v_pk_fma_f32 v[122:123], v[122:123], v[122:123], v[124:125] op_sel:[0,0,0] op_sel_hi:[0,1,1] neg_lo:[0,0,1]
    v_pk_fma_f32 v[128:129], v[128:129], v[128:129], v[130:131] op_sel:[0,0,0] op_sel_hi:[0,1,1] neg_lo:[0,0,1]
    v_pk_mul_f32 v[124:125], v[122:123], v[122:123] op_sel:[1,1] op_sel_hi:[0,1]
    v_pk_mul_f32 v[130:131], v[128:129], v[128:129] op_sel:[1,1] op_sel_hi:[0,1]
    v_pk_fma_f32 v[122:123], v[122:123], v[122:123], v[124:125] op_sel:[0,0,0] op_sel_hi:[0,1,1] neg_lo:[0,0,1]
    v_pk_fma_f32 v[128:129], v[128:129], v[128:129], v[130:131] op_sel:[0,0,0] op_sel_hi:[0,1,1] neg_lo:[0,0,1]
    v_cvt_pk_bf16_f32 v58, v122, v123
    v_cvt_pk_bf16_f32 v59, v128, v129
    v_pk_mul_f32 v[124:125], v[122:123], v[122:123] op_sel:[1,1] op_sel_hi:[0,1]
    v_pk_mul_f32 v[130:131], v[128:129], v[128:129] op_sel:[1,1] op_sel_hi:[0,1]
    v_pk_fma_f32 v[122:123], v[122:123], v[122:123], v[124:125] op_sel:[0,0,0] op_sel_hi:[0,1,1] neg_lo:[0,0,1]
    v_pk_fma_f32 v[128:129], v[128:129], v[128:129], v[130:131] op_sel:[0,0,0] op_sel_hi:[0,1,1] neg_lo:[0,0,1]
    v_pk_mul_f32 v[124:125], v[122:123], v[122:123] op_sel:[1,1] op_sel_hi:[0,1]
    v_pk_mul_f32 v[130:131], v[128:129], v[128:129] op_sel:[1,1] op_sel_hi:[0,1]
    v_pk_fma_f32 v[122:123], v[122:123], v[122:123], v[124:125] op_sel:[0,0,0] op_sel_hi:[0,1,1] neg_lo:[0,0,1]
    v_pk_fma_f32 v[128:129], v[128:129], v[128:129], v[130:131] op_sel:[0,0,0] op_sel_hi:[0,1,1] neg_lo:[0,0,1]
    v_mul_f32_dpp v124, v42, v122 row_newbcast:10 row_mask:0xf bank_mask:0xf
    v_mul_f32_dpp v130, v42, v128 row_newbcast:11 row_mask:0xf bank_mask:0xf
    v_mul_f32_dpp v125, -v42, v123 row_newbcast:10 row_mask:0xf bank_mask:0xf
    v_mul_f32_dpp v131, -v42, v129 row_newbcast:11 row_mask:0xf bank_mask:0xf
    v_fmac_f32_dpp v124, -v43, v123 row_newbcast:10 row_mask:0xf bank_mask:0xf
    v_fmac_f32_dpp v130, -v43, v129 row_newbcast:11 row_mask:0xf bank_mask:0xf
    v_fmac_f32_dpp v125, -v43, v122 row_newbcast:10 row_mask:0xf bank_mask:0xf
    v_fmac_f32_dpp v131, -v43, v128 row_newbcast:11 row_mask:0xf bank_mask:0xf
    v_cvt_pk_bf16_f32 v62, v124, v125
    v_cvt_pk_bf16_f32 v63, v130, v131
    v_mul_f32_dpp v124, v44, v122 row_newbcast:10 row_mask:0xf bank_mask:0xf
    v_mul_f32_dpp v130, v44, v128 row_newbcast:11 row_mask:0xf bank_mask:0xf
    v_mul_f32_dpp v125, -v44, v123 row_newbcast:10 row_mask:0xf bank_mask:0xf
    v_mul_f32_dpp v131, -v44, v129 row_newbcast:11 row_mask:0xf bank_mask:0xf
    v_fmac_f32_dpp v124, -v45, v123 row_newbcast:10 row_mask:0xf bank_mask:0xf
    v_fmac_f32_dpp v130, -v45, v129 row_newbcast:11 row_mask:0xf bank_mask:0xf
    v_fmac_f32_dpp v125, -v45, v122 row_newbcast:10 row_mask:0xf bank_mask:0xf
    v_fmac_f32_dpp v131, -v45, v128 row_newbcast:11 row_mask:0xf bank_mask:0xf
    v_cvt_pk_bf16_f32 v66, v124, v125
    v_cvt_pk_bf16_f32 v67, v130, v131
    v_pk_mul_f32 v[124:125], v[122:123], v[122:123] op_sel:[1,1] op_sel_hi:[0,1]
    v_pk_mul_f32 v[130:131], v[128:129], v[128:129] op_sel:[1,1] op_sel_hi:[0,1]
    v_pk_fma_f32 v[122:123], v[122:123], v[122:123], v[124:125] op_sel:[0,0,0] op_sel_hi:[0,1,1] neg_lo:[0,0,1]
    v_pk_fma_f32 v[128:129], v[128:129], v[128:129], v[130:131] op_sel:[0,0,0] op_sel_hi:[0,1,1] neg_lo:[0,0,1]
    v_pk_mul_f32 v[124:125], v[122:123], v[122:123] op_sel:[1,1] op_sel_hi:[0,1]
    v_pk_mul_f32 v[130:131], v[128:129], v[128:129] op_sel:[1,1] op_sel_hi:[0,1]
    v_pk_fma_f32 v[122:123], v[122:123], v[122:123], v[124:125] op_sel:[0,0,0] op_sel_hi:[0,1,1] neg_lo:[0,0,1]
    v_pk_fma_f32 v[128:129], v[128:129], v[128:129], v[130:131] op_sel:[0,0,0] op_sel_hi:[0,1,1] neg_lo:[0,0,1]
    v_mul_f32_dpp v124, v46, v122 row_newbcast:10 row_mask:0xf bank_mask:0xf
    v_mul_f32_dpp v130, v46, v128 row_newbcast:11 row_mask:0xf bank_mask:0xf
    v_mul_f32_dpp v125, -v46, v123 row_newbcast:10 row_mask:0xf bank_mask:0xf
    v_mul_f32_dpp v131, -v46, v129 row_newbcast:11 row_mask:0xf bank_mask:0xf
    v_fmac_f32_dpp v124, -v47, v123 row_newbcast:10 row_mask:0xf bank_mask:0xf
    v_fmac_f32_dpp v130, -v47, v129 row_newbcast:11 row_mask:0xf bank_mask:0xf
    v_fmac_f32_dpp v125, -v47, v122 row_newbcast:10 row_mask:0xf bank_mask:0xf
    v_fmac_f32_dpp v131, -v47, v128 row_newbcast:11 row_mask:0xf bank_mask:0xf
    v_cvt_pk_bf16_f32 v70, v124, v125
    v_cvt_pk_bf16_f32 v71, v130, v131
    v_mul_f32_dpp v124, v48, v122 row_newbcast:10 row_mask:0xf bank_mask:0xf
    v_mul_f32_dpp v130, v48, v128 row_newbcast:11 row_mask:0xf bank_mask:0xf
    v_mul_f32_dpp v125, -v48, v123 row_newbcast:10 row_mask:0xf bank_mask:0xf
    v_mul_f32_dpp v131, -v48, v129 row_newbcast:11 row_mask:0xf bank_mask:0xf
    v_fmac_f32_dpp v124, -v49, v123 row_newbcast:10 row_mask:0xf bank_mask:0xf
    v_fmac_f32_dpp v130, -v49, v129 row_newbcast:11 row_mask:0xf bank_mask:0xf
    v_fmac_f32_dpp v125, -v49, v122 row_newbcast:10 row_mask:0xf bank_mask:0xf
    v_fmac_f32_dpp v131, -v49, v128 row_newbcast:11 row_mask:0xf bank_mask:0xf
    v_cvt_pk_bf16_f32 v74, v124, v125
    v_cvt_pk_bf16_f32 v75, v130, v131
    s_nop 1
    v_mfma_f32_16x16x32_bf16 v[92:95], v[52:55], v[60:63], 0
    v_mfma_f32_16x16x32_bf16 v[100:103], v[52:55], v[64:67], 0
    v_mfma_f32_16x16x32_bf16 v[96:99], v[56:59], v[68:71], 0
    v_mfma_f32_16x16x32_bf16 v[104:107], v[56:59], v[72:75], 0
    v_mul_f32_dpp v121, v40, v50 row_newbcast:12 row_mask:0xf bank_mask:0xf
    v_mul_f32_dpp v127, v40, v50 row_newbcast:13 row_mask:0xf bank_mask:0xf
    v_mul_f32_dpp v120, v41, v50 row_newbcast:12 row_mask:0xf bank_mask:0xf
    v_mul_f32_dpp v126, v41, v50 row_newbcast:13 row_mask:0xf bank_mask:0xf
    v_exp_f32 v121, v121
    v_exp_f32 v127, v127
    v_cos_f32 v122, v120
    v_cos_f32 v128, v126
    v_sin_f32 v123, v120
    v_sin_f32 v129, v126
    v_mul_f32 v122, v121, v122
    v_mul_f32 v128, v127, v128
    v_mul_f32 v123, v121, v123
    v_mul_f32 v129, v127, v129
    v_cvt_pk_bf16_f32 v52, v122, v123
    v_cvt_pk_bf16_f32 v53, v128, v129
    v_pk_mul_f32 v[124:125], v[122:123], v[122:123] op_sel:[1,1] op_sel_hi:[0,1]
    v_pk_mul_f32 v[130:131], v[128:129], v[128:129] op_sel:[1,1] op_sel_hi:[0,1]
    v_pk_fma_f32 v[122:123], v[122:123], v[122:123], v[124:125] op_sel:[0,0,0] op_sel_hi:[0,1,1] neg_lo:[0,0,1]
    v_pk_fma_f32 v[128:129], v[128:129], v[128:129], v[130:131] op_sel:[0,0,0] op_sel_hi:[0,1,1] neg_lo:[0,0,1]
    v_pk_mul_f32 v[124:125], v[122:123], v[122:123] op_sel:[1,1] op_sel_hi:[0,1]
    v_pk_mul_f32 v[130:131], v[128:129], v[128:129] op_sel:[1,1] op_sel_hi:[0,1]
    v_pk_fma_f32 v[122:123], v[122:123], v[122:123], v[124:125] op_sel:[0,0,0] op_sel_hi:[0,1,1] neg_lo:[0,0,1]
    v_pk_fma_f32 v[128:129], v[128:129], v[128:129], v[130:131] op_sel:[0,0,0] op_sel_hi:[0,1,1] neg_lo:[0,0,1]
    v_cvt_pk_bf16_f32 v56, v122, v123
    v_cvt_pk_bf16_f32 v57, v128, v129
    v_pk_mul_f32 v[124:125], v[122:123], v[122:123] op_sel:[1,1] op_sel_hi:[0,1]
    v_pk_mul_f32 v[130:131], v[128:129], v[128:129] op_sel:[1,1] op_sel_hi:[0,1]
    v_pk_fma_f32 v[122:123], v[122:123], v[122:123], v[124:125] op_sel:[0,0,0] op_sel_hi:[0,1,1] neg_lo:[0,0,1]
    v_pk_fma_f32 v[128:129], v[128:129], v[128:129], v[130:131] op_sel:[0,0,0] op_sel_hi:[0,1,1] neg_lo:[0,0,1]
    v_pk_mul_f32 v[124:125], v[122:123], v[122:123] op_sel:[1,1] op_sel_hi:[0,1]
    v_pk_mul_f32 v[130:131], v[128:129], v[128:129] op_sel:[1,1] op_sel_hi:[0,1]
    v_pk_fma_f32 v[122:123], v[122:123], v[122:123], v[124:125] op_sel:[0,0,0] op_sel_hi:[0,1,1] neg_lo:[0,0,1]
    v_pk_fma_f32 v[128:129], v[128:129], v[128:129], v[130:131] op_sel:[0,0,0] op_sel_hi:[0,1,1] neg_lo:[0,0,1]
    v_mul_f32_dpp v124, v42, v122 row_newbcast:12 row_mask:0xf bank_mask:0xf
    v_mul_f32_dpp v130, v42, v128 row_newbcast:13 row_mask:0xf bank_mask:0xf
    v_mul_f32_dpp v125, -v42, v123 row_newbcast:12 row_mask:0xf bank_mask:0xf
    v_mul_f32_dpp v131, -v42, v129 row_newbcast:13 row_mask:0xf bank_mask:0xf
    v_fmac_f32_dpp v124, -v43, v123 row_newbcast:12 row_mask:0xf bank_mask:0xf
    v_fmac_f32_dpp v130, -v43, v129 row_newbcast:13 row_mask:0xf bank_mask:0xf
    v_fmac_f32_dpp v125, -v43, v122 row_newbcast:12 row_mask:0xf bank_mask:0xf
    v_fmac_f32_dpp v131, -v43, v128 row_newbcast:13 row_mask:0xf bank_mask:0xf
    v_cvt_pk_bf16_f32 v60, v124, v125
    v_cvt_pk_bf16_f32 v61, v130, v131
    v_mul_f32_dpp v124, v44, v122 row_newbcast:12 row_mask:0xf bank_mask:0xf
    v_mul_f32_dpp v130, v44, v128 row_newbcast:13 row_mask:0xf bank_mask:0xf
    v_mul_f32_dpp v125, -v44, v123 row_newbcast:12 row_mask:0xf bank_mask:0xf
    v_mul_f32_dpp v131, -v44, v129 row_newbcast:13 row_mask:0xf bank_mask:0xf
    v_fmac_f32_dpp v124, -v45, v123 row_newbcast:12 row_mask:0xf bank_mask:0xf
    v_fmac_f32_dpp v130, -v45, v129 row_newbcast:13 row_mask:0xf bank_mask:0xf
    v_fmac_f32_dpp v125, -v45, v122 row_newbcast:12 row_mask:0xf bank_mask:0xf
    v_fmac_f32_dpp v131, -v45, v128 row_newbcast:13 row_mask:0xf bank_mask:0xf
    v_cvt_pk_bf16_f32 v64, v124, v125
    v_cvt_pk_bf16_f32 v65, v130, v131
    v_pk_mul_f32 v[124:125], v[122:123], v[122:123] op_sel:[1,1] op_sel_hi:[0,1]
    v_pk_mul_f32 v[130:131], v[128:129], v[128:129] op_sel:[1,1] op_sel_hi:[0,1]
    v_pk_fma_f32 v[122:123], v[122:123], v[122:123], v[124:125] op_sel:[0,0,0] op_sel_hi:[0,1,1] neg_lo:[0,0,1]
    v_pk_fma_f32 v[128:129], v[128:129], v[128:129], v[130:131] op_sel:[0,0,0] op_sel_hi:[0,1,1] neg_lo:[0,0,1]
    v_pk_mul_f32 v[124:125], v[122:123], v[122:123] op_sel:[1,1] op_sel_hi:[0,1]
    v_pk_mul_f32 v[130:131], v[128:129], v[128:129] op_sel:[1,1] op_sel_hi:[0,1]
    v_pk_fma_f32 v[122:123], v[122:123], v[122:123], v[124:125] op_sel:[0,0,0] op_sel_hi:[0,1,1] neg_lo:[0,0,1]
    v_pk_fma_f32 v[128:129], v[128:129], v[128:129], v[130:131] op_sel:[0,0,0] op_sel_hi:[0,1,1] neg_lo:[0,0,1]
    v_mul_f32_dpp v124, v46, v122 row_newbcast:12 row_mask:0xf bank_mask:0xf
    v_mul_f32_dpp v130, v46, v128 row_newbcast:13 row_mask:0xf bank_mask:0xf
    v_mul_f32_dpp v125, -v46, v123 row_newbcast:12 row_mask:0xf bank_mask:0xf
    v_mul_f32_dpp v131, -v46, v129 row_newbcast:13 row_mask:0xf bank_mask:0xf
    v_fmac_f32_dpp v124, -v47, v123 row_newbcast:12 row_mask:0xf bank_mask:0xf
    v_fmac_f32_dpp v130, -v47, v129 row_newbcast:13 row_mask:0xf bank_mask:0xf
    v_fmac_f32_dpp v125, -v47, v122 row_newbcast:12 row_mask:0xf bank_mask:0xf
    v_fmac_f32_dpp v131, -v47, v128 row_newbcast:13 row_mask:0xf bank_mask:0xf
    v_cvt_pk_bf16_f32 v68, v124, v125
    v_cvt_pk_bf16_f32 v69, v130, v131
    v_mul_f32_dpp v124, v48, v122 row_newbcast:12 row_mask:0xf bank_mask:0xf
    v_mul_f32_dpp v130, v48, v128 row_newbcast:13 row_mask:0xf bank_mask:0xf
    v_mul_f32_dpp v125, -v48, v123 row_newbcast:12 row_mask:0xf bank_mask:0xf
    v_mul_f32_dpp v131, -v48, v129 row_newbcast:13 row_mask:0xf bank_mask:0xf
    v_fmac_f32_dpp v124, -v49, v123 row_newbcast:12 row_mask:0xf bank_mask:0xf
    v_fmac_f32_dpp v130, -v49, v129 row_newbcast:13 row_mask:0xf bank_mask:0xf
    v_fmac_f32_dpp v125, -v49, v122 row_newbcast:12 row_mask:0xf bank_mask:0xf
    v_fmac_f32_dpp v131, -v49, v128 row_newbcast:13 row_mask:0xf bank_mask:0xf
    v_cvt_pk_bf16_f32 v72, v124, v125
    v_cvt_pk_bf16_f32 v73, v130, v131
    v_mul_f32_dpp v121, v40, v50 row_newbcast:14 row_mask:0xf bank_mask:0xf
    v_mul_f32_dpp v127, v40, v50 row_newbcast:15 row_mask:0xf bank_mask:0xf
    v_mul_f32_dpp v120, v41, v50 row_newbcast:14 row_mask:0xf bank_mask:0xf
    v_mul_f32_dpp v126, v41, v50 row_newbcast:15 row_mask:0xf bank_mask:0xf
    v_exp_f32 v121, v121
    v_exp_f32 v127, v127
    v_cos_f32 v122, v120
    v_cos_f32 v128, v126
    v_sin_f32 v123, v120
    v_sin_f32 v129, v126
    v_mul_f32 v122, v121, v122
    v_mul_f32 v128, v127, v128
    v_mul_f32 v123, v121, v123
    v_mul_f32 v129, v127, v129
    v_cvt_pk_bf16_f32 v54, v122, v123
    v_cvt_pk_bf16_f32 v55, v128, v129
    v_pk_mul_f32 v[124:125], v[122:123], v[122:123] op_sel:[1,1] op_sel_hi:[0,1]
    v_pk_mul_f32 v[130:131], v[128:129], v[128:129] op_sel:[1,1] op_sel_hi:[0,1]
    v_pk_fma_f32 v[122:123], v[122:123], v[122:123], v[124:125] op_sel:[0,0,0] op_sel_hi:[0,1,1] neg_lo:[0,0,1]
    v_pk_fma_f32 v[128:129], v[128:129], v[128:129], v[130:131] op_sel:[0,0,0] op_sel_hi:[0,1,1] neg_lo:[0,0,1]
    v_pk_mul_f32 v[124:125], v[122:123], v[122:123] op_sel:[1,1] op_sel_hi:[0,1]
    v_pk_mul_f32 v[130:131], v[128:129], v[128:129] op_sel:[1,1] op_sel_hi:[0,1]
    v_pk_fma_f32 v[122:123], v[122:123], v[122:123], v[124:125] op_sel:[0,0,0] op_sel_hi:[0,1,1] neg_lo:[0,0,1]
    v_pk_fma_f32 v[128:129], v[128:129], v[128:129], v[130:131] op_sel:[0,0,0] op_sel_hi:[0,1,1] neg_lo:[0,0,1]
    v_cvt_pk_bf16_f32 v58, v122, v123
    v_cvt_pk_bf16_f32 v59, v128, v129
    v_pk_mul_f32 v[124:125], v[122:123], v[122:123] op_sel:[1,1] op_sel_hi:[0,1]
    v_pk_mul_f32 v[130:131], v[128:129], v[128:129] op_sel:[1,1] op_sel_hi:[0,1]
    v_pk_fma_f32 v[122:123], v[122:123], v[122:123], v[124:125] op_sel:[0,0,0] op_sel_hi:[0,1,1] neg_lo:[0,0,1]
    v_pk_fma_f32 v[128:129], v[128:129], v[128:129], v[130:131] op_sel:[0,0,0] op_sel_hi:[0,1,1] neg_lo:[0,0,1]
    v_pk_mul_f32 v[124:125], v[122:123], v[122:123] op_sel:[1,1] op_sel_hi:[0,1]
    v_pk_mul_f32 v[130:131], v[128:129], v[128:129] op_sel:[1,1] op_sel_hi:[0,1]
    v_pk_fma_f32 v[122:123], v[122:123], v[122:123], v[124:125] op_sel:[0,0,0] op_sel_hi:[0,1,1] neg_lo:[0,0,1]
    v_pk_fma_f32 v[128:129], v[128:129], v[128:129], v[130:131] op_sel:[0,0,0] op_sel_hi:[0,1,1] neg_lo:[0,0,1]
    v_mul_f32_dpp v124, v42, v122 row_newbcast:14 row_mask:0xf bank_mask:0xf
    v_mul_f32_dpp v130, v42, v128 row_newbcast:15 row_mask:0xf bank_mask:0xf
    v_mul_f32_dpp v125, -v42, v123 row_newbcast:14 row_mask:0xf bank_mask:0xf
    v_mul_f32_dpp v131, -v42, v129 row_newbcast:15 row_mask:0xf bank_mask:0xf
    v_fmac_f32_dpp v124, -v43, v123 row_newbcast:14 row_mask:0xf bank_mask:0xf
    v_fmac_f32_dpp v130, -v43, v129 row_newbcast:15 row_mask:0xf bank_mask:0xf
    v_fmac_f32_dpp v125, -v43, v122 row_newbcast:14 row_mask:0xf bank_mask:0xf
    v_fmac_f32_dpp v131, -v43, v128 row_newbcast:15 row_mask:0xf bank_mask:0xf
    v_cvt_pk_bf16_f32 v62, v124, v125
    v_cvt_pk_bf16_f32 v63, v130, v131
    v_mul_f32_dpp v124, v44, v122 row_newbcast:14 row_mask:0xf bank_mask:0xf
    v_mul_f32_dpp v130, v44, v128 row_newbcast:15 row_mask:0xf bank_mask:0xf
    v_mul_f32_dpp v125, -v44, v123 row_newbcast:14 row_mask:0xf bank_mask:0xf
    v_mul_f32_dpp v131, -v44, v129 row_newbcast:15 row_mask:0xf bank_mask:0xf
    v_fmac_f32_dpp v124, -v45, v123 row_newbcast:14 row_mask:0xf bank_mask:0xf
    v_fmac_f32_dpp v130, -v45, v129 row_newbcast:15 row_mask:0xf bank_mask:0xf
    v_fmac_f32_dpp v125, -v45, v122 row_newbcast:14 row_mask:0xf bank_mask:0xf
    v_fmac_f32_dpp v131, -v45, v128 row_newbcast:15 row_mask:0xf bank_mask:0xf
    v_cvt_pk_bf16_f32 v66, v124, v125
    v_cvt_pk_bf16_f32 v67, v130, v131
    v_pk_mul_f32 v[124:125], v[122:123], v[122:123] op_sel:[1,1] op_sel_hi:[0,1]
    v_pk_mul_f32 v[130:131], v[128:129], v[128:129] op_sel:[1,1] op_sel_hi:[0,1]
    v_pk_fma_f32 v[122:123], v[122:123], v[122:123], v[124:125] op_sel:[0,0,0] op_sel_hi:[0,1,1] neg_lo:[0,0,1]
    v_pk_fma_f32 v[128:129], v[128:129], v[128:129], v[130:131] op_sel:[0,0,0] op_sel_hi:[0,1,1] neg_lo:[0,0,1]
    v_pk_mul_f32 v[124:125], v[122:123], v[122:123] op_sel:[1,1] op_sel_hi:[0,1]
    v_pk_mul_f32 v[130:131], v[128:129], v[128:129] op_sel:[1,1] op_sel_hi:[0,1]
    v_pk_fma_f32 v[122:123], v[122:123], v[122:123], v[124:125] op_sel:[0,0,0] op_sel_hi:[0,1,1] neg_lo:[0,0,1]
    v_pk_fma_f32 v[128:129], v[128:129], v[128:129], v[130:131] op_sel:[0,0,0] op_sel_hi:[0,1,1] neg_lo:[0,0,1]
    v_mul_f32_dpp v124, v46, v122 row_newbcast:14 row_mask:0xf bank_mask:0xf
    v_mul_f32_dpp v130, v46, v128 row_newbcast:15 row_mask:0xf bank_mask:0xf
    v_mul_f32_dpp v125, -v46, v123 row_newbcast:14 row_mask:0xf bank_mask:0xf
    v_mul_f32_dpp v131, -v46, v129 row_newbcast:15 row_mask:0xf bank_mask:0xf
    v_fmac_f32_dpp v124, -v47, v123 row_newbcast:14 row_mask:0xf bank_mask:0xf
    v_fmac_f32_dpp v130, -v47, v129 row_newbcast:15 row_mask:0xf bank_mask:0xf
    v_fmac_f32_dpp v125, -v47, v122 row_newbcast:14 row_mask:0xf bank_mask:0xf
    v_fmac_f32_dpp v131, -v47, v128 row_newbcast:15 row_mask:0xf bank_mask:0xf
    v_cvt_pk_bf16_f32 v70, v124, v125
    v_cvt_pk_bf16_f32 v71, v130, v131
    v_mul_f32_dpp v124, v48, v122 row_newbcast:14 row_mask:0xf bank_mask:0xf
    v_mul_f32_dpp v130, v48, v128 row_newbcast:15 row_mask:0xf bank_mask:0xf
    v_mul_f32_dpp v125, -v48, v123 row_newbcast:14 row_mask:0xf bank_mask:0xf
    v_mul_f32_dpp v131, -v48, v129 row_newbcast:15 row_mask:0xf bank_mask:0xf
    v_fmac_f32_dpp v124, -v49, v123 row_newbcast:14 row_mask:0xf bank_mask:0xf
    v_fmac_f32_dpp v130, -v49, v129 row_newbcast:15 row_mask:0xf bank_mask:0xf
    v_fmac_f32_dpp v125, -v49, v122 row_newbcast:14 row_mask:0xf bank_mask:0xf
    v_fmac_f32_dpp v131, -v49, v128 row_newbcast:15 row_mask:0xf bank_mask:0xf
    v_cvt_pk_bf16_f32 v74, v124, v125
    v_cvt_pk_bf16_f32 v75, v130, v131
    s_nop 1
    v_mfma_f32_16x16x32_bf16 v[92:95], v[52:55], v[60:63], v[92:95]
    v_mfma_f32_16x16x32_bf16 v[100:103], v[52:55], v[64:67], v[100:103]
    v_mfma_f32_16x16x32_bf16 v[96:99], v[56:59], v[68:71], v[96:99]
    v_mfma_f32_16x16x32_bf16 v[104:107], v[56:59], v[72:75], v[104:107]
    v_min_u32 v9, 39, v0
    v_lshlrev_b32 v9, 2, v9
    s_and_b32 s56, s2, 7
    s_mul_i32 s56, s56, 256
    s_add_u32 s56, s56, 0x0
    s_cmp_eq_u32 s3, 4
    s_cselect_b32 s44, 0, 0x20000000
    v_or_b32 v9, s44, v9
    s_waitcnt vmcnt(0)
    buffer_load_dword v12, v9, s[28:31], s56 offen sc1
    s_waitcnt vmcnt(0)
    v_xor_b32 v12, s11, v12
    v_cmp_ne_u32 vcc, 0, v12
    s_cmp_lg_u64 vcc, 0
    s_cselect_b32 s44, 4, -1
    s_cmp_eq_u32 s44, s3
    s_cbranch_scc0 L_back_sx_1
    s_mov_b32 s61, 0
L_retry_sx_1:
    s_add_u32 s61, s61, 1
    s_cmp_gt_u32 s61, 50000
    s_cbranch_scc1 L_back_sx_1
    s_sleep 1
    buffer_load_dword v12, v9, s[28:31], s56 offen sc1
    s_waitcnt vmcnt(0)
    v_xor_b32 v12, s11, v12
    v_cmp_ne_u32 vcc, 0, v12
    s_cmp_lg_u64 vcc, 0
    s_cbranch_scc1 L_retry_sx_1
L_back_sx_1:
    s_nop 7
    s_and_b32 s44, s3, 3
    s_mul_i32 s44, s44, 3072
    s_add_u32 s44, s44, 81920
    v_lshl_add_u32 v1, v0, 4, s44
    s_mov_b64 exec, 1
    v_add_f32 v76, s97, v76
    v_add_f32 v92, s98, v92
    s_mov_b64 exec, -1
    v_mov_b32 v85, v86
    v_mov_b32 v86, v88
    v_mov_b32 v87, v90
    ds_write_b128 v1, v[76:79] offset:0
    ds_write_b128 v1, v[80:83] offset:1024
    ds_write_b128 v1, v[84:87] offset:2048
    v_mov_b32 v101, v102
    v_mov_b32 v102, v104
    v_mov_b32 v103, v106
    ds_write_b128 v1, v[92:95] offset:12288
    ds_write_b128 v1, v[96:99] offset:13312
    ds_write_b128 v1, v[100:103] offset:14336
    v_mov_b32 v12, 0
    v_mov_b32 v13, 0
    v_mov_b32 v14, 0
    v_mov_b32 v15, 0
    s_waitcnt lgkmcnt(0)
    s_barrier
    s_and_b32 s44, s3, 3
    s_mul_i32 s45, s44, 192
    s_lshl_b32 s100, s9, 4
    s_add_u32 s100, s100, 0x100000
    s_mov_b32 s48, 1431655766
    v_add_u32 v10, s45, v0
    v_add_u32 v10, 0, v10
    v_mul_hi_u32 v11, v10, s48
    v_mul_u32_u24 v1, 3, v11
    v_sub_u32 v10, v10, v1
    v_mul_u32_u24 v11, 10240, v11
    v_lshl_add_u32 v36, v10, 4, v11
    v_add_u32 v10, s45, v0
    v_add_u32 v10, 64, v10
    v_mul_hi_u32 v11, v10, s48
    v_mul_u32_u24 v1, 3, v11
    v_sub_u32 v10, v10, v1
    v_mul_u32_u24 v11, 10240, v11
    v_lshl_add_u32 v37, v10, 4, v11
    v_add_u32 v10, s45, v0
    v_add_u32 v10, 128, v10
    v_mul_hi_u32 v11, v10, s48
    v_mul_u32_u24 v1, 3, v11
    v_sub_u32 v10, v10, v1
    v_mul_u32_u24 v11, 10240, v11
    v_lshl_add_u32 v38, v10, 4, v11
    buffer_load_dwordx4 v[132:135], v36, s[28:31], s100 offen sc1
    buffer_load_dwordx4 v[136:139], v37, s[28:31], s100 offen sc1
    buffer_load_dwordx4 v[140:143], v38, s[28:31], s100 offen sc1
    s_getpc_b64 s[44:45]
L_pc_sx:
    s_add_u32 s44, s44, L_table-L_pc_sx
    s_addc_u32 s45, s45, 0
    s_and_b32 s46, s3, 3
    s_mul_i32 s46, s46, 3072
    v_mul_u32_u24 v1, 48, v0
    v_add_u32 v1, s46, v1
    global_load_dwordx4 v[144:147], v1, s[44:45] offset:0
    global_load_dwordx4 v[148:151], v1, s[44:45] offset:16
    global_load_dwordx4 v[152:155], v1, s[44:45] offset:32
    s_and_b32 s44, s3, 3
    s_and_b32 s45, s44, 1
    s_lshr_b32 s46, s44, 1
    s_lshl_b32 s47, s46, 10
    s_lshl_b32 s48, s46, 3
    s_add_u32 s48, s48, 2048
    s_cmp_eq_u32 s45, 0
    s_cselect_b32 s47, s47, s48
    v_lshl_add_u32 v2, v0, 4, s47
    v_add_u32 v5, 147456, v2
    v_add_u32 v2, 81920, v2
    ds_read_b64 v[44:45], v2 offset:0
    ds_read_b64 v[46:47], v2 offset:8
    ds_read_b64 v[48:49], v2 offset:3072
    ds_read_b64 v[50:51], v2 offset:3080
    ds_read_b64 v[52:53], v2 offset:6144
    ds_read_b64 v[54:55], v2 offset:6152
    ds_read_b64 v[56:57], v2 offset:9216
    ds_read_b64 v[58:59], v2 offset:9224
    ds_read_b64 v[60:61], v2 offset:12288
    ds_read_b64 v[62:63], v2 offset:12296
    ds_read_b64 v[64:65], v2 offset:15360
    ds_read_b64 v[66:67], v2 offset:15368
    ds_read_b64 v[68:69], v2 offset:18432
    ds_read_b64 v[70:71], v2 offset:18440
    ds_read_b64 v[72:73], v2 offset:21504
    ds_read_b64 v[74:75], v2 offset:21512
    ds_read_b64 v[76:77], v5 offset:0
    ds_read_b64 v[78:79], v5 offset:8
    ds_read_b64 v[80:81], v5 offset:3072
    ds_read_b64 v[82:83], v5 offset:3080
    ds_read_b64 v[84:85], v5 offset:6144
    ds_read_b64 v[86:87], v5 offset:6152
    ds_read_b64 v[88:89], v5 offset:9216
    ds_read_b64 v[90:91], v5 offset:9224
    v_and_b32 v3, 15, v0
    v_lshlrev_b32 v3, 5, v3
    v_lshrrev_b32 v4, 4, v0
    v_lshl_add_u32 v3, v4, 3, v3
    s_lshl_b32 s44, s44, 9
    s_add_u32 s44, s44, 114688
    v_add_u32 v3, s44, v3
    s_cmp_lg_u32 s45, 0
    s_cselect_b64 vcc, -1, 0
    s_waitcnt lgkmcnt(0)
    v_pk_add_f32 v[44:45], v[44:45], v[48:49]
    v_pk_add_f32 v[52:53], v[52:53], v[56:57]
    v_pk_add_f32 v[46:47], v[46:47], v[50:51]
    v_pk_add_f32 v[54:55], v[54:55], v[58:59]
    v_pk_add_f32 v[44:45], v[44:45], v[52:53]
    v_pk_add_f32 v[46:47], v[46:47], v[54:55]
    v_cndmask_b32 v46, v46, v45, vcc
    v_cndmask_b32 v45, v45, v15, vcc
    v_cndmask_b32 v47, v47, v15, vcc
    v_cvt_pk_bf16_f32 v48, v44, v45
    v_cvt_pk_bf16_f32 v49, v46, v47
    ds_write_b64 v3, v[48:49] offset:0
    v_pk_add_f32 v[60:61], v[60:61], v[64:65]
    v_pk_add_f32 v[68:69], v[68:69], v[72:73]
    v_pk_add_f32 v[62:63], v[62:63], v[66:67]
    v_pk_add_f32 v[70:71], v[70:71], v[74:75]
    v_pk_add_f32 v[60:61], v[60:61], v[68:69]
    v_pk_add_f32 v[62:63], v[62:63], v[70:71]
    v_cndmask_b32 v62, v62, v61, vcc
    v_cndmask_b32 v61, v61, v15, vcc
    v_cndmask_b32 v63, v63, v15, vcc
    v_cvt_pk_bf16_f32 v64, v60, v61
    v_cvt_pk_bf16_f32 v65, v62, v63
    ds_write_b64 v3, v[64:65] offset:2048
    v_pk_add_f32 v[76:77], v[76:77], v[80:81]
    v_pk_add_f32 v[84:85], v[84:85], v[88:89]
    v_pk_add_f32 v[78:79], v[78:79], v[82:83]
    v_pk_add_f32 v[86:87], v[86:87], v[90:91]
    v_pk_add_f32 v[76:77], v[76:77], v[84:85]
    v_pk_add_f32 v[78:79], v[78:79], v[86:87]
    v_cndmask_b32 v78, v78, v77, vcc
    v_cndmask_b32 v77, v77, v15, vcc
    v_cndmask_b32 v79, v79, v15, vcc
    v_cvt_pk_bf16_f32 v80, v76, v77
    v_cvt_pk_bf16_f32 v81, v78, v79
    ds_write_b64 v3, v[80:81] offset:4096
    s_waitcnt vmcnt(0)
    s_branch L_x_post
L_slow_m_1:
    s_mov_b32 s61, 0
L_retry_m_1:
    s_add_u32 s61, s61, 1
    s_cmp_gt_u32 s61, 50000
    s_cbranch_scc1 L_back_m_1
    s_sleep 1
    v_mov_b32 v240, 0
    buffer_load_dword v240, v240, s[36:39], 0 offen sc1
    s_waitcnt vmcnt(0)
    v_readfirstlane_b32 s11, v240
    s_cmp_eq_u32 s11, 0
    s_cbranch_scc1 L_retry_m_1
    s_branch L_back_m_1
L_slow_x_1:
    s_mov_b32 s61, 0
L_retry_x_1:
    s_add_u32 s61, s61, 1
    s_cmp_gt_u32 s61, 50000
    s_cbranch_scc1 L_back_x_1
    s_sleep 1
    v_mov_b32 v8, 0
    buffer_load_dword v8, v8, s[36:39], 0 offen sc1
    s_waitcnt vmcnt(0)
    v_readfirstlane_b32 s11, v8
    s_cmp_eq_u32 s11, 0
    s_cbranch_scc1 L_retry_x_1
    s_branch L_back_x_1
L_slow_sc_1:
    s_mov_b32 s61, 0
L_retry_sc_1:
    s_add_u32 s61, s61, 1
    s_cmp_gt_u32 s61, 50000
    s_cbranch_scc1 L_back_sc_1
    s_sleep 1
    v_mov_b32 v3, 0
    buffer_load_dword v3, v3, s[36:39], 0 offen sc1
    s_waitcnt vmcnt(0)
    v_readfirstlane_b32 s11, v3
    s_cmp_eq_u32 s11, 0
    s_cbranch_scc1 L_retry_sc_1
    s_branch L_back_sc_1
L_exit:
    s_endpgm
L_table:
    .long 116480, 116480, 116480, 116480, 116476, 116476, 116476, 116476, 116476, 116476, 116476, 116472
    .long 116476, 116476, 116476, 116472, 116472, 116472, 116472, 116472, 116472, 116472, 116472, 116472
    .long 116472, 116472, 116472, 116472, 116468, 116468, 116468, 116468, 116468, 116468, 116468, 116464
    .long 116468, 116468, 116468, 116464, 116464, 116464, 116464, 116464, 116464, 116464, 116464, 116464
    .long 116464, 116464, 116464, 116464, 116460, 116460, 116460, 116460, 116460, 116460, 116460, 116456
    .long 116460, 116460, 116460, 116456, 116456, 116456, 116456, 116456, 116456, 116456, 116456, 116456
    .long 116456, 116456, 116456, 116456, 116452, 116452, 116452, 116452, 116452, 116452, 116452, 116448
    .long 116452, 116452, 116452, 116448, 116448, 116448, 116448, 116448, 116448, 116448, 116448, 116448
    .long 116448, 116448, 116448, 116448, 116444, 116444, 116444, 116444, 116444, 116444, 116444, 116440
    .long 116444, 116444, 116444, 116440, 116440, 116440, 116440, 116440, 116440, 116440, 116440, 116440
    .long 116440, 116440, 116440, 116440, 116436, 116436, 116436, 116436, 116436, 116436, 116436, 116432
    .long 116436, 116436, 116436, 116432, 116432, 116432, 116432, 116432, 116432, 116432, 116432, 116432
    .long 116432, 116432, 116432, 116432, 116428, 116428, 116428, 116428, 116428, 116428, 116428, 116424
    .long 116428, 116428, 116428, 116424, 116424, 116424, 116424, 116424, 116424, 116424, 116424, 116424
    .long 116424, 116424, 116424, 116424, 116420, 116420, 116420, 116420, 116420, 116420, 116420, 116416
    .long 116420, 116420, 116420, 116416, 116416, 116416, 116416, 116416, 116416, 116416, 116416, 116416
    .long 116416, 116416, 116416, 116416, 116412, 116412, 116412, 116412, 116412, 116412, 116412, 116408
    .long 116412, 116412, 116412, 116408, 116408, 116408, 116408, 116408, 116408, 116408, 116408, 116408
    .long 116408, 116408, 116408, 116408, 116404, 116404, 116404, 116404, 116404, 116404, 116404, 116400
    .long 116404, 116404, 116404, 116400, 116400, 116400, 116400, 116400, 116400, 116400, 116400, 116400
    .long 116400, 116400, 116400, 116400, 116396, 116396, 116396, 116396, 116396, 116396, 116396, 116392
    .long 116396, 116396, 116396, 116392, 116392, 116392, 116392, 116392, 116392, 116392, 116392, 116392
    .long 116392, 116392, 116392, 116392, 116388, 116388, 116388, 116388, 116388, 116388, 116388, 116384
    .long 116388, 116388, 116388, 116384, 116384, 116384, 116384, 116384, 116384, 116384, 116384, 116384
    .long 116384, 116384, 116384, 116384, 116380, 116380, 116380, 116380, 116380, 116380, 116380, 116376
    .long 116380, 116380, 116380, 116376, 116376, 116376, 116376, 116376, 116376, 116376, 116376, 116376
    .long 116376, 116376, 116376, 116376, 116372, 116372, 116372, 116372, 116372, 116372, 116372, 116368
    .long 116372, 116372, 116372, 116368, 116368, 116368, 116368, 116368, 116368, 116368, 116368, 116368
    .long 116368, 116368, 116368, 116368, 116364, 116364, 116364, 116364, 116364, 116364, 116364, 116360
    .long 116364, 116364, 116364, 116360, 116360, 116360, 116360, 116360, 116360, 116360, 116360, 116360
    .long 116360, 116360, 116360, 116360, 116356, 116356, 116356, 116356, 116356, 116356, 116356, 116352
    .long 116356, 116356, 116356, 116352, 116352, 116352, 116352, 116352, 116352, 116352, 116352, 116352
    .long 116352, 116352, 116352, 116352, 116348, 116348, 116348, 116348, 116348, 116348, 116348, 116344
    .long 116348, 116348, 116348, 116344, 116344, 116344, 116344, 116344, 116344, 116344, 116344, 116344
    .long 116344, 116344, 116344, 116344, 116340, 116340, 116340, 116340, 116340, 116340, 116340, 116336
    .long 116340, 116340, 116340, 116336, 116336, 116336, 116336, 116336, 116336, 116336, 116336, 116336
    .long 116336, 116336, 116336, 116336, 116332, 116332, 116332, 116332, 116332, 116332, 116332, 116328
    .long 116332, 116332, 116332, 116328, 116328, 116328, 116328, 116328, 116328, 116328, 116328, 116328
    .long 116328, 116328, 116328, 116328, 116324, 116324, 116324, 116324, 116324, 116324, 116324, 116320
    .long 116324, 116324, 116324, 116320, 116320, 116320, 116320, 116320, 116320, 116320, 116320, 116320
    .long 116320, 116320, 116320, 116320, 116316, 116316, 116316, 116316, 116316, 116316, 116316, 116312
    .long 116316, 116316, 116316, 116312, 116312, 116312, 116312, 116312, 116312, 116312, 116312, 116312
    .long 116312, 116312, 116312, 116312, 116308, 116308, 116308, 116308, 116308, 116308, 116308, 116304
    .long 116308, 116308, 116308, 116304, 116304, 116304, 116304, 116304, 116304, 116304, 116304, 116304
    .long 116304, 116304, 116304, 116304, 116300, 116300, 116300, 116300, 116300, 116300, 116300, 116296
    .long 116300, 116300, 116300, 116296, 116296, 116296, 116296, 116296, 116296, 116296, 116296, 116296
    .long 116296, 116296, 116296, 116296, 116292, 116292, 116292, 116292, 116292, 116292, 116292, 116288
    .long 116292, 116292, 116292, 116288, 116288, 116288, 116288, 116288, 116288, 116288, 116288, 116288
    .long 116288, 116288, 116288, 116288, 116284, 116284, 116284, 116284, 116284, 116284, 116284, 116280
    .long 116284, 116284, 116284, 116280, 116280, 116280, 116280, 116280, 116280, 116280, 116280, 116280
    .long 116280, 116280, 116280, 116280, 116276, 116276, 116276, 116276, 116276, 116276, 116276, 116272
    .long 116276, 116276, 116276, 116272, 116272, 116272, 116272, 116272, 116272, 116272, 116272, 116272
    .long 116272, 116272, 116272, 116272, 116268, 116268, 116268, 116268, 116268, 116268, 116268, 116264
    .long 116268, 116268, 116268, 116264, 116264, 116264, 116264, 116264, 116264, 116264, 116264, 116264
    .long 116264, 116264, 116264, 116264, 116260, 116260, 116260, 116260, 116260, 116260, 116260, 116256
    .long 116260, 116260, 116260, 116256, 116256, 116256, 116256, 116256, 116256, 116256, 116256, 116256
    .long 116256, 116256, 116256, 116256, 116252, 116252, 116252, 116252, 116252, 116252, 116252, 116248
    .long 116252, 116252, 116252, 116248, 116248, 116248, 116248, 116248, 116248, 116248, 116248, 116248
    .long 116248, 116248, 116248, 116248, 116244, 116244, 116244, 116244, 116244, 116244, 116244, 116240
    .long 116244, 116244, 116244, 116240, 116240, 116240, 116240, 116240, 116240, 116240, 116240, 116240
    .long 116240, 116240, 116240, 116240, 116236, 116236, 116236, 116236, 116236, 116236, 116236, 116232
    .long 116236, 116236, 116236, 116232, 116232, 116232, 116232, 116232, 116232, 116232, 116232, 116232
    .long 116232, 116232, 116232, 116232, 116228, 116228, 116228, 116228, 116228, 116228, 116228, 116224
    .long 116228, 116228, 116228, 116224, 116224, 116224, 116224, 116224, 116224, 116224, 116224, 116224
    .long 116224, 116224, 116224, 116224, 116220, 116220, 116220, 116220, 116220, 116220, 116220, 116216
    .long 116220, 116220, 116220, 116216, 116216, 116216, 116216, 116216, 116216, 116216, 116216, 116216
    .long 116216, 116216, 116216, 116216, 116212, 116212, 116212, 116212, 116212, 116212, 116212, 116208
    .long 116212, 116212, 116212, 116208, 116208, 116208, 116208, 116208, 116208, 116208, 116208, 116208
    .long 116208, 116208, 116208, 116208, 116204, 116204, 116204, 116204, 116204, 116204, 116204, 116200
    .long 116204, 116204, 116204, 116200, 116200, 116200, 116200, 116200, 116200, 116200, 116200, 116200
    .long 116200, 116200, 116200, 116200, 116196, 116196, 116196, 116196, 116196, 116196, 116196, 116192
    .long 116196, 116196, 116196, 116192, 116192, 116192, 116192, 116192, 116192, 116192, 116192, 116192
    .long 116192, 116192, 116192, 116192, 116188, 116188, 116188, 116188, 116188, 116188, 116188, 116184
    .long 116188, 116188, 116188, 116184, 116184, 116184, 116184, 116184, 116184, 116184, 116184, 116184
    .long 116184, 116184, 116184, 116184, 116180, 116180, 116180, 116180, 116180, 116180, 116180, 116176
    .long 116180, 116180, 116180, 116176, 116176, 116176, 116176, 116176, 116176, 116176, 116176, 116176
    .long 116176, 116176, 116176, 116176, 116172, 116172, 116172, 116172, 116172, 116172, 116172, 116168
    .long 116172, 116172, 116172, 116168, 116168, 116168, 116168, 116168, 116168, 116168, 116168, 116168
    .long 116168, 116168, 116168, 116168, 116164, 116164, 116164, 116164, 116164, 116164, 116164, 116160
    .long 116164, 116164, 116164, 116160, 116160, 116160, 116160, 116160, 116160, 116160, 116160, 116160
    .long 116160, 116160, 116160, 116160, 116156, 116156, 116156, 116156, 116156, 116156, 116156, 116152
    .long 116156, 116156, 116156, 116152, 116152, 116152, 116152, 116152, 116152, 116152, 116152, 116152
    .long 116152, 116152, 116152, 116152, 116148, 116148, 116148, 116148, 116148, 116148, 116148, 116144
    .long 116148, 116148, 116148, 116144, 116144, 116144, 116144, 116144, 116144, 116144, 116144, 116144
    .long 116144, 116144, 116144, 116144, 116140, 116140, 116140, 116140, 116140, 116140, 116140, 116136
    .long 116140, 116140, 116140, 116136, 116136, 116136, 116136, 116136, 116136, 116136, 116136, 116136
    .long 116136, 116136, 116136, 116136, 116132, 116132, 116132, 116132, 116132, 116132, 116132, 116128
    .long 116132, 116132, 116132, 116128, 116128, 116128, 116128, 116128, 116128, 116128, 116128, 116128
    .long 116128, 116128, 116128, 116128, 116124, 116124, 116124, 116124, 116124, 116124, 116124, 116120
    .long 116124, 116124, 116124, 116120, 116120, 116120, 116120, 116120, 116120, 116120, 116120, 116120
    .long 116120, 116120, 116120, 116120, 116116, 116116, 116116, 116116, 116116, 116116, 116116, 116112
    .long 116116, 116116, 116116, 116112, 116112, 116112, 116112, 116112, 116112, 116112, 116112, 116112
    .long 116112, 116112, 116112, 116112, 116108, 116108, 116108, 116108, 116108, 116108, 116108, 116104
    .long 116108, 116108, 116108, 116104, 116104, 116104, 116104, 116104, 116104, 116104, 116104, 116104
    .long 116104, 116104, 116104, 116104, 116100, 116100, 116100, 116100, 116100, 116100, 116100, 116096
    .long 116100, 116100, 116100, 116096, 116096, 116096, 116096, 116096, 116096, 116096, 116096, 116096
    .long 116096, 116096, 116096, 116096, 116092, 116092, 116092, 116092, 116092, 116092, 116092, 116088
    .long 116092, 116092, 116092, 116088, 116088, 116088, 116088, 116088, 116088, 116088, 116088, 116088
    .long 116088, 116088, 116088, 116088, 116084, 116084, 116084, 116084, 116084, 116084, 116084, 116080
    .long 116084, 116084, 116084, 116080, 116080, 116080, 116080, 116080, 116080, 116080, 116080, 116080
    .long 116080, 116080, 116080, 116080, 116076, 116076, 116076, 116076, 116076, 116076, 116076, 116072
    .long 116076, 116076, 116076, 116072, 116072, 116072, 116072, 116072, 116072, 116072, 116072, 116072
    .long 116072, 116072, 116072, 116072, 116068, 116068, 116068, 116068, 116068, 116068, 116068, 116064
    .long 116068, 116068, 116068, 116064, 116064, 116064, 116064, 116064, 116064, 116064, 116064, 116064
    .long 116064, 116064, 116064, 116064, 116060, 116060, 116060, 116060, 116060, 116060, 116060, 116056
    .long 116060, 116060, 116060, 116056, 116056, 116056, 116056, 116056, 116056, 116056, 116056, 116056
    .long 116056, 116056, 116056, 116056, 116052, 116052, 116052, 116052, 116052, 116052, 116052, 116048
    .long 116052, 116052, 116052, 116048, 116048, 116048, 116048, 116048, 116048, 116048, 116048, 116048
    .long 116048, 116048, 116048, 116048, 116044, 116044, 116044, 116044, 116044, 116044, 116044, 116040
    .long 116044, 116044, 116044, 116040, 116040, 116040, 116040, 116040, 116040, 116040, 116040, 116040
    .long 116040, 116040, 116040, 116040, 116036, 116036, 116036, 116036, 116036, 116036, 116036, 116032
    .long 116036, 116036, 116036, 116032, 116032, 116032, 116032, 116032, 116032, 116032, 116032, 116032
    .long 116032, 116032, 116032, 116032, 116028, 116028, 116028, 116028, 116028, 116028, 116028, 116024
    .long 116028, 116028, 116028, 116024, 116024, 116024, 116024, 116024, 116024, 116024, 116024, 116024
    .long 116024, 116024, 116024, 116024, 116020, 116020, 116020, 116020, 116020, 116020, 116020, 116016
    .long 116020, 116020, 116020, 116016, 116016, 116016, 116016, 116016, 116016, 116016, 116016, 116016
    .long 116016, 116016, 116016, 116016, 116012, 116012, 116012, 116012, 116012, 116012, 116012, 116008
    .long 116012, 116012, 116012, 116008, 116008, 116008, 116008, 116008, 116008, 116008, 116008, 116008
    .long 116008, 116008, 116008, 116008, 116004, 116004, 116004, 116004, 116004, 116004, 116004, 116000
    .long 116004, 116004, 116004, 116000, 116000, 116000, 116000, 116000, 116000, 116000, 116000, 116000
    .long 116000, 116000, 116000, 116000, 115996, 115996, 115996, 115996, 115996, 115996, 115996, 115992
    .long 115996, 115996, 115996, 115992, 115992, 115992, 115992, 115992, 115992, 115992, 115992, 115992
    .long 115992, 115992, 115992, 115992, 115988, 115988, 115988, 115988, 115988, 115988, 115988, 115984
    .long 115988, 115988, 115988, 115984, 115984, 115984, 115984, 115984, 115984, 115984, 115984, 115984
    .long 115984, 115984, 115984, 115984, 115980, 115980, 115980, 115980, 115980, 115980, 115980, 115976
    .long 115980, 115980, 115980, 115976, 115976, 115976, 115976, 115976, 115976, 115976, 115976, 115976
    .long 115976, 115976, 115976, 115976, 115972, 115972, 115972, 115972, 115972, 115972, 115972, 115968
    .long 115972, 115972, 115972, 115968, 115968, 115968, 115968, 115968, 115968, 115968, 115966, 115966
    .long 115968, 115968, 115966, 115966, 115966, 115964, 115964, 115964, 115964, 115964, 115962, 115962
    .long 115964, 115964, 115962, 115962, 115962, 115960, 115960, 115960, 115960, 115960, 115958, 115958
    .long 115960, 115960, 115958, 115958, 115958, 115956, 115956, 115956, 115956, 115956, 115954, 115954
    .long 115956, 115956, 115954, 115954, 115954, 115952, 115952, 115952, 115952, 115952, 115950, 115950
    .long 115952, 115952, 115950, 115950, 115950, 115948, 115948, 115948, 115948, 115948, 115946, 115946
    .long 115948, 115948, 115946, 115946, 115946, 115944, 115944, 115944, 115944, 115944, 115942, 115942
    .long 115944, 115944, 115942, 115942, 115942, 115940, 115940, 115940, 115940, 115940, 115938, 115938
    .long 115940, 115940, 115938, 115938, 115938, 115936, 115936, 115936, 115936, 115936, 115934, 115934
    .long 115936, 115936, 115934, 115934, 115934, 115932, 115932, 115932, 115932, 115932, 115930, 115930
    .long 115932, 115932, 115930, 115930, 115930, 115928, 115928, 115928, 115928, 115928, 115926, 115926
    .long 115928, 115928, 115926, 115926, 115926, 115924, 115924, 115924, 115924, 115924, 115922, 115922
    .long 115924, 115924, 115922, 115922, 115922, 115920, 115920, 115920, 115920, 115920, 115918, 115918
    .long 115920, 115920, 115918, 115918, 115918, 115916, 115916, 115916, 115916, 115916, 115914, 115914
    .long 115916, 115916, 115914, 115914, 115914, 115912, 115912, 115912, 115912, 115912, 115910, 115910
    .long 115912, 115912, 115910, 115910, 115910, 115908, 115908, 115908, 115908, 115908, 115906, 115906
    .long 115908, 115908, 115906, 115906, 115906, 115904, 115904, 115904, 115904, 115904, 115902, 115902
    .long 115904, 115904, 115902, 115902, 115902, 115900, 115900, 115900, 115900, 115900, 115898, 115898
    .long 115900, 115900, 115898, 115898, 115898, 115896, 115896, 115896, 115896, 115896, 115894, 115894
    .long 115896, 115896, 115894, 115894, 115894, 115892, 115892, 115892, 115892, 115892, 115890, 115890
    .long 115892, 115892, 115890, 115890, 115890, 115888, 115888, 115888, 115888, 115888, 115886, 115886
    .long 115888, 115888, 115886, 115886, 115886, 115884, 115884, 115884, 115884, 115884, 115882, 115882
    .long 115884, 115884, 115882, 115882, 115882, 115880, 115880, 115880, 115880, 115880, 115878, 115878
    .long 115880, 115880, 115878, 115878, 115878, 115876, 115876, 115876, 115876, 115876, 115874, 115874
    .long 115876, 115876, 115874, 115874, 115874, 115872, 115872, 115872, 115872, 115872, 115870, 115870
    .long 115872, 115872, 115870, 115870, 115870, 115868, 115868, 115868, 115868, 115868, 115866, 115866
    .long 115868, 115868, 115866, 115866, 115866, 115864, 115864, 115864, 115864, 115864, 115862, 115862
    .long 115864, 115864, 115862, 115862, 115862, 115860, 115860, 115860, 115860, 115860, 115858, 115858
    .long 115860, 115860, 115858, 115858, 115858, 115856, 115856, 115856, 115856, 115856, 115854, 115854
    .long 115856, 115856, 115854, 115854, 115854, 115852, 115852, 115852, 115852, 115852, 115850, 115850
    .long 115852, 115852, 115850, 115850, 115850, 115848, 115848, 115848, 115848, 115848, 115846, 115846
    .long 115848, 115848, 115846, 115846, 115846, 115844, 115844, 115844, 115844, 115844, 115842, 115842
    .long 115844, 115844, 115842, 115842, 115842, 115840, 115840, 115840, 115840, 115840, 115838, 115838
    .long 115840, 115840, 115838, 115838, 115838, 115836, 115836, 115836, 115836, 115836, 115834, 115834
    .long 115836, 115836, 115834, 115834, 115834, 115832, 115832, 115832, 115832, 115832, 115830, 115830
    .long 115832, 115832, 115830, 115830, 115830, 115828, 115828, 115828, 115828, 115828, 115826, 115826
    .long 115828, 115828, 115826, 115826, 115826, 115824, 115824, 115824, 115824, 115824, 115822, 115822
    .long 115824, 115824, 115822, 115822, 115822, 115820, 115820, 115820, 115820, 115820, 115818, 115818
    .long 115820, 115820, 115818, 115818, 115818, 115816, 115816, 115816, 115816, 115816, 115814, 115814
    .long 115816, 115816, 115814, 115814, 115814, 115812, 115812, 115812, 115812, 115812, 115810, 115810
    .long 115812, 115812, 115810, 115810, 115810, 115808, 115808, 115808, 115808, 115808, 115806, 115806
    .long 115808, 115808, 115806, 115806, 115806, 115804, 115804, 115804, 115804, 115804, 115802, 115802
    .long 115804, 115804, 115802, 115802, 115802, 115800, 115800, 115800, 115800, 115800, 115798, 115798
    .long 115800, 115800, 115798, 115798, 115798, 115796, 115796, 115796, 115796, 115796, 115794, 115794
    .long 115796, 115796, 115794, 115794, 115794, 115792, 115792, 115792, 115792, 115792, 115790, 115790
    .long 115792, 115792, 115790, 115790, 115790, 115788, 115788, 115788, 115788, 115788, 115786, 115786
    .long 115788, 115788, 115786, 115786, 115786, 115784, 115784, 115784, 115784, 115784, 115782, 115782
    .long 115784, 115784, 115782, 115782, 115782, 115780, 115780, 115780, 115780, 115780, 115778, 115778
    .long 115780, 115780, 115778, 115778, 115778, 115776, 115776, 115776, 115776, 115776, 115774, 115774
    .long 115776, 115776, 115774, 115774, 115774, 115772, 115772, 115772, 115772, 115772, 115770, 115770
    .long 115772, 115772, 115770, 115770, 115770, 115768, 115768, 115768, 115768, 115768, 115766, 115766
    .long 115768, 115768, 115766, 115766, 115766, 115764, 115764, 115764, 115764, 115764, 115762, 115762
    .long 115764, 115764, 115762, 115762, 115762, 115760, 115760, 115760, 115760, 115760, 115758, 115758
    .long 115760, 115760, 115758, 115758, 115758, 115756, 115756, 115756, 115756, 115756, 115754, 115754
    .long 115756, 115756, 115754, 115754, 115754, 115752, 115752, 115752, 115752, 115752, 115750, 115750
    .long 115752, 115752, 115750, 115750, 115750, 115748, 115748, 115748, 115748, 115748, 115746, 115746
    .long 115748, 115748, 115746, 115746, 115746, 115744, 115744, 115744, 115744, 115744, 115742, 115742
    .long 115744, 115744, 115742, 115742, 115742, 115740, 115740, 115740, 115740, 115740, 115738, 115738
    .long 115740, 115740, 115738, 115738, 115738, 115736, 115736, 115736, 115736, 115736, 115734, 115734
    .long 115736, 115736, 115734, 115734, 115734, 115732, 115732, 115732, 115732, 115732, 115730, 115730
    .long 115732, 115732, 115730, 115730, 115730, 115728, 115728, 115728, 115728, 115728, 115726, 115726
    .long 115728, 115728, 115726, 115726, 115726, 115724, 115724, 115724, 115724, 115724, 115722, 115722
    .long 115724, 115724, 115722, 115722, 115722, 115720, 115720, 115720, 115720, 115720, 115718, 115718
    .long 115720, 115720, 115718, 115718, 115718, 115716, 115716, 115716, 115716, 115716, 115714, 115714
    .long 115716, 115716, 115714, 115714, 115714, 115712, 115712, 115712, 115712, 115708, 115704, 115704
    .long 115712, 115708, 115704, 115704, 115704, 115700, 115696, 115696, 115696, 115692, 115688, 115688
    .long 115696, 115692, 115688, 115688, 115688, 115684, 115680, 115680, 115680, 115676, 115672, 115672
    .long 115680, 115676, 115672, 115672, 115672, 115668, 115664, 115664, 115664, 115660, 115656, 115656
    .long 115664, 115660, 115656, 115656, 115656, 115652, 115648, 115648, 115648, 115644, 115640, 115640
    .long 115648, 115644, 115640, 115640, 115640, 115636, 115632, 115632, 115632, 115628, 115624, 115624
    .long 115632, 115628, 115624, 115624, 115624, 115620, 115616, 115616, 115616, 115612, 115608, 115608
    .long 115616, 115612, 115608, 115608, 115608, 115604, 115600, 115600, 115600, 115596, 115592, 115592
    .long 115600, 115596, 115592, 115592, 115592, 115588, 115584, 115584, 115584, 115580, 115576, 115576
    .long 115584, 115580, 115576, 115576, 115576, 115572, 115568, 115568, 115568, 115564, 115560, 115560
    .long 115568, 115564, 115560, 115560, 115560, 115556, 115552, 115552, 115552, 115548, 115544, 115544
    .long 115552, 115548, 115544, 115544, 115544, 115540, 115536, 115536, 115536, 115532, 115528, 115528
    .long 115536, 115532, 115528, 115528, 115528, 115524, 115520, 115520, 115520, 115516, 115512, 115512
    .long 115520, 115516, 115512, 115512, 115512, 115508, 115504, 115504, 115504, 115500, 115496, 115496
    .long 115504, 115500, 115496, 115496, 115496, 115492, 115488, 115488, 115488, 115484, 115480, 115480
    .long 115488, 115484, 115480, 115480, 115480, 115476, 115472, 115472, 115472, 115468, 115464, 115464
    .long 115472, 115468, 115464, 115464, 115464, 115460, 115456, 115456, 115456, 115452, 115448, 115448
    .long 115456, 115452, 115448, 115448, 115448, 115444, 115440, 115440, 115440, 115436, 115432, 115432
    .long 115440, 115436, 115432, 115432, 115432, 115428, 115424, 115424, 115424, 115420, 115416, 115416
    .long 115424, 115420, 115416, 115416, 115416, 115412, 115408, 115408, 115408, 115404, 115400, 115400
    .long 115408, 115404, 115400, 115400, 115400, 115396, 115392, 115392, 115392, 115388, 115384, 115384
    .long 115392, 115388, 115384, 115384, 115384, 115380, 115376, 115376, 115376, 115372, 115368, 115368
    .long 115376, 115372, 115368, 115368, 115368, 115364, 115360, 115360, 115360, 115356, 115352, 115352
    .long 115360, 115356, 115352, 115352, 115352, 115348, 115344, 115344, 115344, 115340, 115336, 115336
    .long 115344, 115340, 115336, 115336, 115336, 115332, 115328, 115328, 115328, 115324, 115320, 115320
    .long 115328, 115324, 115320, 115320, 115320, 115316, 115312, 115312, 115312, 115308, 115304, 115304
    .long 115312, 115308, 115304, 115304, 115304, 115300, 115296, 115296, 115296, 115292, 115288, 115288
    .long 115296, 115292, 115288, 115288, 115288, 115284, 115280, 115280, 115280, 115276, 115272, 115272
    .long 115280, 115276, 115272, 115272, 115272, 115268, 115264, 115264, 115264, 115260, 115256, 115256
    .long 115264, 115260, 115256, 115256, 115256, 115252, 115248, 115248, 115248, 115244, 115240, 115240
    .long 115248, 115244, 115240, 115240, 115240, 115236, 115232, 115232, 115232, 115228, 115224, 115224
    .long 115232, 115228, 115224, 115224, 115224, 115220, 115216, 115216, 115216, 115212, 115208, 115208
    .long 115216, 115212, 115208, 115208, 115208, 115204, 115200, 115200, 115198, 115196, 115194, 115192
    .long 115198, 115196, 115194, 115192, 115190, 115188, 115186, 115184, 115182, 115180, 115178, 115176
    .long 115182, 115180, 115178, 115176, 115174, 115172, 115170, 115168, 115166, 115164, 115162, 115160
    .long 115166, 115164, 115162, 115160, 115158, 115156, 115154, 115152, 115150, 115148, 115146, 115144
    .long 115150, 115148, 115146, 115144, 115142, 115140, 115138, 115136, 115134, 115132, 115130, 115128
    .long 115134, 115132, 115130, 115128, 115126, 115124, 115122, 115120, 115118, 115116, 115114, 115112
    .long 115118, 115116, 115114, 115112, 115110, 115108, 115106, 115104, 115102, 115100, 115098, 115096
    .long 115102, 115100, 115098, 115096, 115094, 115092, 115090, 115088, 115086, 115084, 115082, 115080
    .long 115086, 115084, 115082, 115080, 115078, 115076, 115074, 115072, 115070, 115068, 115066, 115064
    .long 115070, 115068, 115066, 115064, 115062, 115060, 115058, 115056, 115054, 115052, 115050, 115048
    .long 115054, 115052, 115050, 115048, 115046, 115044, 115042, 115040, 115038, 115036, 115034, 115032
    .long 115038, 115036, 115034, 115032, 115030, 115028, 115026, 115024, 115022, 115020, 115018, 115016
    .long 115022, 115020, 115018, 115016, 115014, 115012, 115010, 115008, 115006, 115004, 115002, 115000
    .long 115006, 115004, 115002, 115000, 114998, 114996, 114994, 114992, 114990, 114988, 114986, 114984
    .long 114990, 114988, 114986, 114984, 114982, 114980, 114978, 114976, 114974, 114972, 114970, 114968
    .long 114974, 114972, 114970, 114968, 114966, 114964, 114962, 114960, 114958, 114956, 114954, 114952
    .long 114958, 114956, 114954, 114952, 114950, 114948, 114946, 114944, 114942, 114940, 114938, 114936
    .long 114942, 114940, 114938, 114936, 114934, 114932, 114930, 114928, 114926, 114924, 114922, 114920
    .long 114926, 114924, 114922, 114920, 114918, 114916, 114914, 114912, 114910, 114908, 114906, 114904
    .long 114910, 114908, 114906, 114904, 114902, 114900, 114898, 114896, 114894, 114892, 114890, 114888
    .long 114894, 114892, 114890, 114888, 114886, 114884, 114882, 114880, 114878, 114876, 114874, 114872
    .long 114878, 114876, 114874, 114872, 114870, 114868, 114866, 114864, 114862, 114860, 114858, 114856
    .long 114862, 114860, 114858, 114856, 114854, 114852, 114850, 114848, 114846, 114844, 114842, 114840
    .long 114846, 114844, 114842, 114840, 114838, 114836, 114834, 114832, 114830, 114828, 114826, 114824
    .long 114830, 114828, 114826, 114824, 114822, 114820, 114818, 114816, 114814, 114812, 114810, 114808
    .long 114814, 114812, 114810, 114808, 114806, 114804, 114802, 114800, 114798, 114796, 114794, 114792
    .long 114798, 114796, 114794, 114792, 114790, 114788, 114786, 114784, 114782, 114780, 114778, 114776
    .long 114782, 114780, 114778, 114776, 114774, 114772, 114770, 114768, 114766, 114764, 114762, 114760
    .long 114766, 114764, 114762, 114760, 114758, 114756, 114754, 114752, 114750, 114748, 114746, 114744
    .long 114750, 114748, 114746, 114744, 114742, 114740, 114738, 114736, 114734, 114732, 114730, 114728
    .long 114734, 114732, 114730, 114728, 114726, 114724, 114722, 114720, 114718, 114716, 114714, 114712
    .long 114718, 114716, 114714, 114712, 114710, 114708, 114706, 114704, 114702, 114700, 114698, 114696
    .long 114702, 114700, 114698, 114696, 114694, 114692, 114690, 114688, 115202, 115202, 115202, 115202
L_end:
    s_endpgm
.section .rodata,"a"
.p2align 6
.amdhsa_kernel parallel_sum__ssm_conv_s4__glu_gated_reglu__prompt_kernel
  .amdhsa_next_free_vgpr 256
  .amdhsa_next_free_sgpr 102
  .amdhsa_accum_offset 256
  .amdhsa_group_segment_fixed_size 0
  .amdhsa_kernarg_size 128
  .amdhsa_user_sgpr_count 2
  .amdhsa_user_sgpr_kernarg_segment_ptr 1
  .amdhsa_system_sgpr_workgroup_id_x 1
  .amdhsa_float_denorm_mode_32 0
  .amdhsa_ieee_mode 0
  .amdhsa_float_denorm_mode_16_64 3
.end_amdhsa_kernel
```
